```python
import torch

def _softmax(x, axis=-1):
    return torch.softmax(x, dim=axis)
def _gelu(x):
    return torch.nn.functional.gelu(x, approximate="tanh")
def _silu(x):
    return torch.nn.functional.silu(x)
def _sigmoid(x):
    return torch.sigmoid(x)
def _layernorm(x, axis=-1, eps=1e-5):
    m = x.mean(dim=axis, keepdim=True)
    v = x.var(dim=axis, keepdim=True, unbiased=False)
    return (x - m) / torch.sqrt(v + eps)
def _scatter_add(tgt, idx, src, axis=0):
    return tgt.clone().index_add_(axis, idx, src)
def _segment_sum(src, seg, n):
    out = torch.zeros((n,) + src.shape[1:], dtype=src.dtype)
    return out.index_add_(0, seg, src)
def _pad(x, pw):
    flat = tuple(v for pair in reversed(pw) for v in pair)
    return torch.nn.functional.pad(x, flat)

kernel_name = 'gated_mix__grouped_kv_mqa__glu_gated_geglu__prompt'

def setup_inputs():

    _w = (lambda a: (lambda t: t.to(torch.bfloat16) if t.is_floating_point() else t)(torch.as_tensor(a)))
    def _A_setup():
        B, S, D, H = 1, 2048, 640, 32
        Dh = D // H
        return {
            "x": _w((lambda *s: torch.randn(*s, dtype=torch.bfloat16) * 0.05)(B, S, D)),
            "wq": _w((lambda *s: torch.randn(*s, dtype=torch.bfloat16) * 0.8)(D, H * Dh)),
            "wk": _w((lambda *s: torch.randn(*s, dtype=torch.bfloat16) * 0.8)(D, Dh)),
            "wv": _w((lambda *s: torch.randn(*s, dtype=torch.bfloat16) * 0.05)(D, Dh)),
            "wo": _w((lambda *s: torch.randn(*s, dtype=torch.bfloat16) * 0.05)(H * Dh, D)),
        }
    _A_in = _A_setup()

    def _B_setup():
        B, S, Dm, Df = 1, 2048, 640, 1536
        return {
            "x": _w((lambda *s: torch.randn(*s, dtype=torch.bfloat16) * 0.05)(B, S, Dm)),
            "w_gate": _w((lambda *s: torch.randn(*s, dtype=torch.bfloat16) * 0.8)(Dm, Df) * (Dm ** -0.5)),
            "w_up": _w((lambda *s: torch.randn(*s, dtype=torch.bfloat16) * 0.8)(Dm, Df) * (Dm ** -0.5)),
            "w_down": _w((lambda *s: torch.randn(*s, dtype=torch.bfloat16) * 0.8)(Df, Dm) * (Df ** -0.5)),
        }
    _B_in = _B_setup()

    return {
        "A_x": _A_in["x"],
        "A_wq": _A_in["wq"],
        "A_wk": _A_in["wk"],
        "A_wv": _A_in["wv"],
        "A_wo": _A_in["wo"],
        "B_x": _B_in["x"],
        "B_w_gate": _B_in["w_gate"],
        "B_w_up": _B_in["w_up"],
        "B_w_down": _B_in["w_down"],
        "gate_w": _w((lambda *s: torch.randn(*s, dtype=torch.bfloat16) * 0.05)(640) * 16.0),
    }

def reference(A_x, A_wq, A_wk, A_wv, A_wo, B_x, B_w_gate, B_w_up, B_w_down, gate_w):
    def _A_ref(x, wq, wk, wv, wo):
        B, S, D = x.shape
        H = 32
        Dh = D // H
        q = (lambda x, *d: x.permute(*d))((x @ wq).reshape(B, S, H, Dh), 0, 2, 1, 3)
        k = x @ wk
        v = x @ wv
        scores = torch.einsum("bhqd,bkd->bhqk", q, k) * (Dh ** -0.5)
        p = _softmax(scores, axis=-1)
        o = torch.einsum("bhqk,bkd->bhqd", p, v)
        return (lambda x, *d: x.permute(*d))(o, 0, 2, 1, 3).reshape(B, S, H * Dh) @ wo

    def _B_ref(x, w_gate, w_up, w_down):
        g = torch.einsum("bsd,df->bsf", x, w_gate)
        u = torch.einsum("bsd,df->bsf", x, w_up)
        h = _gelu(g) * u
        return torch.einsum("bsf,fd->bsd", h, w_down)

    x = A_x
    g = _sigmoid((x * gate_w).sum(-1, keepdims=True))
    a = _A_ref(x, A_wq, A_wk, A_wv, A_wo)
    b = _B_ref(x, B_w_gate, B_w_up, B_w_down)
    return g * a + (1 - g) * b
```

```asm
; @launch grid=(256,1,1) block=(768,1,1) lds=162304
.amdgcn_target "amdgcn-amd-amdhsa--gfx950"
.text
.globl gated_mix__grouped_kv_mqa__glu_gated_geglu__prompt_kernel
.p2align 8
.type gated_mix__grouped_kv_mqa__glu_gated_geglu__prompt_kernel,@function
gated_mix__grouped_kv_mqa__glu_gated_geglu__prompt_kernel:
    s_cmp_ge_u32 s2, 256
    s_cbranch_scc1 K_done
    s_load_dwordx8 s[4:11], s[0:1], 0
    s_load_dwordx4 s[56:59], s[0:1], 48
    s_load_dwordx2 s[12:13], s[0:1], 72
    s_load_dwordx2 s[14:15], s[0:1], 96
    v_lshrrev_b32 v2, 6, v0
    v_and_b32 v1, 63, v0
    v_readfirstlane_b32 s18, v2
    s_and_b32 s40, s2, 1
    s_lshl_b32 s40, s40, 3
    s_bfe_u32 s41, s2, 0x30003
    s_add_u32 s16, s40, s41
    s_bfe_u32 s17, s2, 0x20001
    s_lshr_b32 s60, s2, 6
    s_lshr_b32 s40, s16, 2
    s_add_u32 s40, s40, s17
    s_and_b32 s40, s40, 3
    s_mul_i32 s40, s40, 5
    s_lshr_b32 s63, s40, 1
    s_lshr_b32 s40, s17, 1
    s_lshl_b32 s54, s16, 1
    s_add_u32 s54, s54, s40
    s_and_b32 s40, s17, 1
    s_lshl_b32 s40, s40, 2
    s_add_u32 s55, s40, s60
    s_cmp_lt_u32 s18, 8
    s_cbranch_scc1 K_comp
    s_sub_u32 s61, s18, 8
    v_lshrrev_b32 v2, 3, v1
    s_lshl_b32 s40, s61, 5
    v_add_u32 v2, s40, v2
    v_mul_u32_u24 v2, 1280, v2
    v_lshrrev_b32 v3, 4, v1
    v_and_b32 v9, 7, v1
    v_xor_b32 v3, v3, v9
    v_lshl_add_u32 v4, v3, 4, v2
    v_xor_b32 v3, 4, v3
    v_lshl_add_u32 v5, v3, 4, v2
    v_add_u32 v5, 10240, v5
    s_mul_i32 s40, s16, 163840
    s_lshl_b32 s43, s61, 12
    s_cmp_eq_u32 s60, 3
    s_cbranch_scc1 K_ldq
    v_lshrrev_b32 v2, 4, v1
    s_and_b32 s41, s61, 1
    s_lshl_b32 s41, s41, 2
    v_or_b32 v3, s41, v2
    s_lshl_b32 s41, s61, 3
    v_add_u32 v2, s41, v2
    v_mul_u32_u24 v2, 3072, v2
    v_bfe_u32 v9, v1, 1, 3
    v_xor_b32 v3, v3, v9
    v_lshl_add_u32 v2, v3, 5, v2
    v_and_b32 v3, 1, v1
    v_lshl_add_u32 v6, v3, 4, v2
    s_mul_i32 s41, s17, 3
    s_add_u32 s41, s41, s60
    s_lshl_b32 s41, s41, 8
    s_sub_u32 s42, 1966080, s41
    s_lshl_b32 s44, s61, 11
    s_waitcnt lgkmcnt(0)
    s_add_u32 s20, s4, s40
    s_addc_u32 s21, s5, 0
    s_mov_b32 s22, 163840
    s_mov_b32 s23, 0x00020000
    s_add_u32 s24, s56, s41
    s_addc_u32 s25, s57, 0
    s_mov_b32 s26, s42
    s_mov_b32 s27, 0x00020000
    s_add_u32 s28, s58, s41
    s_addc_u32 s29, s59, 0
    s_mov_b32 s30, s42
    s_mov_b32 s31, 0x00020000
    s_lshl_b32 s46, s63, 7
    s_add_u32 m0, s43, 0
    s_nop 0
    buffer_load_dwordx4 v4, s[20:23], s46 offen lds
    s_add_u32 m0, s43, 1024
    s_nop 0
    buffer_load_dwordx4 v5, s[20:23], s46 offen lds
    s_add_u32 s45, s46, 20480
    s_add_u32 m0, s43, 2048
    s_nop 0
    buffer_load_dwordx4 v4, s[20:23], s45 offen lds
    s_add_u32 m0, s43, 3072
    s_nop 0
    buffer_load_dwordx4 v5, s[20:23], s45 offen lds
    s_mul_i32 s47, s63, 196608
    s_add_u32 m0, s44, 65536
    s_nop 0
    buffer_load_dwordx4 v6, s[24:27], s47 offen lds
    s_add_u32 m0, s44, 73728
    s_nop 0
    buffer_load_dwordx4 v6, s[28:31], s47 offen lds
    s_add_u32 s45, s47, 12288
    s_add_u32 m0, s44, 66560
    s_nop 0
    buffer_load_dwordx4 v6, s[24:27], s45 offen lds
    s_add_u32 m0, s44, 74752
    s_nop 0
    buffer_load_dwordx4 v6, s[28:31], s45 offen lds
    s_load_dwordx2 s[6:7], s[0:1], 32
    s_load_dwordx2 s[12:13], s[0:1], 64
    s_load_dwordx4 s[8:11], s[0:1], 80
    v_lshlrev_b32 v2, 2, v1
    v_add_u32 v2, 151552, v2
    v_mov_b32 v3, 0
    ds_write_b32 v2, v3
    s_add_u32 s47, s47, 98304
    s_add_u32 m0, s44, 81920
    s_nop 0
    buffer_load_dwordx4 v6, s[24:27], s47 offen lds
    s_add_u32 m0, s44, 90112
    s_nop 0
    buffer_load_dwordx4 v6, s[28:31], s47 offen lds
    s_add_u32 s45, s47, 12288
    s_add_u32 m0, s44, 82944
    s_nop 0
    buffer_load_dwordx4 v6, s[24:27], s45 offen lds
    s_add_u32 m0, s44, 91136
    s_nop 0
    buffer_load_dwordx4 v6, s[28:31], s45 offen lds
    s_add_u32 s46, s46, 128
    s_cmp_eq_u32 s46, 1280
    s_cselect_b32 s46, 0, s46
    s_add_u32 m0, s43, 16384
    s_nop 0
    buffer_load_dwordx4 v4, s[20:23], s46 offen lds
    s_add_u32 m0, s43, 17408
    s_nop 0
    buffer_load_dwordx4 v5, s[20:23], s46 offen lds
    s_add_u32 s45, s46, 20480
    s_add_u32 m0, s43, 18432
    s_nop 0
    buffer_load_dwordx4 v4, s[20:23], s45 offen lds
    s_add_u32 m0, s43, 19456
    s_nop 0
    buffer_load_dwordx4 v5, s[20:23], s45 offen lds
    s_add_u32 s47, s47, 98304
    s_cmp_eq_u32 s47, 1966080
    s_cselect_b32 s47, 0, s47
    s_add_u32 m0, s44, 98304
    s_nop 0
    buffer_load_dwordx4 v6, s[24:27], s47 offen lds
    s_add_u32 m0, s44, 106496
    s_nop 0
    buffer_load_dwordx4 v6, s[28:31], s47 offen lds
    s_add_u32 s45, s47, 12288
    s_add_u32 m0, s44, 99328
    s_nop 0
    buffer_load_dwordx4 v6, s[24:27], s45 offen lds
    s_add_u32 m0, s44, 107520
    s_nop 0
    buffer_load_dwordx4 v6, s[28:31], s45 offen lds
    s_waitcnt vmcnt(12) lgkmcnt(0)
    s_barrier
    s_waitcnt vmcnt(8)
    s_barrier
    s_add_u32 s47, s47, 98304
    s_add_u32 m0, s44, 114688
    s_nop 0
    buffer_load_dwordx4 v6, s[24:27], s47 offen lds
    s_add_u32 m0, s44, 122880
    s_nop 0
    buffer_load_dwordx4 v6, s[28:31], s47 offen lds
    s_add_u32 s45, s47, 12288
    s_add_u32 m0, s44, 115712
    s_nop 0
    buffer_load_dwordx4 v6, s[24:27], s45 offen lds
    s_add_u32 m0, s44, 123904
    s_nop 0
    buffer_load_dwordx4 v6, s[28:31], s45 offen lds
    s_add_u32 s46, s46, 128
    s_cmp_eq_u32 s46, 1280
    s_cselect_b32 s46, 0, s46
    s_add_u32 m0, s43, 32768
    s_nop 0
    buffer_load_dwordx4 v4, s[20:23], s46 offen lds
    s_add_u32 m0, s43, 33792
    s_nop 0
    buffer_load_dwordx4 v5, s[20:23], s46 offen lds
    s_waitcnt vmcnt(6)
    s_barrier
    s_add_u32 s45, s46, 20480
    s_add_u32 m0, s43, 34816
    s_nop 0
    buffer_load_dwordx4 v4, s[20:23], s45 offen lds
    s_add_u32 m0, s43, 35840
    s_nop 0
    buffer_load_dwordx4 v5, s[20:23], s45 offen lds
    s_add_u32 s47, s47, 98304
    s_cmp_eq_u32 s47, 1966080
    s_cselect_b32 s47, 0, s47
    s_add_u32 m0, s44, 131072
    s_nop 0
    buffer_load_dwordx4 v6, s[24:27], s47 offen lds
    s_add_u32 m0, s44, 139264
    s_nop 0
    buffer_load_dwordx4 v6, s[28:31], s47 offen lds
    s_add_u32 s45, s47, 12288
    s_add_u32 m0, s44, 132096
    s_nop 0
    buffer_load_dwordx4 v6, s[24:27], s45 offen lds
    s_add_u32 m0, s44, 140288
    s_nop 0
    buffer_load_dwordx4 v6, s[28:31], s45 offen lds
    s_waitcnt vmcnt(8)
    s_barrier
    s_add_u32 s47, s47, 98304
    s_add_u32 m0, s44, 65536
    s_nop 0
    buffer_load_dwordx4 v6, s[24:27], s47 offen lds
    s_add_u32 m0, s44, 73728
    s_nop 0
    buffer_load_dwordx4 v6, s[28:31], s47 offen lds
    s_add_u32 s45, s47, 12288
    s_add_u32 m0, s44, 66560
    s_nop 0
    buffer_load_dwordx4 v6, s[24:27], s45 offen lds
    s_add_u32 m0, s44, 74752
    s_nop 0
    buffer_load_dwordx4 v6, s[28:31], s45 offen lds
    s_add_u32 s46, s46, 128
    s_cmp_eq_u32 s46, 1280
    s_cselect_b32 s46, 0, s46
    s_add_u32 m0, s43, 49152
    s_nop 0
    buffer_load_dwordx4 v4, s[20:23], s46 offen lds
    s_add_u32 m0, s43, 50176
    s_nop 0
    buffer_load_dwordx4 v5, s[20:23], s46 offen lds
    s_waitcnt vmcnt(6)
    s_barrier
    s_add_u32 s45, s46, 20480
    s_add_u32 m0, s43, 51200
    s_nop 0
    buffer_load_dwordx4 v4, s[20:23], s45 offen lds
    s_add_u32 m0, s43, 52224
    s_nop 0
    buffer_load_dwordx4 v5, s[20:23], s45 offen lds
    s_add_u32 s47, s47, 98304
    s_cmp_eq_u32 s47, 1966080
    s_cselect_b32 s47, 0, s47
    s_add_u32 m0, s44, 81920
    s_nop 0
    buffer_load_dwordx4 v6, s[24:27], s47 offen lds
    s_add_u32 m0, s44, 90112
    s_nop 0
    buffer_load_dwordx4 v6, s[28:31], s47 offen lds
    s_add_u32 s45, s47, 12288
    s_add_u32 m0, s44, 82944
    s_nop 0
    buffer_load_dwordx4 v6, s[24:27], s45 offen lds
    s_add_u32 m0, s44, 91136
    s_nop 0
    buffer_load_dwordx4 v6, s[28:31], s45 offen lds
    s_waitcnt vmcnt(8)
    s_barrier
    s_add_u32 s47, s47, 98304
    s_add_u32 m0, s44, 98304
    s_nop 0
    buffer_load_dwordx4 v6, s[24:27], s47 offen lds
    s_add_u32 m0, s44, 106496
    s_nop 0
    buffer_load_dwordx4 v6, s[28:31], s47 offen lds
    s_add_u32 s45, s47, 12288
    s_add_u32 m0, s44, 99328
    s_nop 0
    buffer_load_dwordx4 v6, s[24:27], s45 offen lds
    s_add_u32 m0, s44, 107520
    s_nop 0
    buffer_load_dwordx4 v6, s[28:31], s45 offen lds
    s_add_u32 s46, s46, 128
    s_cmp_eq_u32 s46, 1280
    s_cselect_b32 s46, 0, s46
    s_add_u32 m0, s43, 0
    s_nop 0
    buffer_load_dwordx4 v4, s[20:23], s46 offen lds
    s_add_u32 m0, s43, 1024
    s_nop 0
    buffer_load_dwordx4 v5, s[20:23], s46 offen lds
    s_waitcnt vmcnt(6)
    s_barrier
    s_add_u32 s45, s46, 20480
    s_add_u32 m0, s43, 2048
    s_nop 0
    buffer_load_dwordx4 v4, s[20:23], s45 offen lds
    s_add_u32 m0, s43, 3072
    s_nop 0
    buffer_load_dwordx4 v5, s[20:23], s45 offen lds
    s_add_u32 s47, s47, 98304
    s_cmp_eq_u32 s47, 1966080
    s_cselect_b32 s47, 0, s47
    s_add_u32 m0, s44, 114688
    s_nop 0
    buffer_load_dwordx4 v6, s[24:27], s47 offen lds
    s_add_u32 m0, s44, 122880
    s_nop 0
    buffer_load_dwordx4 v6, s[28:31], s47 offen lds
    s_add_u32 s45, s47, 12288
    s_add_u32 m0, s44, 115712
    s_nop 0
    buffer_load_dwordx4 v6, s[24:27], s45 offen lds
    s_add_u32 m0, s44, 123904
    s_nop 0
    buffer_load_dwordx4 v6, s[28:31], s45 offen lds
    s_waitcnt vmcnt(8)
    s_barrier
    s_add_u32 s47, s47, 98304
    s_add_u32 m0, s44, 131072
    s_nop 0
    buffer_load_dwordx4 v6, s[24:27], s47 offen lds
    s_add_u32 m0, s44, 139264
    s_nop 0
    buffer_load_dwordx4 v6, s[28:31], s47 offen lds
    s_add_u32 s45, s47, 12288
    s_add_u32 m0, s44, 132096
    s_nop 0
    buffer_load_dwordx4 v6, s[24:27], s45 offen lds
    s_add_u32 m0, s44, 140288
    s_nop 0
    buffer_load_dwordx4 v6, s[28:31], s45 offen lds
    s_add_u32 s46, s46, 128
    s_cmp_eq_u32 s46, 1280
    s_cselect_b32 s46, 0, s46
    s_add_u32 m0, s43, 16384
    s_nop 0
    buffer_load_dwordx4 v4, s[20:23], s46 offen lds
    s_add_u32 m0, s43, 17408
    s_nop 0
    buffer_load_dwordx4 v5, s[20:23], s46 offen lds
    s_waitcnt vmcnt(6)
    s_barrier
    s_add_u32 s45, s46, 20480
    s_add_u32 m0, s43, 18432
    s_nop 0
    buffer_load_dwordx4 v4, s[20:23], s45 offen lds
    s_add_u32 m0, s43, 19456
    s_nop 0
    buffer_load_dwordx4 v5, s[20:23], s45 offen lds
    s_add_u32 s47, s47, 98304
    s_cmp_eq_u32 s47, 1966080
    s_cselect_b32 s47, 0, s47
    s_add_u32 m0, s44, 65536
    s_nop 0
    buffer_load_dwordx4 v6, s[24:27], s47 offen lds
    s_add_u32 m0, s44, 73728
    s_nop 0
    buffer_load_dwordx4 v6, s[28:31], s47 offen lds
    s_add_u32 s45, s47, 12288
    s_add_u32 m0, s44, 66560
    s_nop 0
    buffer_load_dwordx4 v6, s[24:27], s45 offen lds
    s_add_u32 m0, s44, 74752
    s_nop 0
    buffer_load_dwordx4 v6, s[28:31], s45 offen lds
    s_waitcnt vmcnt(8)
    s_barrier
    s_add_u32 s47, s47, 98304
    s_add_u32 m0, s44, 81920
    s_nop 0
    buffer_load_dwordx4 v6, s[24:27], s47 offen lds
    s_add_u32 m0, s44, 90112
    s_nop 0
    buffer_load_dwordx4 v6, s[28:31], s47 offen lds
    s_add_u32 s45, s47, 12288
    s_add_u32 m0, s44, 82944
    s_nop 0
    buffer_load_dwordx4 v6, s[24:27], s45 offen lds
    s_add_u32 m0, s44, 91136
    s_nop 0
    buffer_load_dwordx4 v6, s[28:31], s45 offen lds
    s_add_u32 s46, s46, 128
    s_cmp_eq_u32 s46, 1280
    s_cselect_b32 s46, 0, s46
    s_add_u32 m0, s43, 32768
    s_nop 0
    buffer_load_dwordx4 v4, s[20:23], s46 offen lds
    s_add_u32 m0, s43, 33792
    s_nop 0
    buffer_load_dwordx4 v5, s[20:23], s46 offen lds
    s_waitcnt vmcnt(6)
    s_barrier
    s_add_u32 s45, s46, 20480
    s_add_u32 m0, s43, 34816
    s_nop 0
    buffer_load_dwordx4 v4, s[20:23], s45 offen lds
    s_add_u32 m0, s43, 35840
    s_nop 0
    buffer_load_dwordx4 v5, s[20:23], s45 offen lds
    s_add_u32 s47, s47, 98304
    s_cmp_eq_u32 s47, 1966080
    s_cselect_b32 s47, 0, s47
    s_add_u32 m0, s44, 98304
    s_nop 0
    buffer_load_dwordx4 v6, s[24:27], s47 offen lds
    s_add_u32 m0, s44, 106496
    s_nop 0
    buffer_load_dwordx4 v6, s[28:31], s47 offen lds
    s_add_u32 s45, s47, 12288
    s_add_u32 m0, s44, 99328
    s_nop 0
    buffer_load_dwordx4 v6, s[24:27], s45 offen lds
    s_add_u32 m0, s44, 107520
    s_nop 0
    buffer_load_dwordx4 v6, s[28:31], s45 offen lds
    s_load_dword s48, s[10:11], 0
    s_waitcnt vmcnt(8)
    s_barrier
    s_add_u32 s47, s47, 98304
    s_add_u32 m0, s44, 114688
    s_nop 0
    buffer_load_dwordx4 v6, s[24:27], s47 offen lds
    s_add_u32 m0, s44, 122880
    s_nop 0
    buffer_load_dwordx4 v6, s[28:31], s47 offen lds
    s_add_u32 s45, s47, 12288
    s_add_u32 m0, s44, 115712
    s_nop 0
    buffer_load_dwordx4 v6, s[24:27], s45 offen lds
    s_add_u32 m0, s44, 123904
    s_nop 0
    buffer_load_dwordx4 v6, s[28:31], s45 offen lds
    s_add_u32 s46, s46, 128
    s_cmp_eq_u32 s46, 1280
    s_cselect_b32 s46, 0, s46
    s_add_u32 m0, s43, 49152
    s_nop 0
    buffer_load_dwordx4 v4, s[20:23], s46 offen lds
    s_add_u32 m0, s43, 50176
    s_nop 0
    buffer_load_dwordx4 v5, s[20:23], s46 offen lds
    s_waitcnt vmcnt(6)
    s_barrier
    s_add_u32 s45, s46, 20480
    s_add_u32 m0, s43, 51200
    s_nop 0
    buffer_load_dwordx4 v4, s[20:23], s45 offen lds
    s_add_u32 m0, s43, 52224
    s_nop 0
    buffer_load_dwordx4 v5, s[20:23], s45 offen lds
    s_add_u32 s47, s47, 98304
    s_cmp_eq_u32 s47, 1966080
    s_cselect_b32 s47, 0, s47
    s_add_u32 m0, s44, 131072
    s_nop 0
    buffer_load_dwordx4 v6, s[24:27], s47 offen lds
    s_add_u32 m0, s44, 139264
    s_nop 0
    buffer_load_dwordx4 v6, s[28:31], s47 offen lds
    s_add_u32 s45, s47, 12288
    s_add_u32 m0, s44, 132096
    s_nop 0
    buffer_load_dwordx4 v6, s[24:27], s45 offen lds
    s_add_u32 m0, s44, 140288
    s_nop 0
    buffer_load_dwordx4 v6, s[28:31], s45 offen lds
    s_waitcnt vmcnt(8)
    s_barrier
    s_add_u32 s47, s47, 98304
    s_add_u32 m0, s44, 65536
    s_nop 0
    buffer_load_dwordx4 v6, s[24:27], s47 offen lds
    s_add_u32 m0, s44, 73728
    s_nop 0
    buffer_load_dwordx4 v6, s[28:31], s47 offen lds
    s_add_u32 s45, s47, 12288
    s_add_u32 m0, s44, 66560
    s_nop 0
    buffer_load_dwordx4 v6, s[24:27], s45 offen lds
    s_add_u32 m0, s44, 74752
    s_nop 0
    buffer_load_dwordx4 v6, s[28:31], s45 offen lds
    s_add_u32 s46, s46, 128
    s_cmp_eq_u32 s46, 1280
    s_cselect_b32 s46, 0, s46
    s_add_u32 m0, s43, 0
    s_nop 0
    buffer_load_dwordx4 v4, s[20:23], s46 offen lds
    s_add_u32 m0, s43, 1024
    s_nop 0
    buffer_load_dwordx4 v5, s[20:23], s46 offen lds
    s_waitcnt lgkmcnt(0)
    s_cmp_ge_u32 s48, 64
    s_cbranch_scc0 LF_slow
LF_back:
    s_waitcnt vmcnt(6)
    s_barrier
    s_add_u32 s45, s46, 20480
    s_add_u32 m0, s43, 2048
    s_nop 0
    buffer_load_dwordx4 v4, s[20:23], s45 offen lds
    s_add_u32 m0, s43, 3072
    s_nop 0
    buffer_load_dwordx4 v5, s[20:23], s45 offen lds
    s_add_u32 s47, s47, 98304
    s_cmp_eq_u32 s47, 1966080
    s_cselect_b32 s47, 0, s47
    s_add_u32 m0, s44, 81920
    s_nop 0
    buffer_load_dwordx4 v6, s[24:27], s47 offen lds
    s_add_u32 m0, s44, 90112
    s_nop 0
    buffer_load_dwordx4 v6, s[28:31], s47 offen lds
    s_add_u32 s45, s47, 12288
    s_add_u32 m0, s44, 82944
    s_nop 0
    buffer_load_dwordx4 v6, s[24:27], s45 offen lds
    s_add_u32 m0, s44, 91136
    s_nop 0
    buffer_load_dwordx4 v6, s[28:31], s45 offen lds
    s_waitcnt vmcnt(8)
    s_barrier
    s_add_u32 s47, s47, 98304
    s_add_u32 m0, s44, 98304
    s_nop 0
    buffer_load_dwordx4 v6, s[24:27], s47 offen lds
    s_add_u32 m0, s44, 106496
    s_nop 0
    buffer_load_dwordx4 v6, s[28:31], s47 offen lds
    s_add_u32 s45, s47, 12288
    s_add_u32 m0, s44, 99328
    s_nop 0
    buffer_load_dwordx4 v6, s[24:27], s45 offen lds
    s_add_u32 m0, s44, 107520
    s_nop 0
    buffer_load_dwordx4 v6, s[28:31], s45 offen lds
    s_add_u32 s46, s46, 128
    s_cmp_eq_u32 s46, 1280
    s_cselect_b32 s46, 0, s46
    s_add_u32 m0, s43, 16384
    s_nop 0
    buffer_load_dwordx4 v4, s[20:23], s46 offen lds
    s_add_u32 m0, s43, 17408
    s_nop 0
    buffer_load_dwordx4 v5, s[20:23], s46 offen lds
    s_waitcnt vmcnt(6)
    s_barrier
    s_add_u32 s45, s46, 20480
    s_add_u32 m0, s43, 18432
    s_nop 0
    buffer_load_dwordx4 v4, s[20:23], s45 offen lds
    s_add_u32 m0, s43, 19456
    s_nop 0
    buffer_load_dwordx4 v5, s[20:23], s45 offen lds
    s_add_u32 s47, s47, 98304
    s_cmp_eq_u32 s47, 1966080
    s_cselect_b32 s47, 0, s47
    s_add_u32 m0, s44, 114688
    s_nop 0
    buffer_load_dwordx4 v6, s[24:27], s47 offen lds
    s_add_u32 m0, s44, 122880
    s_nop 0
    buffer_load_dwordx4 v6, s[28:31], s47 offen lds
    s_add_u32 s45, s47, 12288
    s_add_u32 m0, s44, 115712
    s_nop 0
    buffer_load_dwordx4 v6, s[24:27], s45 offen lds
    s_add_u32 m0, s44, 123904
    s_nop 0
    buffer_load_dwordx4 v6, s[28:31], s45 offen lds
    s_waitcnt vmcnt(8)
    s_barrier
    s_add_u32 s47, s47, 98304
    s_add_u32 m0, s44, 131072
    s_nop 0
    buffer_load_dwordx4 v6, s[24:27], s47 offen lds
    s_add_u32 m0, s44, 139264
    s_nop 0
    buffer_load_dwordx4 v6, s[28:31], s47 offen lds
    s_add_u32 s45, s47, 12288
    s_add_u32 m0, s44, 132096
    s_nop 0
    buffer_load_dwordx4 v6, s[24:27], s45 offen lds
    s_add_u32 m0, s44, 140288
    s_nop 0
    buffer_load_dwordx4 v6, s[28:31], s45 offen lds
    s_lshr_b32 s42, s54, 1
    s_lshl_b32 s40, s42, 10
    s_add_u32 s40, s40, 3473408
    s_lshr_b32 s63, s55, 1
    s_lshl_b32 s63, s63, 8
    s_add_u32 s63, s63, s40
    s_lshl_b32 s40, s16, 10
    s_add_u32 s40, s40, 3473408
    s_lshl_b32 s56, s17, 2
    s_add_u32 s56, s56, s60
    s_lshl_b32 s56, s56, 2
    s_add_u32 s56, s56, s40
    s_mul_i32 s48, s17, 3
    s_add_u32 s48, s48, s60
    s_lshl_b32 s48, s48, 3
    s_mul_i32 s41, s16, 384
    s_add_u32 s48, s48, s41
    s_bfe_u32 s41, s18, 0x10001
    s_mul_i32 s41, s41, 192
    s_add_u32 s48, s48, s41
    s_and_b32 s41, s18, 1
    s_lshl_b32 s41, s41, 2
    s_add_u32 s48, s48, s41
    s_lshl_b32 s48, s48, 10
    s_add_u32 s48, s48, 4194304
    s_cmp_eq_u32 s60, 3
    s_cselect_b32 s48, 0, s48
    s_lshl_b32 s41, s55, 2
    s_lshr_b32 s47, 0x88c46222, s41
    s_and_b32 s47, s47, 15
    s_lshl_b32 s47, s47, 16
    s_bitset1_b32 s47, s42
    s_sub_u32 s60, s18, 8
    s_and_b32 s61, s60, 1
    s_lshr_b32 s62, s60, 1
    s_lshl_b32 s46, s54, 1
    s_add_u32 s46, s46, s61
    v_lshlrev_b32 v38, 4, v1
    v_lshlrev_b32 v39, 2, v1
    s_mov_b32 s32, s14
    s_mov_b32 s33, s15
    s_mov_b32 s34, 16777216
    s_mov_b32 s35, 0x00020000
    s_waitcnt vmcnt(4)
    s_barrier
G_common:
    s_lshl_b32 s41, s54, 6
    s_lshl_b32 s42, s55, 2
    s_add_u32 s41, s41, s42
    s_lshl_b32 s42, s62, 5
    s_add_u32 s41, s41, s42
    s_lshl_b32 s42, s61, 1
    s_add_u32 s41, s41, s42
    s_mul_i32 s57, s41, 1280
    s_lshl_b32 s58, s54, 8
    s_add_u32 s58, s58, 3407872
    v_add_u32 v12, 0, v1
    v_mul_u32_u24 v13, 205, v12
    v_lshrrev_b32 v13, 11, v13
    v_mul_u32_u24 v14, 10, v13
    v_sub_u32 v14, v12, v14
    v_mul_u32_u24 v13, 1280, v13
    v_lshl_add_u32 v4, v14, 4, v13
    v_add_u32 v12, 64, v1
    v_mul_u32_u24 v13, 205, v12
    v_lshrrev_b32 v13, 11, v13
    v_mul_u32_u24 v14, 10, v13
    v_sub_u32 v14, v12, v14
    v_mul_u32_u24 v13, 1280, v13
    v_lshl_add_u32 v5, v14, 4, v13
    v_add_u32 v12, 128, v1
    v_mul_u32_u24 v13, 205, v12
    v_lshrrev_b32 v13, 11, v13
    v_mul_u32_u24 v14, 10, v13
    v_sub_u32 v14, v12, v14
    v_mul_u32_u24 v13, 1280, v13
    v_lshl_add_u32 v6, v14, 4, v13
    v_add_u32 v12, 192, v1
    v_mul_u32_u24 v13, 205, v12
    v_lshrrev_b32 v13, 11, v13
    v_mul_u32_u24 v14, 10, v13
    v_sub_u32 v14, v12, v14
    v_mul_u32_u24 v13, 1280, v13
    v_lshl_add_u32 v7, v14, 4, v13
    v_add_u32 v12, 256, v1
    v_mul_u32_u24 v13, 205, v12
    v_lshrrev_b32 v13, 11, v13
    v_mul_u32_u24 v14, 10, v13
    v_sub_u32 v14, v12, v14
    v_mul_u32_u24 v13, 1280, v13
    v_lshl_add_u32 v8, v14, 4, v13
    s_mul_i32 s40, s61, 98304
    s_sub_u32 s41, 98304, s40
    v_add_u32 v2, s40, v38
    v_add_u32 v3, s41, v38
    v_lshrrev_b32 v12, 5, v1
    v_bfe_u32 v13, v1, 2, 2
    v_lshl_add_u32 v12, v12, 2, v13
    v_mul_u32_u24 v12, 160, v12
    v_bfe_u32 v13, v1, 4, 1
    v_lshl_add_u32 v12, v13, 5, v12
    v_and_b32 v13, 3, v1
    v_lshl_add_u32 v12, v13, 3, v12
    s_mul_i32 s44, s60, 25600
    s_add_u32 s44, s44, 28672
    v_add_u32 v9, s44, v12
    s_mul_i32 s40, s60, 2560
    s_add_u32 s40, s40, 151808
    v_and_b32 v12, 0x2f0, v38
    v_bfe_u32 v13, v1, 4, 1
    v_lshl_add_u32 v12, v13, 3, v12
    v_add_u32 v40, s40, v12
    v_mul_u32_u24 v13, 1280, v13
    v_and_b32 v12, 15, v1
    v_lshl_add_u32 v37, v12, 4, v13
    v_lshl_add_u32 v12, v12, 3, v13
    v_add_u32 v42, s40, v12
    v_add_u32 v43, s44, v38
    v_add_u32 v41, 162048, v39
    s_lshl_b32 s40, s61, 7
    v_and_b32 v12, 127, v39
    v_add_u32 v12, s40, v12
    v_lshlrev_b32 v13, 8, v1
    s_mul_i32 s40, s55, 160
    s_mul_i32 s41, s60, 491520
    s_add_u32 s41, s41, s40
    s_sub_u32 s42, 1966080, s41
    s_add_u32 s20, s12, s41
    s_addc_u32 s21, s13, 0
    s_mov_b32 s22, s42
    s_mov_b32 s23, 0x00020000
    s_mul_i32 s41, s60, 204800
    s_add_u32 s41, s41, s40
    s_sub_u32 s42, 819200, s41
    s_add_u32 s24, s6, s41
    s_addc_u32 s25, s7, 0
    s_mov_b32 s26, s42
    s_mov_b32 s27, 0x00020000
    s_mul_i32 s41, s46, 40960
    s_add_u32 s41, s41, s40
    s_sub_u32 s42, 2621440, s41
    s_add_u32 s28, s8, s41
    s_addc_u32 s29, s9, 0
    s_mov_b32 s30, s42
    s_mov_b32 s31, 0x00020000
    s_mul_i32 s43, s54, 192
    s_mul_i32 s40, s60, 24
    s_add_u32 s43, s43, s40
    s_lshl_b32 s43, s43, 10
    s_add_u32 s43, s43, 4194304
    s_mul_i32 s50, s46, 40
    s_mul_i32 s40, s62, 20
    s_add_u32 s50, s50, s40
    s_lshl_b32 s50, s50, 10
    s_add_u32 s50, s50, 0
    s_add_u32 s51, s50, 5120
    s_add_u32 s52, s50, 10240
    s_add_u32 s53, s50, 15360
    v_mov_b32 v14, 151608
    s_waitcnt vmcnt(0)
    s_barrier
    s_cmp_lg_u32 s60, 0
    s_cbranch_scc1 G_rdy
    s_or_b32 s41, s47, 0xffff
    s_mov_b32 s59, 131072
    buffer_load_dword v45, v39, s[32:35], s63 offen sc1
    s_sleep 3
    buffer_load_dword v46, v39, s[32:35], s63 offen sc1
    s_sleep 3
G_poll:
    buffer_load_dword v44, v39, s[32:35], s63 offen sc1
    s_waitcnt vmcnt(2)
    v_cmp_eq_u32 vcc, 1, v45
    s_nop 1
    v_mov_b32 v11, vcc_lo
    ds_write_b32 v14, v11
    s_andn2_b32 s40, s41, vcc_lo
    s_cmp_eq_u32 s40, 0
    s_cbranch_scc1 G_poll_out
    s_sleep 3
    buffer_load_dword v45, v39, s[32:35], s63 offen sc1
    s_waitcnt vmcnt(2)
    v_cmp_eq_u32 vcc, 1, v46
    s_nop 1
    v_mov_b32 v11, vcc_lo
    ds_write_b32 v14, v11
    s_andn2_b32 s40, s41, vcc_lo
    s_cmp_eq_u32 s40, 0
    s_cbranch_scc1 G_poll_out
    s_sleep 3
    buffer_load_dword v46, v39, s[32:35], s63 offen sc1
    s_waitcnt vmcnt(2)
    v_cmp_eq_u32 vcc, 1, v44
    s_nop 1
    v_mov_b32 v11, vcc_lo
    ds_write_b32 v14, v11
    s_andn2_b32 s40, s41, vcc_lo
    s_cmp_eq_u32 s40, 0
    s_cbranch_scc1 G_poll_out
    s_sleep 3
    s_sub_u32 s59, s59, 1
    s_cbranch_scc0 G_poll
G_poll_out:
    v_mov_b32 v11, -1
    ds_write_b32 v14, v11
    s_branch G_go
G_rdy:
    v_mov_b32 v0, 151608
    ds_read_b32 v0, v0
    s_sleep 1
    s_waitcnt lgkmcnt(0)
    v_readfirstlane_b32 s49, v0
    s_andn2_b32 s49, s47, s49
    s_cbranch_scc1 G_rdy
G_go:
    buffer_load_dwordx4 v[24:27], v38, s[32:35], s57 offen sc1
    buffer_load_dwordx4 v[28:31], v38, s[32:35], s57 offen offset:1280 sc1
    s_mov_b32 exec_hi, 0
    buffer_load_dwordx4 v[32:35], v37, s[32:35], s57 offen offset:1024 sc1
    s_mov_b32 exec_hi, -1
    buffer_load_dword v36, v39, s[32:35], s58 offen sc1
    buffer_load_dword v10, v12, s[32:35], s58 offen sc1
    v_mov_b32 v11, 1
    v_mov_b32 v14, 151620
    s_waitcnt vmcnt(4)
    ds_write2_b64 v40, v[24:25], v[26:27] offset0:0 offset1:32
    s_waitcnt vmcnt(3)
    ds_write2_b64 v40, v[28:29], v[30:31] offset0:160 offset1:192
    s_mov_b32 exec_hi, 0
    s_waitcnt vmcnt(2)
    ds_write2_b64 v42, v[32:33], v[34:35] offset0:128 offset1:144
    s_mov_b32 exec_lo, 1
    ds_add_u32 v14, v11
    s_mov_b64 exec, -1
    s_waitcnt vmcnt(0)
    ds_write_b32 v41, v36
    s_cmp_eq_u32 s48, 0
    s_waitcnt lgkmcnt(0)
    s_barrier
    s_cbranch_scc1 G_nohs
    ds_read_b128 v[72:75], v43 offset:5120
    ds_read_b128 v[76:79], v43 offset:6144
    ds_read_b128 v[80:83], v43 offset:7168
    ds_read_b128 v[84:87], v43 offset:8192
    ds_read_b128 v[88:91], v43 offset:9216
    ds_read_b128 v[92:95], v43 offset:10240
    ds_read_b128 v[96:99], v43 offset:11264
    ds_read_b128 v[100:103], v43 offset:12288
    s_add_u32 s40, s48, 98304
    s_waitcnt lgkmcnt(7)
    buffer_store_dwordx4 v[72:75], v38, s[32:35], s48 offen offset:0 sc1
    s_waitcnt lgkmcnt(6)
    buffer_store_dwordx4 v[76:79], v38, s[32:35], s48 offen offset:1024 sc1
    s_waitcnt lgkmcnt(5)
    buffer_store_dwordx4 v[80:83], v38, s[32:35], s48 offen offset:2048 sc1
    s_waitcnt lgkmcnt(4)
    buffer_store_dwordx4 v[84:87], v38, s[32:35], s48 offen offset:3072 sc1
    s_waitcnt lgkmcnt(3)
    buffer_store_dwordx4 v[88:91], v38, s[32:35], s40 offen offset:0 sc1
    s_waitcnt lgkmcnt(2)
    buffer_store_dwordx4 v[92:95], v38, s[32:35], s40 offen offset:1024 sc1
    s_waitcnt lgkmcnt(1)
    buffer_store_dwordx4 v[96:99], v38, s[32:35], s40 offen offset:2048 sc1
    s_waitcnt lgkmcnt(0)
    buffer_store_dwordx4 v[100:103], v38, s[32:35], s40 offen offset:3072 sc1
G_nohs:
    s_mov_b32 s45, 0
    s_add_u32 m0, s44, 15360
    s_nop 0
    buffer_load_dwordx4 v4, s[20:23], s45 offen lds
    s_add_u32 m0, s44, 16384
    s_nop 0
    buffer_load_dwordx4 v5, s[20:23], s45 offen lds
    s_add_u32 m0, s44, 17408
    s_nop 0
    buffer_load_dwordx4 v6, s[20:23], s45 offen lds
    s_add_u32 m0, s44, 18432
    s_nop 0
    buffer_load_dwordx4 v7, s[20:23], s45 offen lds
    s_add_u32 m0, s44, 19456
    s_nop 0
    buffer_load_dwordx4 v8, s[20:23], s45 offen lds
    s_mov_b32 s45, 40960
    s_add_u32 m0, s44, 20480
    s_nop 0
    buffer_load_dwordx4 v4, s[20:23], s45 offen lds
    s_add_u32 m0, s44, 21504
    s_nop 0
    buffer_load_dwordx4 v5, s[20:23], s45 offen lds
    s_add_u32 m0, s44, 22528
    s_nop 0
    buffer_load_dwordx4 v6, s[20:23], s45 offen lds
    s_add_u32 m0, s44, 23552
    s_nop 0
    buffer_load_dwordx4 v7, s[20:23], s45 offen lds
    s_add_u32 m0, s44, 24576
    s_nop 0
    buffer_load_dwordx4 v8, s[20:23], s45 offen lds
    s_waitcnt vmcnt(10)
    s_mov_b64 exec, 1
    ds_add_rtn_u32 v0, v14, v11 offset:4
    s_mov_b64 exec, 15
    s_waitcnt lgkmcnt(0)
    v_readfirstlane_b32 s49, v0
    s_cmp_lg_u32 s49, 3
    s_cbranch_scc1 G_nofl
    buffer_store_dword v11, v13, s[32:35], s56 offen offset:192 sc1
G_nofl:
    s_mov_b64 exec, -1
    s_cmp_lg_u32 s60, 0
    s_cbranch_scc1 G_hrd
    s_mov_b32 s59, 131072
    buffer_load_dword v45, v39, s[32:35], s63 offen sc1
    s_sleep 3
    buffer_load_dword v46, v39, s[32:35], s63 offen sc1
    s_sleep 3
G_hp:
    buffer_load_dword v44, v39, s[32:35], s63 offen sc1
    s_waitcnt vmcnt(2)
    v_cmp_eq_u32 vcc, 1, v45
    s_lshr_b32 s40, vcc_hi, 16
    s_cmp_eq_u32 s40, 0xffff
    s_cbranch_scc1 G_hp_out
    s_sleep 3
    buffer_load_dword v45, v39, s[32:35], s63 offen sc1
    s_waitcnt vmcnt(2)
    v_cmp_eq_u32 vcc, 1, v46
    s_lshr_b32 s40, vcc_hi, 16
    s_cmp_eq_u32 s40, 0xffff
    s_cbranch_scc1 G_hp_out
    s_sleep 3
    buffer_load_dword v46, v39, s[32:35], s63 offen sc1
    s_waitcnt vmcnt(2)
    v_cmp_eq_u32 vcc, 1, v44
    s_lshr_b32 s40, vcc_hi, 16
    s_cmp_eq_u32 s40, 0xffff
    s_cbranch_scc1 G_hp_out
    s_sleep 3
    s_sub_u32 s59, s59, 1
    s_cbranch_scc0 G_hp
G_hp_out:
    v_mov_b32 v0, 151612
    v_mov_b32 v11, 1
    ds_write_b32 v0, v11
    s_branch G_hgo
G_hrd:
    v_mov_b32 v0, 151612
    ds_read_b32 v0, v0
    s_sleep 2
    s_waitcnt lgkmcnt(0)
    v_readfirstlane_b32 s49, v0
    s_cmp_lt_u32 s49, 1
    s_cbranch_scc1 G_hrd
G_hgo:
    buffer_load_dwordx4 v[24:27], v2, s[32:35], s43 offen offset:0 sc1
    buffer_load_dwordx4 v[28:31], v3, s[32:35], s43 offen offset:0 sc1
    buffer_load_dwordx4 v[32:35], v2, s[32:35], s43 offen offset:1024 sc1
    buffer_load_dwordx4 v[36:39], v3, s[32:35], s43 offen offset:1024 sc1
    buffer_load_dwordx4 v[40:43], v2, s[32:35], s43 offen offset:2048 sc1
    buffer_load_dwordx4 v[44:47], v3, s[32:35], s43 offen offset:2048 sc1
    buffer_load_dwordx4 v[48:51], v2, s[32:35], s43 offen offset:3072 sc1
    buffer_load_dwordx4 v[52:55], v3, s[32:35], s43 offen offset:3072 sc1
    s_mov_b32 s45, 81920
    s_add_u32 m0, s44, 0
    s_nop 0
    buffer_load_dwordx4 v4, s[20:23], s45 offen lds
    s_add_u32 m0, s44, 1024
    s_nop 0
    buffer_load_dwordx4 v5, s[20:23], s45 offen lds
    s_add_u32 m0, s44, 2048
    s_nop 0
    buffer_load_dwordx4 v6, s[20:23], s45 offen lds
    s_add_u32 m0, s44, 3072
    s_nop 0
    buffer_load_dwordx4 v7, s[20:23], s45 offen lds
    s_add_u32 m0, s44, 4096
    s_nop 0
    buffer_load_dwordx4 v8, s[20:23], s45 offen lds
    s_add_u32 s43, s43, 4096
    buffer_load_dwordx4 v[56:59], v2, s[32:35], s43 offen offset:0 sc1
    buffer_load_dwordx4 v[60:63], v3, s[32:35], s43 offen offset:0 sc1
    buffer_load_dwordx4 v[64:67], v2, s[32:35], s43 offen offset:1024 sc1
    buffer_load_dwordx4 v[68:71], v3, s[32:35], s43 offen offset:1024 sc1
    s_mov_b32 s45, 122880
    s_add_u32 m0, s44, 5120
    s_nop 0
    buffer_load_dwordx4 v4, s[20:23], s45 offen lds
    s_add_u32 m0, s44, 6144
    s_nop 0
    buffer_load_dwordx4 v5, s[20:23], s45 offen lds
    s_add_u32 m0, s44, 7168
    s_nop 0
    buffer_load_dwordx4 v6, s[20:23], s45 offen lds
    s_add_u32 m0, s44, 8192
    s_nop 0
    buffer_load_dwordx4 v7, s[20:23], s45 offen lds
    s_add_u32 m0, s44, 9216
    s_nop 0
    buffer_load_dwordx4 v8, s[20:23], s45 offen lds
    s_mov_b32 s45, 163840
    s_add_u32 m0, s44, 10240
    s_nop 0
    buffer_load_dwordx4 v4, s[20:23], s45 offen lds
    s_add_u32 m0, s44, 11264
    s_nop 0
    buffer_load_dwordx4 v5, s[20:23], s45 offen lds
    s_add_u32 m0, s44, 12288
    s_nop 0
    buffer_load_dwordx4 v6, s[20:23], s45 offen lds
    s_add_u32 m0, s44, 13312
    s_nop 0
    buffer_load_dwordx4 v7, s[20:23], s45 offen lds
    s_add_u32 m0, s44, 14336
    s_nop 0
    buffer_load_dwordx4 v8, s[20:23], s45 offen lds
    s_waitcnt vmcnt(32)
    ds_read_b64_tr_b16 v[12:13], v9 offset:15360
    ds_read_b64_tr_b16 v[14:15], v9 offset:17920
    ds_read_b64_tr_b16 v[16:17], v9 offset:15424
    ds_read_b64_tr_b16 v[18:19], v9 offset:17984
    ds_read_b64_tr_b16 v[20:21], v9 offset:15488
    ds_read_b64_tr_b16 v[22:23], v9 offset:18048
    s_waitcnt vmcnt(25)
    s_waitcnt lgkmcnt(4)
    v_mfma_f32_32x32x16_bf16 v[120:135], v[12:15], v[24:27], 0
    v_mfma_f32_32x32x16_bf16 v[72:87], v[12:15], v[28:31], 0
    ds_read_b64_tr_b16 v[12:13], v9 offset:16640
    ds_read_b64_tr_b16 v[14:15], v9 offset:19200
    s_waitcnt lgkmcnt(4)
    v_mfma_f32_32x32x16_bf16 v[136:151], v[16:19], v[24:27], 0
    v_mfma_f32_32x32x16_bf16 v[88:103], v[16:19], v[28:31], 0
    ds_read_b64_tr_b16 v[16:17], v9 offset:16704
    ds_read_b64_tr_b16 v[18:19], v9 offset:19264
    s_waitcnt lgkmcnt(4)
    v_mfma_f32_32x32x16_bf16 v[152:167], v[20:23], v[24:27], 0
    v_mfma_f32_32x32x16_bf16 v[104:119], v[20:23], v[28:31], 0
    ds_read_b64_tr_b16 v[20:21], v9 offset:16768
    ds_read_b64_tr_b16 v[22:23], v9 offset:19328
    buffer_load_dwordx4 v[24:27], v2, s[32:35], s43 offen offset:2048 sc1
    buffer_load_dwordx4 v[28:31], v3, s[32:35], s43 offen offset:2048 sc1
    s_waitcnt vmcnt(25)
    s_waitcnt vmcnt(29)
    s_waitcnt lgkmcnt(4)
    v_mfma_f32_32x32x16_bf16 v[120:135], v[12:15], v[32:35], v[120:135]
    v_mfma_f32_32x32x16_bf16 v[72:87], v[12:15], v[36:39], v[72:87]
    ds_read_b64_tr_b16 v[12:13], v9 offset:20480
    ds_read_b64_tr_b16 v[14:15], v9 offset:23040
    s_waitcnt lgkmcnt(4)
    v_mfma_f32_32x32x16_bf16 v[136:151], v[16:19], v[32:35], v[136:151]
    v_mfma_f32_32x32x16_bf16 v[88:103], v[16:19], v[36:39], v[88:103]
    ds_read_b64_tr_b16 v[16:17], v9 offset:20544
    ds_read_b64_tr_b16 v[18:19], v9 offset:23104
    s_waitcnt lgkmcnt(4)
    v_mfma_f32_32x32x16_bf16 v[152:167], v[20:23], v[32:35], v[152:167]
    v_mfma_f32_32x32x16_bf16 v[104:119], v[20:23], v[36:39], v[104:119]
    ds_read_b64_tr_b16 v[20:21], v9 offset:20608
    ds_read_b64_tr_b16 v[22:23], v9 offset:23168
    s_mov_b32 s45, 204800
    s_add_u32 m0, s44, 15360
    s_nop 0
    buffer_load_dwordx4 v4, s[20:23], s45 offen lds
    s_add_u32 m0, s44, 16384
    s_nop 0
    buffer_load_dwordx4 v5, s[20:23], s45 offen lds
    s_add_u32 m0, s44, 17408
    s_nop 0
    buffer_load_dwordx4 v6, s[20:23], s45 offen lds
    s_add_u32 m0, s44, 18432
    s_nop 0
    buffer_load_dwordx4 v7, s[20:23], s45 offen lds
    s_add_u32 m0, s44, 19456
    s_nop 0
    buffer_load_dwordx4 v8, s[20:23], s45 offen lds
    buffer_load_dwordx4 v[32:35], v2, s[32:35], s43 offen offset:3072 sc1
    buffer_load_dwordx4 v[36:39], v3, s[32:35], s43 offen offset:3072 sc1
    s_waitcnt vmcnt(30)
    s_waitcnt lgkmcnt(4)
    v_mfma_f32_32x32x16_bf16 v[120:135], v[12:15], v[40:43], v[120:135]
    v_mfma_f32_32x32x16_bf16 v[72:87], v[12:15], v[44:47], v[72:87]
    ds_read_b64_tr_b16 v[12:13], v9 offset:21760
    ds_read_b64_tr_b16 v[14:15], v9 offset:24320
    s_waitcnt lgkmcnt(4)
    v_mfma_f32_32x32x16_bf16 v[136:151], v[16:19], v[40:43], v[136:151]
    v_mfma_f32_32x32x16_bf16 v[88:103], v[16:19], v[44:47], v[88:103]
    ds_read_b64_tr_b16 v[16:17], v9 offset:21824
    ds_read_b64_tr_b16 v[18:19], v9 offset:24384
    s_waitcnt lgkmcnt(4)
    v_mfma_f32_32x32x16_bf16 v[152:167], v[20:23], v[40:43], v[152:167]
    v_mfma_f32_32x32x16_bf16 v[104:119], v[20:23], v[44:47], v[104:119]
    ds_read_b64_tr_b16 v[20:21], v9 offset:21888
    ds_read_b64_tr_b16 v[22:23], v9 offset:24448
    s_add_u32 s43, s43, 4096
    buffer_load_dwordx4 v[40:43], v2, s[32:35], s43 offen offset:0 sc1
    buffer_load_dwordx4 v[44:47], v3, s[32:35], s43 offen offset:0 sc1
    s_waitcnt vmcnt(30)
    s_waitcnt vmcnt(25)
    s_waitcnt lgkmcnt(4)
    v_mfma_f32_32x32x16_bf16 v[120:135], v[12:15], v[48:51], v[120:135]
    v_mfma_f32_32x32x16_bf16 v[72:87], v[12:15], v[52:55], v[72:87]
    ds_read_b64_tr_b16 v[12:13], v9 offset:0
    ds_read_b64_tr_b16 v[14:15], v9 offset:2560
    s_waitcnt lgkmcnt(4)
    v_mfma_f32_32x32x16_bf16 v[136:151], v[16:19], v[48:51], v[136:151]
    v_mfma_f32_32x32x16_bf16 v[88:103], v[16:19], v[52:55], v[88:103]
    ds_read_b64_tr_b16 v[16:17], v9 offset:64
    ds_read_b64_tr_b16 v[18:19], v9 offset:2624
    s_waitcnt lgkmcnt(4)
    v_mfma_f32_32x32x16_bf16 v[152:167], v[20:23], v[48:51], v[152:167]
    v_mfma_f32_32x32x16_bf16 v[104:119], v[20:23], v[52:55], v[104:119]
    ds_read_b64_tr_b16 v[20:21], v9 offset:128
    ds_read_b64_tr_b16 v[22:23], v9 offset:2688
    s_mov_b32 s45, 245760
    s_add_u32 m0, s44, 20480
    s_nop 0
    buffer_load_dwordx4 v4, s[20:23], s45 offen lds
    s_add_u32 m0, s44, 21504
    s_nop 0
    buffer_load_dwordx4 v5, s[20:23], s45 offen lds
    s_add_u32 m0, s44, 22528
    s_nop 0
    buffer_load_dwordx4 v6, s[20:23], s45 offen lds
    s_add_u32 m0, s44, 23552
    s_nop 0
    buffer_load_dwordx4 v7, s[20:23], s45 offen lds
    s_add_u32 m0, s44, 24576
    s_nop 0
    buffer_load_dwordx4 v8, s[20:23], s45 offen lds
    buffer_load_dwordx4 v[48:51], v2, s[32:35], s43 offen offset:1024 sc1
    buffer_load_dwordx4 v[52:55], v3, s[32:35], s43 offen offset:1024 sc1
    s_waitcnt vmcnt(30)
    s_waitcnt lgkmcnt(4)
    v_mfma_f32_32x32x16_bf16 v[120:135], v[12:15], v[56:59], v[120:135]
    v_mfma_f32_32x32x16_bf16 v[72:87], v[12:15], v[60:63], v[72:87]
    ds_read_b64_tr_b16 v[12:13], v9 offset:1280
    ds_read_b64_tr_b16 v[14:15], v9 offset:3840
    s_waitcnt lgkmcnt(4)
    v_mfma_f32_32x32x16_bf16 v[136:151], v[16:19], v[56:59], v[136:151]
    v_mfma_f32_32x32x16_bf16 v[88:103], v[16:19], v[60:63], v[88:103]
    ds_read_b64_tr_b16 v[16:17], v9 offset:1344
    ds_read_b64_tr_b16 v[18:19], v9 offset:3904
    s_waitcnt lgkmcnt(4)
    v_mfma_f32_32x32x16_bf16 v[152:167], v[20:23], v[56:59], v[152:167]
    v_mfma_f32_32x32x16_bf16 v[104:119], v[20:23], v[60:63], v[104:119]
    ds_read_b64_tr_b16 v[20:21], v9 offset:1408
    ds_read_b64_tr_b16 v[22:23], v9 offset:3968
    buffer_load_dwordx4 v[56:59], v2, s[32:35], s43 offen offset:2048 sc1
    buffer_load_dwordx4 v[60:63], v3, s[32:35], s43 offen offset:2048 sc1
    s_waitcnt vmcnt(30)
    s_waitcnt vmcnt(25)
    s_waitcnt lgkmcnt(4)
    v_mfma_f32_32x32x16_bf16 v[120:135], v[12:15], v[64:67], v[120:135]
    v_mfma_f32_32x32x16_bf16 v[72:87], v[12:15], v[68:71], v[72:87]
    ds_read_b64_tr_b16 v[12:13], v9 offset:5120
    ds_read_b64_tr_b16 v[14:15], v9 offset:7680
    s_waitcnt lgkmcnt(4)
    v_mfma_f32_32x32x16_bf16 v[136:151], v[16:19], v[64:67], v[136:151]
    v_mfma_f32_32x32x16_bf16 v[88:103], v[16:19], v[68:71], v[88:103]
    ds_read_b64_tr_b16 v[16:17], v9 offset:5184
    ds_read_b64_tr_b16 v[18:19], v9 offset:7744
    s_waitcnt lgkmcnt(4)
    v_mfma_f32_32x32x16_bf16 v[152:167], v[20:23], v[64:67], v[152:167]
    v_mfma_f32_32x32x16_bf16 v[104:119], v[20:23], v[68:71], v[104:119]
    ds_read_b64_tr_b16 v[20:21], v9 offset:5248
    ds_read_b64_tr_b16 v[22:23], v9 offset:7808
    s_mov_b32 s45, 286720
    s_add_u32 m0, s44, 0
    s_nop 0
    buffer_load_dwordx4 v4, s[20:23], s45 offen lds
    s_add_u32 m0, s44, 1024
    s_nop 0
    buffer_load_dwordx4 v5, s[20:23], s45 offen lds
    s_add_u32 m0, s44, 2048
    s_nop 0
    buffer_load_dwordx4 v6, s[20:23], s45 offen lds
    s_add_u32 m0, s44, 3072
    s_nop 0
    buffer_load_dwordx4 v7, s[20:23], s45 offen lds
    s_add_u32 m0, s44, 4096
    s_nop 0
    buffer_load_dwordx4 v8, s[20:23], s45 offen lds
    buffer_load_dwordx4 v[64:67], v2, s[32:35], s43 offen offset:3072 sc1
    buffer_load_dwordx4 v[68:71], v3, s[32:35], s43 offen offset:3072 sc1
    s_waitcnt vmcnt(25)
    s_waitcnt lgkmcnt(4)
    v_mfma_f32_32x32x16_bf16 v[120:135], v[12:15], v[24:27], v[120:135]
    v_mfma_f32_32x32x16_bf16 v[72:87], v[12:15], v[28:31], v[72:87]
    ds_read_b64_tr_b16 v[12:13], v9 offset:6400
    ds_read_b64_tr_b16 v[14:15], v9 offset:8960
    s_waitcnt lgkmcnt(4)
    v_mfma_f32_32x32x16_bf16 v[136:151], v[16:19], v[24:27], v[136:151]
    v_mfma_f32_32x32x16_bf16 v[88:103], v[16:19], v[28:31], v[88:103]
    ds_read_b64_tr_b16 v[16:17], v9 offset:6464
    ds_read_b64_tr_b16 v[18:19], v9 offset:9024
    s_waitcnt lgkmcnt(4)
    v_mfma_f32_32x32x16_bf16 v[152:167], v[20:23], v[24:27], v[152:167]
    v_mfma_f32_32x32x16_bf16 v[104:119], v[20:23], v[28:31], v[104:119]
    ds_read_b64_tr_b16 v[20:21], v9 offset:6528
    ds_read_b64_tr_b16 v[22:23], v9 offset:9088
    s_add_u32 s43, s43, 4096
    buffer_load_dwordx4 v[24:27], v2, s[32:35], s43 offen offset:0 sc1
    buffer_load_dwordx4 v[28:31], v3, s[32:35], s43 offen offset:0 sc1
    s_waitcnt vmcnt(20)
    s_waitcnt vmcnt(29)
    s_waitcnt lgkmcnt(4)
    v_mfma_f32_32x32x16_bf16 v[120:135], v[12:15], v[32:35], v[120:135]
    v_mfma_f32_32x32x16_bf16 v[72:87], v[12:15], v[36:39], v[72:87]
    ds_read_b64_tr_b16 v[12:13], v9 offset:10240
    ds_read_b64_tr_b16 v[14:15], v9 offset:12800
    s_waitcnt lgkmcnt(4)
    v_mfma_f32_32x32x16_bf16 v[136:151], v[16:19], v[32:35], v[136:151]
    v_mfma_f32_32x32x16_bf16 v[88:103], v[16:19], v[36:39], v[88:103]
    ds_read_b64_tr_b16 v[16:17], v9 offset:10304
    ds_read_b64_tr_b16 v[18:19], v9 offset:12864
    s_waitcnt lgkmcnt(4)
    v_mfma_f32_32x32x16_bf16 v[152:167], v[20:23], v[32:35], v[152:167]
    v_mfma_f32_32x32x16_bf16 v[104:119], v[20:23], v[36:39], v[104:119]
    ds_read_b64_tr_b16 v[20:21], v9 offset:10368
    ds_read_b64_tr_b16 v[22:23], v9 offset:12928
    s_mov_b32 s45, 327680
    s_add_u32 m0, s44, 5120
    s_nop 0
    buffer_load_dwordx4 v4, s[20:23], s45 offen lds
    s_add_u32 m0, s44, 6144
    s_nop 0
    buffer_load_dwordx4 v5, s[20:23], s45 offen lds
    s_add_u32 m0, s44, 7168
    s_nop 0
    buffer_load_dwordx4 v6, s[20:23], s45 offen lds
    s_add_u32 m0, s44, 8192
    s_nop 0
    buffer_load_dwordx4 v7, s[20:23], s45 offen lds
    s_add_u32 m0, s44, 9216
    s_nop 0
    buffer_load_dwordx4 v8, s[20:23], s45 offen lds
    buffer_load_dwordx4 v[32:35], v2, s[32:35], s43 offen offset:1024 sc1
    buffer_load_dwordx4 v[36:39], v3, s[32:35], s43 offen offset:1024 sc1
    s_waitcnt vmcnt(25)
    s_waitcnt lgkmcnt(4)
    v_mfma_f32_32x32x16_bf16 v[120:135], v[12:15], v[40:43], v[120:135]
    v_mfma_f32_32x32x16_bf16 v[72:87], v[12:15], v[44:47], v[72:87]
    ds_read_b64_tr_b16 v[12:13], v9 offset:11520
    ds_read_b64_tr_b16 v[14:15], v9 offset:14080
    s_waitcnt lgkmcnt(4)
    v_mfma_f32_32x32x16_bf16 v[136:151], v[16:19], v[40:43], v[136:151]
    v_mfma_f32_32x32x16_bf16 v[88:103], v[16:19], v[44:47], v[88:103]
    ds_read_b64_tr_b16 v[16:17], v9 offset:11584
    ds_read_b64_tr_b16 v[18:19], v9 offset:14144
    s_waitcnt lgkmcnt(4)
    v_mfma_f32_32x32x16_bf16 v[152:167], v[20:23], v[40:43], v[152:167]
    v_mfma_f32_32x32x16_bf16 v[104:119], v[20:23], v[44:47], v[104:119]
    ds_read_b64_tr_b16 v[20:21], v9 offset:11648
    ds_read_b64_tr_b16 v[22:23], v9 offset:14208
    buffer_load_dwordx4 v[40:43], v2, s[32:35], s43 offen offset:2048 sc1
    buffer_load_dwordx4 v[44:47], v3, s[32:35], s43 offen offset:2048 sc1
    s_waitcnt vmcnt(20)
    s_waitcnt vmcnt(31)
    s_waitcnt lgkmcnt(4)
    v_mfma_f32_32x32x16_bf16 v[120:135], v[12:15], v[48:51], v[120:135]
    v_mfma_f32_32x32x16_bf16 v[72:87], v[12:15], v[52:55], v[72:87]
    ds_read_b64_tr_b16 v[12:13], v9 offset:15360
    ds_read_b64_tr_b16 v[14:15], v9 offset:17920
    s_waitcnt lgkmcnt(4)
    v_mfma_f32_32x32x16_bf16 v[136:151], v[16:19], v[48:51], v[136:151]
    v_mfma_f32_32x32x16_bf16 v[88:103], v[16:19], v[52:55], v[88:103]
    ds_read_b64_tr_b16 v[16:17], v9 offset:15424
    ds_read_b64_tr_b16 v[18:19], v9 offset:17984
    s_waitcnt lgkmcnt(4)
    v_mfma_f32_32x32x16_bf16 v[152:167], v[20:23], v[48:51], v[152:167]
    v_mfma_f32_32x32x16_bf16 v[104:119], v[20:23], v[52:55], v[104:119]
    ds_read_b64_tr_b16 v[20:21], v9 offset:15488
    ds_read_b64_tr_b16 v[22:23], v9 offset:18048
    s_mov_b32 s45, 368640
    s_add_u32 m0, s44, 10240
    s_nop 0
    buffer_load_dwordx4 v4, s[20:23], s45 offen lds
    s_add_u32 m0, s44, 11264
    s_nop 0
    buffer_load_dwordx4 v5, s[20:23], s45 offen lds
    s_add_u32 m0, s44, 12288
    s_nop 0
    buffer_load_dwordx4 v6, s[20:23], s45 offen lds
    s_add_u32 m0, s44, 13312
    s_nop 0
    buffer_load_dwordx4 v7, s[20:23], s45 offen lds
    s_add_u32 m0, s44, 14336
    s_nop 0
    buffer_load_dwordx4 v8, s[20:23], s45 offen lds
    buffer_load_dwordx4 v[48:51], v2, s[32:35], s43 offen offset:3072 sc1
    buffer_load_dwordx4 v[52:55], v3, s[32:35], s43 offen offset:3072 sc1
    s_waitcnt vmcnt(25)
    s_waitcnt lgkmcnt(4)
    v_mfma_f32_32x32x16_bf16 v[120:135], v[12:15], v[56:59], v[120:135]
    v_mfma_f32_32x32x16_bf16 v[72:87], v[12:15], v[60:63], v[72:87]
    ds_read_b64_tr_b16 v[12:13], v9 offset:16640
    ds_read_b64_tr_b16 v[14:15], v9 offset:19200
    s_waitcnt lgkmcnt(4)
    v_mfma_f32_32x32x16_bf16 v[136:151], v[16:19], v[56:59], v[136:151]
    v_mfma_f32_32x32x16_bf16 v[88:103], v[16:19], v[60:63], v[88:103]
    ds_read_b64_tr_b16 v[16:17], v9 offset:16704
    ds_read_b64_tr_b16 v[18:19], v9 offset:19264
    s_waitcnt lgkmcnt(4)
    v_mfma_f32_32x32x16_bf16 v[152:167], v[20:23], v[56:59], v[152:167]
    v_mfma_f32_32x32x16_bf16 v[104:119], v[20:23], v[60:63], v[104:119]
    ds_read_b64_tr_b16 v[20:21], v9 offset:16768
    ds_read_b64_tr_b16 v[22:23], v9 offset:19328
    s_add_u32 s43, s43, 4096
    buffer_load_dwordx4 v[56:59], v2, s[32:35], s43 offen offset:0 sc1
    buffer_load_dwordx4 v[60:63], v3, s[32:35], s43 offen offset:0 sc1
    s_waitcnt vmcnt(20)
    s_waitcnt vmcnt(31)
    s_waitcnt lgkmcnt(4)
    v_mfma_f32_32x32x16_bf16 v[120:135], v[12:15], v[64:67], v[120:135]
    v_mfma_f32_32x32x16_bf16 v[72:87], v[12:15], v[68:71], v[72:87]
    ds_read_b64_tr_b16 v[12:13], v9 offset:20480
    ds_read_b64_tr_b16 v[14:15], v9 offset:23040
    s_waitcnt lgkmcnt(4)
    v_mfma_f32_32x32x16_bf16 v[136:151], v[16:19], v[64:67], v[136:151]
    v_mfma_f32_32x32x16_bf16 v[88:103], v[16:19], v[68:71], v[88:103]
    ds_read_b64_tr_b16 v[16:17], v9 offset:20544
    ds_read_b64_tr_b16 v[18:19], v9 offset:23104
    s_waitcnt lgkmcnt(4)
    v_mfma_f32_32x32x16_bf16 v[152:167], v[20:23], v[64:67], v[152:167]
    v_mfma_f32_32x32x16_bf16 v[104:119], v[20:23], v[68:71], v[104:119]
    ds_read_b64_tr_b16 v[20:21], v9 offset:20608
    ds_read_b64_tr_b16 v[22:23], v9 offset:23168
    s_mov_b32 s45, 409600
    s_add_u32 m0, s44, 15360
    s_nop 0
    buffer_load_dwordx4 v4, s[20:23], s45 offen lds
    s_add_u32 m0, s44, 16384
    s_nop 0
    buffer_load_dwordx4 v5, s[20:23], s45 offen lds
    s_add_u32 m0, s44, 17408
    s_nop 0
    buffer_load_dwordx4 v6, s[20:23], s45 offen lds
    s_add_u32 m0, s44, 18432
    s_nop 0
    buffer_load_dwordx4 v7, s[20:23], s45 offen lds
    s_add_u32 m0, s44, 19456
    s_nop 0
    buffer_load_dwordx4 v8, s[20:23], s45 offen lds
    buffer_load_dwordx4 v[64:67], v2, s[32:35], s43 offen offset:1024 sc1
    buffer_load_dwordx4 v[68:71], v3, s[32:35], s43 offen offset:1024 sc1
    s_waitcnt vmcnt(25)
    s_waitcnt lgkmcnt(4)
    v_mfma_f32_32x32x16_bf16 v[120:135], v[12:15], v[24:27], v[120:135]
    v_mfma_f32_32x32x16_bf16 v[72:87], v[12:15], v[28:31], v[72:87]
    ds_read_b64_tr_b16 v[12:13], v9 offset:21760
    ds_read_b64_tr_b16 v[14:15], v9 offset:24320
    s_waitcnt lgkmcnt(4)
    v_mfma_f32_32x32x16_bf16 v[136:151], v[16:19], v[24:27], v[136:151]
    v_mfma_f32_32x32x16_bf16 v[88:103], v[16:19], v[28:31], v[88:103]
    ds_read_b64_tr_b16 v[16:17], v9 offset:21824
    ds_read_b64_tr_b16 v[18:19], v9 offset:24384
    s_waitcnt lgkmcnt(4)
    v_mfma_f32_32x32x16_bf16 v[152:167], v[20:23], v[24:27], v[152:167]
    v_mfma_f32_32x32x16_bf16 v[104:119], v[20:23], v[28:31], v[104:119]
    ds_read_b64_tr_b16 v[20:21], v9 offset:21888
    ds_read_b64_tr_b16 v[22:23], v9 offset:24448
    buffer_load_dwordx4 v[24:27], v2, s[32:35], s43 offen offset:2048 sc1
    buffer_load_dwordx4 v[28:31], v3, s[32:35], s43 offen offset:2048 sc1
    s_waitcnt vmcnt(20)
    s_waitcnt vmcnt(31)
    s_waitcnt lgkmcnt(4)
    v_mfma_f32_32x32x16_bf16 v[120:135], v[12:15], v[32:35], v[120:135]
    v_mfma_f32_32x32x16_bf16 v[72:87], v[12:15], v[36:39], v[72:87]
    ds_read_b64_tr_b16 v[12:13], v9 offset:0
    ds_read_b64_tr_b16 v[14:15], v9 offset:2560
    s_waitcnt lgkmcnt(4)
    v_mfma_f32_32x32x16_bf16 v[136:151], v[16:19], v[32:35], v[136:151]
    v_mfma_f32_32x32x16_bf16 v[88:103], v[16:19], v[36:39], v[88:103]
    ds_read_b64_tr_b16 v[16:17], v9 offset:64
    ds_read_b64_tr_b16 v[18:19], v9 offset:2624
    s_waitcnt lgkmcnt(4)
    v_mfma_f32_32x32x16_bf16 v[152:167], v[20:23], v[32:35], v[152:167]
    v_mfma_f32_32x32x16_bf16 v[104:119], v[20:23], v[36:39], v[104:119]
    ds_read_b64_tr_b16 v[20:21], v9 offset:128
    ds_read_b64_tr_b16 v[22:23], v9 offset:2688
    s_mov_b32 s45, 450560
    s_add_u32 m0, s44, 20480
    s_nop 0
    buffer_load_dwordx4 v4, s[20:23], s45 offen lds
    s_add_u32 m0, s44, 21504
    s_nop 0
    buffer_load_dwordx4 v5, s[20:23], s45 offen lds
    s_add_u32 m0, s44, 22528
    s_nop 0
    buffer_load_dwordx4 v6, s[20:23], s45 offen lds
    s_add_u32 m0, s44, 23552
    s_nop 0
    buffer_load_dwordx4 v7, s[20:23], s45 offen lds
    s_add_u32 m0, s44, 24576
    s_nop 0
    buffer_load_dwordx4 v8, s[20:23], s45 offen lds
    buffer_load_dwordx4 v[32:35], v2, s[32:35], s43 offen offset:3072 sc1
    buffer_load_dwordx4 v[36:39], v3, s[32:35], s43 offen offset:3072 sc1
    s_waitcnt vmcnt(25)
    s_waitcnt lgkmcnt(4)
    v_mfma_f32_32x32x16_bf16 v[120:135], v[12:15], v[40:43], v[120:135]
    v_mfma_f32_32x32x16_bf16 v[72:87], v[12:15], v[44:47], v[72:87]
    ds_read_b64_tr_b16 v[12:13], v9 offset:1280
    ds_read_b64_tr_b16 v[14:15], v9 offset:3840
    s_waitcnt lgkmcnt(4)
    v_mfma_f32_32x32x16_bf16 v[136:151], v[16:19], v[40:43], v[136:151]
    v_mfma_f32_32x32x16_bf16 v[88:103], v[16:19], v[44:47], v[88:103]
    ds_read_b64_tr_b16 v[16:17], v9 offset:1344
    ds_read_b64_tr_b16 v[18:19], v9 offset:3904
    s_waitcnt lgkmcnt(4)
    v_mfma_f32_32x32x16_bf16 v[152:167], v[20:23], v[40:43], v[152:167]
    v_mfma_f32_32x32x16_bf16 v[104:119], v[20:23], v[44:47], v[104:119]
    ds_read_b64_tr_b16 v[20:21], v9 offset:1408
    ds_read_b64_tr_b16 v[22:23], v9 offset:3968
    s_add_u32 s43, s43, 4096
    buffer_load_dwordx4 v[40:43], v2, s[32:35], s43 offen offset:0 sc1
    buffer_load_dwordx4 v[44:47], v3, s[32:35], s43 offen offset:0 sc1
    s_waitcnt vmcnt(20)
    s_waitcnt vmcnt(31)
    s_waitcnt lgkmcnt(4)
    v_mfma_f32_32x32x16_bf16 v[120:135], v[12:15], v[48:51], v[120:135]
    v_mfma_f32_32x32x16_bf16 v[72:87], v[12:15], v[52:55], v[72:87]
    ds_read_b64_tr_b16 v[12:13], v9 offset:5120
    ds_read_b64_tr_b16 v[14:15], v9 offset:7680
    s_waitcnt lgkmcnt(4)
    v_mfma_f32_32x32x16_bf16 v[136:151], v[16:19], v[48:51], v[136:151]
    v_mfma_f32_32x32x16_bf16 v[88:103], v[16:19], v[52:55], v[88:103]
    ds_read_b64_tr_b16 v[16:17], v9 offset:5184
    ds_read_b64_tr_b16 v[18:19], v9 offset:7744
    s_waitcnt lgkmcnt(4)
    v_mfma_f32_32x32x16_bf16 v[152:167], v[20:23], v[48:51], v[152:167]
    v_mfma_f32_32x32x16_bf16 v[104:119], v[20:23], v[52:55], v[104:119]
    ds_read_b64_tr_b16 v[20:21], v9 offset:5248
    ds_read_b64_tr_b16 v[22:23], v9 offset:7808
    s_mov_b32 s45, 0
    s_add_u32 m0, s44, 0
    s_nop 0
    buffer_load_dwordx4 v4, s[24:27], s45 offen lds
    s_add_u32 m0, s44, 1024
    s_nop 0
    buffer_load_dwordx4 v5, s[24:27], s45 offen lds
    s_add_u32 m0, s44, 2048
    s_nop 0
    buffer_load_dwordx4 v6, s[24:27], s45 offen lds
    s_add_u32 m0, s44, 3072
    s_nop 0
    buffer_load_dwordx4 v7, s[24:27], s45 offen lds
    s_add_u32 m0, s44, 4096
    s_nop 0
    buffer_load_dwordx4 v8, s[24:27], s45 offen lds
    buffer_load_dwordx4 v[48:51], v2, s[32:35], s43 offen offset:1024 sc1
    buffer_load_dwordx4 v[52:55], v3, s[32:35], s43 offen offset:1024 sc1
    s_waitcnt vmcnt(25)
    s_waitcnt lgkmcnt(4)
    v_mfma_f32_32x32x16_bf16 v[120:135], v[12:15], v[56:59], v[120:135]
    v_mfma_f32_32x32x16_bf16 v[72:87], v[12:15], v[60:63], v[72:87]
    ds_read_b64_tr_b16 v[12:13], v9 offset:6400
    ds_read_b64_tr_b16 v[14:15], v9 offset:8960
    s_waitcnt lgkmcnt(4)
    v_mfma_f32_32x32x16_bf16 v[136:151], v[16:19], v[56:59], v[136:151]
    v_mfma_f32_32x32x16_bf16 v[88:103], v[16:19], v[60:63], v[88:103]
    ds_read_b64_tr_b16 v[16:17], v9 offset:6464
    ds_read_b64_tr_b16 v[18:19], v9 offset:9024
    s_waitcnt lgkmcnt(4)
    v_mfma_f32_32x32x16_bf16 v[152:167], v[20:23], v[56:59], v[152:167]
    v_mfma_f32_32x32x16_bf16 v[104:119], v[20:23], v[60:63], v[104:119]
    ds_read_b64_tr_b16 v[20:21], v9 offset:6528
    ds_read_b64_tr_b16 v[22:23], v9 offset:9088
    buffer_load_dwordx4 v[56:59], v2, s[32:35], s43 offen offset:2048 sc1
    buffer_load_dwordx4 v[60:63], v3, s[32:35], s43 offen offset:2048 sc1
    s_waitcnt vmcnt(20)
    s_waitcnt vmcnt(31)
    s_waitcnt lgkmcnt(4)
    v_mfma_f32_32x32x16_bf16 v[120:135], v[12:15], v[64:67], v[120:135]
    v_mfma_f32_32x32x16_bf16 v[72:87], v[12:15], v[68:71], v[72:87]
    ds_read_b64_tr_b16 v[12:13], v9 offset:10240
    ds_read_b64_tr_b16 v[14:15], v9 offset:12800
    s_waitcnt lgkmcnt(4)
    v_mfma_f32_32x32x16_bf16 v[136:151], v[16:19], v[64:67], v[136:151]
    v_mfma_f32_32x32x16_bf16 v[88:103], v[16:19], v[68:71], v[88:103]
    ds_read_b64_tr_b16 v[16:17], v9 offset:10304
    ds_read_b64_tr_b16 v[18:19], v9 offset:12864
    s_waitcnt lgkmcnt(4)
    v_mfma_f32_32x32x16_bf16 v[152:167], v[20:23], v[64:67], v[152:167]
    v_mfma_f32_32x32x16_bf16 v[104:119], v[20:23], v[68:71], v[104:119]
    ds_read_b64_tr_b16 v[20:21], v9 offset:10368
    ds_read_b64_tr_b16 v[22:23], v9 offset:12928
    s_mov_b32 s45, 40960
    s_add_u32 m0, s44, 5120
    s_nop 0
    buffer_load_dwordx4 v4, s[24:27], s45 offen lds
    s_add_u32 m0, s44, 6144
    s_nop 0
    buffer_load_dwordx4 v5, s[24:27], s45 offen lds
    s_add_u32 m0, s44, 7168
    s_nop 0
    buffer_load_dwordx4 v6, s[24:27], s45 offen lds
    s_add_u32 m0, s44, 8192
    s_nop 0
    buffer_load_dwordx4 v7, s[24:27], s45 offen lds
    s_add_u32 m0, s44, 9216
    s_nop 0
    buffer_load_dwordx4 v8, s[24:27], s45 offen lds
    buffer_load_dwordx4 v[64:67], v2, s[32:35], s43 offen offset:3072 sc1
    buffer_load_dwordx4 v[68:71], v3, s[32:35], s43 offen offset:3072 sc1
    s_waitcnt vmcnt(25)
    s_waitcnt lgkmcnt(4)
    v_mfma_f32_32x32x16_bf16 v[120:135], v[12:15], v[24:27], v[120:135]
    v_mfma_f32_32x32x16_bf16 v[72:87], v[12:15], v[28:31], v[72:87]
    ds_read_b64_tr_b16 v[12:13], v9 offset:11520
    ds_read_b64_tr_b16 v[14:15], v9 offset:14080
    s_waitcnt lgkmcnt(4)
    v_mfma_f32_32x32x16_bf16 v[136:151], v[16:19], v[24:27], v[136:151]
    v_mfma_f32_32x32x16_bf16 v[88:103], v[16:19], v[28:31], v[88:103]
    ds_read_b64_tr_b16 v[16:17], v9 offset:11584
    ds_read_b64_tr_b16 v[18:19], v9 offset:14144
    s_waitcnt lgkmcnt(4)
    v_mfma_f32_32x32x16_bf16 v[152:167], v[20:23], v[24:27], v[152:167]
    v_mfma_f32_32x32x16_bf16 v[104:119], v[20:23], v[28:31], v[104:119]
    ds_read_b64_tr_b16 v[20:21], v9 offset:11648
    ds_read_b64_tr_b16 v[22:23], v9 offset:14208
    s_waitcnt vmcnt(18)
    s_waitcnt vmcnt(29)
    s_waitcnt lgkmcnt(4)
    v_mfma_f32_32x32x16_bf16 v[120:135], v[12:15], v[32:35], v[120:135]
    v_mfma_f32_32x32x16_bf16 v[72:87], v[12:15], v[36:39], v[72:87]
    ds_read_b64_tr_b16 v[12:13], v9 offset:15360
    ds_read_b64_tr_b16 v[14:15], v9 offset:17920
    s_waitcnt lgkmcnt(4)
    v_mfma_f32_32x32x16_bf16 v[136:151], v[16:19], v[32:35], v[136:151]
    v_mfma_f32_32x32x16_bf16 v[88:103], v[16:19], v[36:39], v[88:103]
    ds_read_b64_tr_b16 v[16:17], v9 offset:15424
    ds_read_b64_tr_b16 v[18:19], v9 offset:17984
    s_waitcnt lgkmcnt(4)
    v_mfma_f32_32x32x16_bf16 v[152:167], v[20:23], v[32:35], v[152:167]
    v_mfma_f32_32x32x16_bf16 v[104:119], v[20:23], v[36:39], v[104:119]
    ds_read_b64_tr_b16 v[20:21], v9 offset:15488
    ds_read_b64_tr_b16 v[22:23], v9 offset:18048
    s_mov_b32 s45, 81920
    s_add_u32 m0, s44, 10240
    s_nop 0
    buffer_load_dwordx4 v4, s[24:27], s45 offen lds
    s_add_u32 m0, s44, 11264
    s_nop 0
    buffer_load_dwordx4 v5, s[24:27], s45 offen lds
    s_add_u32 m0, s44, 12288
    s_nop 0
    buffer_load_dwordx4 v6, s[24:27], s45 offen lds
    s_add_u32 m0, s44, 13312
    s_nop 0
    buffer_load_dwordx4 v7, s[24:27], s45 offen lds
    s_add_u32 m0, s44, 14336
    s_nop 0
    buffer_load_dwordx4 v8, s[24:27], s45 offen lds
    s_waitcnt vmcnt(21)
    s_waitcnt lgkmcnt(4)
    v_mfma_f32_32x32x16_bf16 v[120:135], v[12:15], v[40:43], v[120:135]
    v_mfma_f32_32x32x16_bf16 v[72:87], v[12:15], v[44:47], v[72:87]
    ds_read_b64_tr_b16 v[12:13], v9 offset:16640
    ds_read_b64_tr_b16 v[14:15], v9 offset:19200
    s_waitcnt lgkmcnt(4)
    v_mfma_f32_32x32x16_bf16 v[136:151], v[16:19], v[40:43], v[136:151]
    v_mfma_f32_32x32x16_bf16 v[88:103], v[16:19], v[44:47], v[88:103]
    ds_read_b64_tr_b16 v[16:17], v9 offset:16704
    ds_read_b64_tr_b16 v[18:19], v9 offset:19264
    s_waitcnt lgkmcnt(4)
    v_mfma_f32_32x32x16_bf16 v[152:167], v[20:23], v[40:43], v[152:167]
    v_mfma_f32_32x32x16_bf16 v[104:119], v[20:23], v[44:47], v[104:119]
    ds_read_b64_tr_b16 v[20:21], v9 offset:16768
    ds_read_b64_tr_b16 v[22:23], v9 offset:19328
    s_waitcnt vmcnt(14)
    s_waitcnt vmcnt(25)
    s_waitcnt lgkmcnt(4)
    v_mfma_f32_32x32x16_bf16 v[120:135], v[12:15], v[48:51], v[120:135]
    v_mfma_f32_32x32x16_bf16 v[72:87], v[12:15], v[52:55], v[72:87]
    ds_read_b64_tr_b16 v[12:13], v9 offset:20480
    ds_read_b64_tr_b16 v[14:15], v9 offset:23040
    s_waitcnt lgkmcnt(4)
    v_mfma_f32_32x32x16_bf16 v[136:151], v[16:19], v[48:51], v[136:151]
    v_mfma_f32_32x32x16_bf16 v[88:103], v[16:19], v[52:55], v[88:103]
    ds_read_b64_tr_b16 v[16:17], v9 offset:20544
    ds_read_b64_tr_b16 v[18:19], v9 offset:23104
    s_waitcnt lgkmcnt(4)
    v_mfma_f32_32x32x16_bf16 v[152:167], v[20:23], v[48:51], v[152:167]
    v_mfma_f32_32x32x16_bf16 v[104:119], v[20:23], v[52:55], v[104:119]
    ds_read_b64_tr_b16 v[20:21], v9 offset:20608
    ds_read_b64_tr_b16 v[22:23], v9 offset:23168
    s_mov_b32 s45, 122880
    s_add_u32 m0, s44, 15360
    s_nop 0
    buffer_load_dwordx4 v4, s[24:27], s45 offen lds
    s_add_u32 m0, s44, 16384
    s_nop 0
    buffer_load_dwordx4 v5, s[24:27], s45 offen lds
    s_add_u32 m0, s44, 17408
    s_nop 0
    buffer_load_dwordx4 v6, s[24:27], s45 offen lds
    s_add_u32 m0, s44, 18432
    s_nop 0
    buffer_load_dwordx4 v7, s[24:27], s45 offen lds
    s_add_u32 m0, s44, 19456
    s_nop 0
    buffer_load_dwordx4 v8, s[24:27], s45 offen lds
    s_waitcnt vmcnt(17)
    s_waitcnt lgkmcnt(4)
    v_mfma_f32_32x32x16_bf16 v[120:135], v[12:15], v[56:59], v[120:135]
    v_mfma_f32_32x32x16_bf16 v[72:87], v[12:15], v[60:63], v[72:87]
    ds_read_b64_tr_b16 v[12:13], v9 offset:21760
    ds_read_b64_tr_b16 v[14:15], v9 offset:24320
    s_waitcnt lgkmcnt(4)
    v_mfma_f32_32x32x16_bf16 v[136:151], v[16:19], v[56:59], v[136:151]
    v_mfma_f32_32x32x16_bf16 v[88:103], v[16:19], v[60:63], v[88:103]
    ds_read_b64_tr_b16 v[16:17], v9 offset:21824
    ds_read_b64_tr_b16 v[18:19], v9 offset:24384
    s_waitcnt lgkmcnt(4)
    v_mfma_f32_32x32x16_bf16 v[152:167], v[20:23], v[56:59], v[152:167]
    v_mfma_f32_32x32x16_bf16 v[104:119], v[20:23], v[60:63], v[104:119]
    ds_read_b64_tr_b16 v[20:21], v9 offset:21888
    ds_read_b64_tr_b16 v[22:23], v9 offset:24448
    s_waitcnt vmcnt(10)
    s_waitcnt lgkmcnt(4)
    v_mfma_f32_32x32x16_bf16 v[120:135], v[12:15], v[64:67], v[120:135]
    v_mfma_f32_32x32x16_bf16 v[72:87], v[12:15], v[68:71], v[72:87]
    s_waitcnt lgkmcnt(2)
    v_mfma_f32_32x32x16_bf16 v[136:151], v[16:19], v[64:67], v[136:151]
    v_mfma_f32_32x32x16_bf16 v[88:103], v[16:19], v[68:71], v[88:103]
    s_waitcnt lgkmcnt(0)
    v_mfma_f32_32x32x16_bf16 v[152:167], v[20:23], v[64:67], v[152:167]
    v_mfma_f32_32x32x16_bf16 v[104:119], v[20:23], v[68:71], v[104:119]
    s_mov_b32 s45, 163840
    s_add_u32 m0, s44, 20480
    s_nop 0
    buffer_load_dwordx4 v4, s[24:27], s45 offen lds
    s_add_u32 m0, s44, 21504
    s_nop 0
    buffer_load_dwordx4 v5, s[24:27], s45 offen lds
    s_add_u32 m0, s44, 22528
    s_nop 0
    buffer_load_dwordx4 v6, s[24:27], s45 offen lds
    s_add_u32 m0, s44, 23552
    s_nop 0
    buffer_load_dwordx4 v7, s[24:27], s45 offen lds
    s_add_u32 m0, s44, 24576
    s_nop 0
    buffer_load_dwordx4 v8, s[24:27], s45 offen lds
    v_lshrrev_b32 v7, 5, v1
    v_lshlrev_b32 v6, 3, v1
    v_lshl_add_u32 v6, v7, 8, v6
    v_add_u32 v6, 4096, v6
    s_mul_i32 s40, s62, 10240
    s_add_u32 s40, s40, 131072
    v_lshlrev_b32 v2, 4, v1
    v_add_u32 v3, s40, v2
    s_lshl_b32 s40, s62, 2
    s_add_u32 s41, s40, 151600
    s_add_u32 s40, s40, 151592
    s_cmp_eq_u32 s61, 0
    s_cbranch_scc0 G_x1
    ds_write_b128 v3, v[72:75] offset:0
    ds_write_b128 v3, v[76:79] offset:1024
    ds_write_b128 v3, v[80:83] offset:2048
    ds_write_b128 v3, v[84:87] offset:3072
    ds_write_b128 v3, v[88:91] offset:4096
    ds_write_b128 v3, v[92:95] offset:5120
    ds_write_b128 v3, v[96:99] offset:6144
    ds_write_b128 v3, v[100:103] offset:7168
    ds_write_b128 v3, v[104:107] offset:8192
    ds_write_b128 v3, v[108:111] offset:9216
    s_waitcnt vmcnt(0) lgkmcnt(0)
    v_mov_b32 v0, s40
    v_mov_b32 v11, 1
    ds_write_b32 v0, v11
    buffer_load_dwordx4 v[80:83], v2, s[32:35], s50 offen offset:0 sc1
    buffer_load_dwordx4 v[84:87], v2, s[32:35], s50 offen offset:2048 sc1
    buffer_load_dwordx4 v[88:91], v2, s[32:35], s51 offen offset:0 sc1
    buffer_load_dwordx4 v[92:95], v2, s[32:35], s51 offen offset:2048 sc1
    buffer_load_dwordx2 v[96:97], v6, s[32:35], s50 offen offset:0 sc1
    buffer_load_dwordx2 v[98:99], v6, s[32:35], s51 offen offset:0 sc1
    buffer_load_dwordx4 v[100:103], v2, s[32:35], s52 offen offset:0 sc1
    buffer_load_dwordx4 v[104:107], v2, s[32:35], s52 offen offset:2048 sc1
    buffer_load_dwordx4 v[108:111], v2, s[32:35], s53 offen offset:0 sc1
    buffer_load_dwordx4 v[112:115], v2, s[32:35], s53 offen offset:2048 sc1
    buffer_load_dwordx2 v[116:117], v6, s[32:35], s52 offen offset:0 sc1
    buffer_load_dwordx2 v[118:119], v6, s[32:35], s53 offen offset:0 sc1
G_x0w:
    v_mov_b32 v0, s41
    ds_read_b32 v0, v0
    s_sleep 2
    s_waitcnt lgkmcnt(0)
    v_readfirstlane_b32 s49, v0
    s_cmp_lt_u32 s49, 1
    s_cbranch_scc1 G_x0w
    ds_read_b128 v[24:27], v3 offset:0
    ds_read_b128 v[28:31], v3 offset:1024
    ds_read_b128 v[32:35], v3 offset:2048
    ds_read_b128 v[36:39], v3 offset:3072
    ds_read_b128 v[40:43], v3 offset:4096
    ds_read_b128 v[44:47], v3 offset:5120
    ds_read_b128 v[48:51], v3 offset:6144
    ds_read_b128 v[52:55], v3 offset:7168
    ds_read_b128 v[56:59], v3 offset:8192
    ds_read_b128 v[60:63], v3 offset:9216
    s_branch G_x2
G_x1:
G_x1w:
    v_mov_b32 v0, s40
    ds_read_b32 v0, v0
    s_sleep 2
    s_waitcnt lgkmcnt(0)
    v_readfirstlane_b32 s49, v0
    s_cmp_lt_u32 s49, 1
    s_cbranch_scc1 G_x1w
    ds_read_b128 v[24:27], v3 offset:0
    ds_read_b128 v[28:31], v3 offset:1024
    ds_read_b128 v[32:35], v3 offset:2048
    ds_read_b128 v[36:39], v3 offset:3072
    ds_read_b128 v[40:43], v3 offset:4096
    ds_read_b128 v[44:47], v3 offset:5120
    ds_read_b128 v[48:51], v3 offset:6144
    ds_read_b128 v[52:55], v3 offset:7168
    ds_read_b128 v[56:59], v3 offset:8192
    ds_read_b128 v[60:63], v3 offset:9216
    s_waitcnt lgkmcnt(0)
    ds_write_b128 v3, v[72:75] offset:0
    ds_write_b128 v3, v[76:79] offset:1024
    ds_write_b128 v3, v[80:83] offset:2048
    ds_write_b128 v3, v[84:87] offset:3072
    ds_write_b128 v3, v[88:91] offset:4096
    ds_write_b128 v3, v[92:95] offset:5120
    ds_write_b128 v3, v[96:99] offset:6144
    ds_write_b128 v3, v[100:103] offset:7168
    ds_write_b128 v3, v[104:107] offset:8192
    ds_write_b128 v3, v[108:111] offset:9216
    s_waitcnt vmcnt(0) lgkmcnt(0)
    v_mov_b32 v0, s41
    v_mov_b32 v11, 1
    ds_write_b32 v0, v11
    buffer_load_dwordx4 v[80:83], v2, s[32:35], s50 offen offset:0 sc1
    buffer_load_dwordx4 v[84:87], v2, s[32:35], s50 offen offset:2048 sc1
    buffer_load_dwordx4 v[88:91], v2, s[32:35], s51 offen offset:0 sc1
    buffer_load_dwordx4 v[92:95], v2, s[32:35], s51 offen offset:2048 sc1
    buffer_load_dwordx2 v[96:97], v6, s[32:35], s50 offen offset:0 sc1
    buffer_load_dwordx2 v[98:99], v6, s[32:35], s51 offen offset:0 sc1
    buffer_load_dwordx4 v[100:103], v2, s[32:35], s52 offen offset:0 sc1
    buffer_load_dwordx4 v[104:107], v2, s[32:35], s52 offen offset:2048 sc1
    buffer_load_dwordx4 v[108:111], v2, s[32:35], s53 offen offset:0 sc1
    buffer_load_dwordx4 v[112:115], v2, s[32:35], s53 offen offset:2048 sc1
    buffer_load_dwordx2 v[116:117], v6, s[32:35], s52 offen offset:0 sc1
    buffer_load_dwordx2 v[118:119], v6, s[32:35], s53 offen offset:0 sc1
G_x2:
    v_sub_f32 v10, 1.0, v10
    s_mul_i32 s40, s61, 25600
    v_subrev_u32 v4, s40, v9
    v_lshrrev_b32 v0, 5, v1
    v_mul_u32_u24 v5, 5760, v0
    v_add_u32 v5, v5, v4
    v_add_u32 v5, 2560, v5
    v_and_b32 v7, 31, v1
    v_mul_u32_u24 v7, 1280, v7
    v_lshl_add_u32 v8, v0, 3, v7
    v_lshl_add_u32 v7, v0, 4, v7
    s_mul_i32 s40, s60, 5120
    s_add_u32 s40, s40, 0
    v_add_u32 v3, s40, v2
    s_xor_b32 s40, s60, 2
    s_mul_i32 s40, s40, 5120
    s_add_u32 s40, s40, 0
    v_add_u32 v9, s40, v2
    s_mov_b32 s48, 131072
    v_mov_b32 v11, 151584
    s_mov_b32 s47, 8
    s_waitcnt lgkmcnt(0)
    v_add_f32 v120, v120, v24
    v_add_f32 v121, v121, v25
    v_add_f32 v122, v122, v26
    v_add_f32 v123, v123, v27
    v_add_f32 v124, v124, v28
    v_add_f32 v125, v125, v29
    v_add_f32 v126, v126, v30
    v_add_f32 v127, v127, v31
    v_add_f32 v128, v128, v32
    v_add_f32 v129, v129, v33
    v_add_f32 v130, v130, v34
    v_add_f32 v131, v131, v35
    v_add_f32 v132, v132, v36
    v_add_f32 v133, v133, v37
    v_add_f32 v134, v134, v38
    v_add_f32 v135, v135, v39
    v_add_f32 v136, v136, v40
    v_add_f32 v137, v137, v41
    v_add_f32 v138, v138, v42
    v_add_f32 v139, v139, v43
    v_add_f32 v140, v140, v44
    v_add_f32 v141, v141, v45
    v_add_f32 v142, v142, v46
    v_add_f32 v143, v143, v47
    v_add_f32 v144, v144, v48
    v_add_f32 v145, v145, v49
    v_add_f32 v146, v146, v50
    v_add_f32 v147, v147, v51
    v_add_f32 v148, v148, v52
    v_add_f32 v149, v149, v53
    v_add_f32 v150, v150, v54
    v_add_f32 v151, v151, v55
    v_add_f32 v152, v152, v56
    v_add_f32 v153, v153, v57
    v_add_f32 v154, v154, v58
    v_add_f32 v155, v155, v59
    v_add_f32 v156, v156, v60
    v_add_f32 v157, v157, v61
    v_add_f32 v158, v158, v62
    v_add_f32 v159, v159, v63
G_o0:
    s_waitcnt vmcnt(0) lgkmcnt(0)
    v_or3_b32 v36, v80, v84, v88
    v_or3_b32 v37, v92, v96, v98
    v_or3_b32 v37, v100, v104, v37
    v_or3_b32 v36, v108, v112, v36
    v_or3_b32 v37, v116, v118, v37
    v_or_b32 v36, v36, v37
    v_and_b32 v36, 1, v36
    v_cmp_eq_u32 vcc, 1, v36
    s_cbranch_vccnz G_r0
G_g0:
    ds_read_b64_tr_b16 v[12:13], v4 offset:0
    ds_read_b64_tr_b16 v[14:15], v4 offset:1280
    ds_read_b64_tr_b16 v[16:17], v4 offset:64
    ds_read_b64_tr_b16 v[18:19], v4 offset:1344
    ds_read_b64_tr_b16 v[20:21], v4 offset:128
    ds_read_b64_tr_b16 v[22:23], v4 offset:1408
    ds_read_b64_tr_b16 v[24:25], v4 offset:6400
    ds_read_b64_tr_b16 v[26:27], v4 offset:7680
    ds_read_b64_tr_b16 v[28:29], v4 offset:6464
    ds_read_b64_tr_b16 v[30:31], v4 offset:7744
    ds_read_b64_tr_b16 v[32:33], v4 offset:6528
    ds_read_b64_tr_b16 v[34:35], v4 offset:7808
    v_mul_f32 v120, v120, v10
    v_mul_f32 v121, v121, v10
    v_mul_f32 v122, v122, v10
    v_mul_f32 v123, v123, v10
    v_mul_f32 v124, v124, v10
    v_mul_f32 v125, v125, v10
    v_mul_f32 v126, v126, v10
    v_mul_f32 v127, v127, v10
    v_mul_f32 v128, v128, v10
    v_mul_f32 v129, v129, v10
    v_mul_f32 v130, v130, v10
    v_mul_f32 v131, v131, v10
    v_mul_f32 v132, v132, v10
    v_mul_f32 v133, v133, v10
    v_mul_f32 v134, v134, v10
    v_mul_f32 v135, v135, v10
    v_mul_f32 v136, v136, v10
    v_mul_f32 v137, v137, v10
    v_mul_f32 v138, v138, v10
    v_mul_f32 v139, v139, v10
    v_mul_f32 v140, v140, v10
    v_mul_f32 v141, v141, v10
    v_mul_f32 v142, v142, v10
    v_mul_f32 v143, v143, v10
    v_mul_f32 v144, v144, v10
    v_mul_f32 v145, v145, v10
    v_mul_f32 v146, v146, v10
    v_mul_f32 v147, v147, v10
    v_mul_f32 v148, v148, v10
    v_mul_f32 v149, v149, v10
    v_mul_f32 v150, v150, v10
    v_mul_f32 v151, v151, v10
    v_mul_f32 v152, v152, v10
    v_mul_f32 v153, v153, v10
    v_mul_f32 v154, v154, v10
    v_mul_f32 v155, v155, v10
    v_mul_f32 v156, v156, v10
    v_mul_f32 v157, v157, v10
    v_mul_f32 v158, v158, v10
    v_mul_f32 v159, v159, v10
    s_waitcnt lgkmcnt(12)
    s_waitcnt lgkmcnt(6)
    v_mfma_f32_32x32x16_bf16 v[120:135], v[12:15], v[80:83], v[120:135]
    v_mfma_f32_32x32x16_bf16 v[136:151], v[16:19], v[80:83], v[136:151]
    v_mfma_f32_32x32x16_bf16 v[152:167], v[20:23], v[80:83], v[152:167]
    ds_read_b64_tr_b16 v[12:13], v4 offset:12800
    ds_read_b64_tr_b16 v[14:15], v4 offset:14080
    ds_read_b64_tr_b16 v[16:17], v4 offset:12864
    ds_read_b64_tr_b16 v[18:19], v4 offset:14144
    ds_read_b64_tr_b16 v[20:21], v4 offset:12928
    ds_read_b64_tr_b16 v[22:23], v4 offset:14208
    s_waitcnt lgkmcnt(6)
    v_mfma_f32_32x32x16_bf16 v[120:135], v[24:27], v[84:87], v[120:135]
    v_mfma_f32_32x32x16_bf16 v[136:151], v[28:31], v[84:87], v[136:151]
    v_mfma_f32_32x32x16_bf16 v[152:167], v[32:35], v[84:87], v[152:167]
    ds_read_b64_tr_b16 v[24:25], v4 offset:19200
    ds_read_b64_tr_b16 v[26:27], v4 offset:20480
    ds_read_b64_tr_b16 v[28:29], v4 offset:19264
    ds_read_b64_tr_b16 v[30:31], v4 offset:20544
    ds_read_b64_tr_b16 v[32:33], v4 offset:19328
    ds_read_b64_tr_b16 v[34:35], v4 offset:20608
    s_waitcnt lgkmcnt(6)
    v_mfma_f32_32x32x16_bf16 v[120:135], v[12:15], v[88:91], v[120:135]
    v_mfma_f32_32x32x16_bf16 v[136:151], v[16:19], v[88:91], v[136:151]
    v_mfma_f32_32x32x16_bf16 v[152:167], v[20:23], v[88:91], v[152:167]
    ds_read_b64_tr_b16 v[12:13], v5 offset:0
    ds_read_b64_tr_b16 v[14:15], v5 offset:12800
    ds_read_b64_tr_b16 v[16:17], v5 offset:64
    ds_read_b64_tr_b16 v[18:19], v5 offset:12864
    ds_read_b64_tr_b16 v[20:21], v5 offset:128
    ds_read_b64_tr_b16 v[22:23], v5 offset:12928
    s_waitcnt lgkmcnt(6)
    v_mfma_f32_32x32x16_bf16 v[120:135], v[24:27], v[92:95], v[120:135]
    v_mfma_f32_32x32x16_bf16 v[136:151], v[28:31], v[92:95], v[136:151]
    v_mfma_f32_32x32x16_bf16 v[152:167], v[32:35], v[92:95], v[152:167]
    ds_read_b64_tr_b16 v[24:25], v4 offset:25600
    ds_read_b64_tr_b16 v[26:27], v4 offset:26880
    ds_read_b64_tr_b16 v[28:29], v4 offset:25664
    ds_read_b64_tr_b16 v[30:31], v4 offset:26944
    ds_read_b64_tr_b16 v[32:33], v4 offset:25728
    ds_read_b64_tr_b16 v[34:35], v4 offset:27008
    s_waitcnt lgkmcnt(6)
    v_mfma_f32_32x32x16_bf16 v[120:135], v[12:15], v[96:99], v[120:135]
    v_mfma_f32_32x32x16_bf16 v[136:151], v[16:19], v[96:99], v[136:151]
    v_mfma_f32_32x32x16_bf16 v[152:167], v[20:23], v[96:99], v[152:167]
    ds_read_b32 v0, v11
    ds_read_b64_tr_b16 v[12:13], v4 offset:32000
    ds_read_b64_tr_b16 v[14:15], v4 offset:33280
    ds_read_b64_tr_b16 v[16:17], v4 offset:32064
    ds_read_b64_tr_b16 v[18:19], v4 offset:33344
    ds_read_b64_tr_b16 v[20:21], v4 offset:32128
    ds_read_b64_tr_b16 v[22:23], v4 offset:33408
    s_waitcnt lgkmcnt(6)
    v_mfma_f32_32x32x16_bf16 v[120:135], v[24:27], v[100:103], v[120:135]
    v_mfma_f32_32x32x16_bf16 v[136:151], v[28:31], v[100:103], v[136:151]
    v_mfma_f32_32x32x16_bf16 v[152:167], v[32:35], v[100:103], v[152:167]
    v_readfirstlane_b32 s49, v0
    s_cmp_ge_u32 s49, s47
    s_cbranch_scc1 G_cd
G_bd:
    ds_read_b64_tr_b16 v[24:25], v4 offset:38400
    ds_read_b64_tr_b16 v[26:27], v4 offset:39680
    ds_read_b64_tr_b16 v[28:29], v4 offset:38464
    ds_read_b64_tr_b16 v[30:31], v4 offset:39744
    ds_read_b64_tr_b16 v[32:33], v4 offset:38528
    ds_read_b64_tr_b16 v[34:35], v4 offset:39808
    s_waitcnt lgkmcnt(6)
    v_mfma_f32_32x32x16_bf16 v[120:135], v[12:15], v[104:107], v[120:135]
    v_mfma_f32_32x32x16_bf16 v[136:151], v[16:19], v[104:107], v[136:151]
    v_mfma_f32_32x32x16_bf16 v[152:167], v[20:23], v[104:107], v[152:167]
    ds_read_b64_tr_b16 v[12:13], v4 offset:44800
    ds_read_b64_tr_b16 v[14:15], v4 offset:46080
    ds_read_b64_tr_b16 v[16:17], v4 offset:44864
    ds_read_b64_tr_b16 v[18:19], v4 offset:46144
    ds_read_b64_tr_b16 v[20:21], v4 offset:44928
    ds_read_b64_tr_b16 v[22:23], v4 offset:46208
    s_waitcnt lgkmcnt(6)
    v_mfma_f32_32x32x16_bf16 v[120:135], v[24:27], v[108:111], v[120:135]
    v_mfma_f32_32x32x16_bf16 v[136:151], v[28:31], v[108:111], v[136:151]
    v_mfma_f32_32x32x16_bf16 v[152:167], v[32:35], v[108:111], v[152:167]
    ds_read_b32 v0, v11
    ds_read_b64_tr_b16 v[24:25], v5 offset:25600
    ds_read_b64_tr_b16 v[26:27], v5 offset:38400
    ds_read_b64_tr_b16 v[28:29], v5 offset:25664
    ds_read_b64_tr_b16 v[30:31], v5 offset:38464
    ds_read_b64_tr_b16 v[32:33], v5 offset:25728
    ds_read_b64_tr_b16 v[34:35], v5 offset:38528
    s_waitcnt lgkmcnt(6)
    v_mfma_f32_32x32x16_bf16 v[120:135], v[12:15], v[112:115], v[120:135]
    v_mfma_f32_32x32x16_bf16 v[136:151], v[16:19], v[112:115], v[136:151]
    v_mfma_f32_32x32x16_bf16 v[152:167], v[20:23], v[112:115], v[152:167]
    v_readfirstlane_b32 s49, v0
    s_cmp_ge_u32 s49, s47
    s_cbranch_scc1 G_ce
G_be:
    ds_read_b64_tr_b16 v[12:13], v4 offset:3200
    ds_read_b64_tr_b16 v[14:15], v4 offset:4480
    ds_read_b64_tr_b16 v[16:17], v4 offset:3264
    ds_read_b64_tr_b16 v[18:19], v4 offset:4544
    ds_read_b64_tr_b16 v[20:21], v4 offset:3328
    ds_read_b64_tr_b16 v[22:23], v4 offset:4608
    s_waitcnt lgkmcnt(6)
    v_mfma_f32_32x32x16_bf16 v[120:135], v[24:27], v[116:119], v[120:135]
    v_mfma_f32_32x32x16_bf16 v[136:151], v[28:31], v[116:119], v[136:151]
    v_mfma_f32_32x32x16_bf16 v[152:167], v[32:35], v[116:119], v[152:167]
    ds_read_b64_tr_b16 v[24:25], v4 offset:9600
    ds_read_b64_tr_b16 v[26:27], v4 offset:10880
    ds_read_b64_tr_b16 v[28:29], v4 offset:9664
    ds_read_b64_tr_b16 v[30:31], v4 offset:10944
    ds_read_b64_tr_b16 v[32:33], v4 offset:9728
    ds_read_b64_tr_b16 v[34:35], v4 offset:11008
    s_cmp_lg_u32 s47, 8
    s_cbranch_scc1 G_o2
G_dn:
    v_mov_b32 v0, 151584
    ds_read_b32 v0, v0
    s_sleep 1
    s_waitcnt lgkmcnt(0)
    v_readfirstlane_b32 s49, v0
    s_cmp_lt_u32 s49, 8
    s_cbranch_scc1 G_dn
    buffer_load_dwordx4 v[40:43], v2, s[32:35], s50 offen offset:1024 sc1
    buffer_load_dwordx4 v[44:47], v2, s[32:35], s50 offen offset:3072 sc1
    buffer_load_dwordx4 v[48:51], v2, s[32:35], s51 offen offset:1024 sc1
    buffer_load_dwordx4 v[52:55], v2, s[32:35], s51 offen offset:3072 sc1
    buffer_load_dwordx2 v[56:57], v6, s[32:35], s50 offen offset:256 sc1
    buffer_load_dwordx2 v[58:59], v6, s[32:35], s51 offen offset:256 sc1
    buffer_load_dwordx4 v[60:63], v2, s[32:35], s52 offen offset:1024 sc1
    buffer_load_dwordx4 v[64:67], v2, s[32:35], s52 offen offset:3072 sc1
    buffer_load_dwordx4 v[68:71], v2, s[32:35], s53 offen offset:1024 sc1
    buffer_load_dwordx4 v[72:75], v2, s[32:35], s53 offen offset:3072 sc1
    buffer_load_dwordx2 v[76:77], v6, s[32:35], s52 offen offset:256 sc1
    buffer_load_dwordx2 v[78:79], v6, s[32:35], s53 offen offset:256 sc1
G_o2:
    s_waitcnt vmcnt(6)
    v_or3_b32 v36, v40, v44, v48
    v_or3_b32 v37, v52, v56, v58
    v_or_b32 v36, v36, v37
    v_and_b32 v36, 1, v36
    v_cmp_eq_u32 vcc, 1, v36
    s_cbranch_vccnz G_r2
G_g2:
    s_waitcnt lgkmcnt(6)
    v_mfma_f32_32x32x16_bf16 v[120:135], v[12:15], v[40:43], v[120:135]
    v_mfma_f32_32x32x16_bf16 v[136:151], v[16:19], v[40:43], v[136:151]
    v_mfma_f32_32x32x16_bf16 v[152:167], v[20:23], v[40:43], v[152:167]
    ds_read_b64_tr_b16 v[12:13], v4 offset:16000
    ds_read_b64_tr_b16 v[14:15], v4 offset:17280
    ds_read_b64_tr_b16 v[16:17], v4 offset:16064
    ds_read_b64_tr_b16 v[18:19], v4 offset:17344
    ds_read_b64_tr_b16 v[20:21], v4 offset:16128
    ds_read_b64_tr_b16 v[22:23], v4 offset:17408
    s_waitcnt lgkmcnt(6)
    v_mfma_f32_32x32x16_bf16 v[120:135], v[24:27], v[44:47], v[120:135]
    v_mfma_f32_32x32x16_bf16 v[136:151], v[28:31], v[44:47], v[136:151]
    v_mfma_f32_32x32x16_bf16 v[152:167], v[32:35], v[44:47], v[152:167]
    ds_read_b64_tr_b16 v[24:25], v4 offset:22400
    ds_read_b64_tr_b16 v[26:27], v4 offset:23680
    ds_read_b64_tr_b16 v[28:29], v4 offset:22464
    ds_read_b64_tr_b16 v[30:31], v4 offset:23744
    ds_read_b64_tr_b16 v[32:33], v4 offset:22528
    ds_read_b64_tr_b16 v[34:35], v4 offset:23808
    s_waitcnt lgkmcnt(6)
    v_mfma_f32_32x32x16_bf16 v[120:135], v[12:15], v[48:51], v[120:135]
    v_mfma_f32_32x32x16_bf16 v[136:151], v[16:19], v[48:51], v[136:151]
    v_mfma_f32_32x32x16_bf16 v[152:167], v[20:23], v[48:51], v[152:167]
    ds_read_b64_tr_b16 v[12:13], v5 offset:3200
    ds_read_b64_tr_b16 v[14:15], v5 offset:16000
    ds_read_b64_tr_b16 v[16:17], v5 offset:3264
    ds_read_b64_tr_b16 v[18:19], v5 offset:16064
    ds_read_b64_tr_b16 v[20:21], v5 offset:3328
    ds_read_b64_tr_b16 v[22:23], v5 offset:16128
    s_waitcnt lgkmcnt(6)
    v_mfma_f32_32x32x16_bf16 v[120:135], v[24:27], v[52:55], v[120:135]
    v_mfma_f32_32x32x16_bf16 v[136:151], v[28:31], v[52:55], v[136:151]
    v_mfma_f32_32x32x16_bf16 v[152:167], v[32:35], v[52:55], v[152:167]
    ds_read_b64_tr_b16 v[24:25], v4 offset:28800
    ds_read_b64_tr_b16 v[26:27], v4 offset:30080
    ds_read_b64_tr_b16 v[28:29], v4 offset:28864
    ds_read_b64_tr_b16 v[30:31], v4 offset:30144
    ds_read_b64_tr_b16 v[32:33], v4 offset:28928
    ds_read_b64_tr_b16 v[34:35], v4 offset:30208
    s_waitcnt lgkmcnt(6)
    v_mfma_f32_32x32x16_bf16 v[120:135], v[12:15], v[56:59], v[120:135]
    v_mfma_f32_32x32x16_bf16 v[136:151], v[16:19], v[56:59], v[136:151]
    v_mfma_f32_32x32x16_bf16 v[152:167], v[20:23], v[56:59], v[152:167]
    ds_read_b64_tr_b16 v[12:13], v4 offset:35200
    ds_read_b64_tr_b16 v[14:15], v4 offset:36480
    ds_read_b64_tr_b16 v[16:17], v4 offset:35264
    ds_read_b64_tr_b16 v[18:19], v4 offset:36544
    ds_read_b64_tr_b16 v[20:21], v4 offset:35328
    ds_read_b64_tr_b16 v[22:23], v4 offset:36608
G_o3:
    s_waitcnt vmcnt(0)
    v_or3_b32 v36, v60, v64, v68
    v_or3_b32 v37, v72, v76, v78
    v_or_b32 v36, v36, v37
    v_and_b32 v36, 1, v36
    v_cmp_eq_u32 vcc, 1, v36
    s_cbranch_vccnz G_r3
G_g3:
    s_waitcnt lgkmcnt(6)
    v_mfma_f32_32x32x16_bf16 v[120:135], v[24:27], v[60:63], v[120:135]
    v_mfma_f32_32x32x16_bf16 v[136:151], v[28:31], v[60:63], v[136:151]
    v_mfma_f32_32x32x16_bf16 v[152:167], v[32:35], v[60:63], v[152:167]
    ds_read_b64_tr_b16 v[24:25], v4 offset:41600
    ds_read_b64_tr_b16 v[26:27], v4 offset:42880
    ds_read_b64_tr_b16 v[28:29], v4 offset:41664
    ds_read_b64_tr_b16 v[30:31], v4 offset:42944
    ds_read_b64_tr_b16 v[32:33], v4 offset:41728
    ds_read_b64_tr_b16 v[34:35], v4 offset:43008
    s_waitcnt lgkmcnt(6)
    v_mfma_f32_32x32x16_bf16 v[120:135], v[12:15], v[64:67], v[120:135]
    v_mfma_f32_32x32x16_bf16 v[136:151], v[16:19], v[64:67], v[136:151]
    v_mfma_f32_32x32x16_bf16 v[152:167], v[20:23], v[64:67], v[152:167]
    ds_read_b64_tr_b16 v[12:13], v4 offset:48000
    ds_read_b64_tr_b16 v[14:15], v4 offset:49280
    ds_read_b64_tr_b16 v[16:17], v4 offset:48064
    ds_read_b64_tr_b16 v[18:19], v4 offset:49344
    ds_read_b64_tr_b16 v[20:21], v4 offset:48128
    ds_read_b64_tr_b16 v[22:23], v4 offset:49408
    s_waitcnt lgkmcnt(6)
    v_mfma_f32_32x32x16_bf16 v[120:135], v[24:27], v[68:71], v[120:135]
    v_mfma_f32_32x32x16_bf16 v[136:151], v[28:31], v[68:71], v[136:151]
    v_mfma_f32_32x32x16_bf16 v[152:167], v[32:35], v[68:71], v[152:167]
    ds_read_b64_tr_b16 v[24:25], v5 offset:28800
    ds_read_b64_tr_b16 v[26:27], v5 offset:41600
    ds_read_b64_tr_b16 v[28:29], v5 offset:28864
    ds_read_b64_tr_b16 v[30:31], v5 offset:41664
    ds_read_b64_tr_b16 v[32:33], v5 offset:28928
    ds_read_b64_tr_b16 v[34:35], v5 offset:41728
    s_waitcnt lgkmcnt(6)
    v_mfma_f32_32x32x16_bf16 v[120:135], v[12:15], v[72:75], v[120:135]
    v_mfma_f32_32x32x16_bf16 v[136:151], v[16:19], v[72:75], v[136:151]
    v_mfma_f32_32x32x16_bf16 v[152:167], v[20:23], v[72:75], v[152:167]
    s_waitcnt lgkmcnt(0)
    v_mfma_f32_32x32x16_bf16 v[120:135], v[24:27], v[76:79], v[120:135]
    v_mfma_f32_32x32x16_bf16 v[136:151], v[28:31], v[76:79], v[136:151]
    v_mfma_f32_32x32x16_bf16 v[152:167], v[32:35], v[76:79], v[152:167]
    s_cmp_eq_u32 s62, 0
    s_nop 7
    s_cbranch_scc0 G_f1
    s_nop 8
    ds_write_b128 v3, v[140:143] offset:0
    ds_write_b128 v3, v[144:147] offset:1024
    ds_write_b128 v3, v[148:151] offset:2048
    ds_write_b128 v3, v[152:155] offset:3072
    ds_write_b128 v3, v[156:159] offset:4096
    s_waitcnt vmcnt(0) lgkmcnt(0)
    s_barrier
    ds_read_b128 v[40:43], v9 offset:0
    ds_read_b128 v[44:47], v9 offset:1024
    ds_read_b128 v[48:51], v9 offset:2048
    ds_read_b128 v[52:55], v9 offset:3072
    ds_read_b128 v[56:59], v9 offset:4096
    s_waitcnt lgkmcnt(4)
    v_add_f32 v40, v40, v120
    v_add_f32 v41, v41, v121
    v_add_f32 v42, v42, v122
    v_add_f32 v43, v43, v123
    v_cvt_pk_bf16_f32 v60, v40, v41
    v_cvt_pk_bf16_f32 v61, v42, v43
    s_waitcnt lgkmcnt(3)
    v_add_f32 v44, v44, v124
    v_add_f32 v45, v45, v125
    v_add_f32 v46, v46, v126
    v_add_f32 v47, v47, v127
    v_cvt_pk_bf16_f32 v62, v44, v45
    v_cvt_pk_bf16_f32 v63, v46, v47
    s_nop 0
    v_permlane32_swap_b32 v60, v62
    v_permlane32_swap_b32 v61, v63
    buffer_store_dwordx4 v[60:63], v7, s[28:31], 0 offen offset:0
    s_waitcnt lgkmcnt(2)
    v_add_f32 v48, v48, v128
    v_add_f32 v49, v49, v129
    v_add_f32 v50, v50, v130
    v_add_f32 v51, v51, v131
    v_cvt_pk_bf16_f32 v64, v48, v49
    v_cvt_pk_bf16_f32 v65, v50, v51
    s_waitcnt lgkmcnt(1)
    v_add_f32 v52, v52, v132
    v_add_f32 v53, v53, v133
    v_add_f32 v54, v54, v134
    v_add_f32 v55, v55, v135
    v_cvt_pk_bf16_f32 v66, v52, v53
    v_cvt_pk_bf16_f32 v67, v54, v55
    s_nop 0
    v_permlane32_swap_b32 v64, v66
    v_permlane32_swap_b32 v65, v67
    buffer_store_dwordx4 v[64:67], v7, s[28:31], 0 offen offset:32
    s_waitcnt lgkmcnt(0)
    v_add_f32 v56, v56, v136
    v_add_f32 v57, v57, v137
    v_add_f32 v58, v58, v138
    v_add_f32 v59, v59, v139
    v_cvt_pk_bf16_f32 v68, v56, v57
    v_cvt_pk_bf16_f32 v69, v58, v59
    buffer_store_dwordx2 v[68:69], v8, s[28:31], 0 offen offset:64
    s_endpgm
G_f1:
    ds_write_b128 v3, v[120:123] offset:0
    ds_write_b128 v3, v[124:127] offset:1024
    ds_write_b128 v3, v[128:131] offset:2048
    ds_write_b128 v3, v[132:135] offset:3072
    ds_write_b128 v3, v[136:139] offset:4096
    s_waitcnt vmcnt(0) lgkmcnt(0)
    s_barrier
    ds_read_b128 v[40:43], v9 offset:0
    ds_read_b128 v[44:47], v9 offset:1024
    ds_read_b128 v[48:51], v9 offset:2048
    ds_read_b128 v[52:55], v9 offset:3072
    ds_read_b128 v[56:59], v9 offset:4096
    s_waitcnt lgkmcnt(4)
    v_add_f32 v40, v40, v140
    v_add_f32 v41, v41, v141
    v_add_f32 v42, v42, v142
    v_add_f32 v43, v43, v143
    v_cvt_pk_bf16_f32 v70, v40, v41
    v_cvt_pk_bf16_f32 v71, v42, v43
    buffer_store_dwordx2 v[70:71], v8, s[28:31], 0 offen offset:80
    s_waitcnt lgkmcnt(3)
    v_add_f32 v44, v44, v144
    v_add_f32 v45, v45, v145
    v_add_f32 v46, v46, v146
    v_add_f32 v47, v47, v147
    v_cvt_pk_bf16_f32 v72, v44, v45
    v_cvt_pk_bf16_f32 v73, v46, v47
    s_waitcnt lgkmcnt(2)
    v_add_f32 v48, v48, v148
    v_add_f32 v49, v49, v149
    v_add_f32 v50, v50, v150
    v_add_f32 v51, v51, v151
    v_cvt_pk_bf16_f32 v74, v48, v49
    v_cvt_pk_bf16_f32 v75, v50, v51
    s_nop 0
    v_permlane32_swap_b32 v72, v74
    v_permlane32_swap_b32 v73, v75
    buffer_store_dwordx4 v[72:75], v7, s[28:31], 0 offen offset:96
    s_waitcnt lgkmcnt(1)
    v_add_f32 v52, v52, v152
    v_add_f32 v53, v53, v153
    v_add_f32 v54, v54, v154
    v_add_f32 v55, v55, v155
    v_cvt_pk_bf16_f32 v76, v52, v53
    v_cvt_pk_bf16_f32 v77, v54, v55
    s_waitcnt lgkmcnt(0)
    v_add_f32 v56, v56, v156
    v_add_f32 v57, v57, v157
    v_add_f32 v58, v58, v158
    v_add_f32 v59, v59, v159
    v_cvt_pk_bf16_f32 v78, v56, v57
    v_cvt_pk_bf16_f32 v79, v58, v59
    s_nop 0
    v_permlane32_swap_b32 v76, v78
    v_permlane32_swap_b32 v77, v79
    buffer_store_dwordx4 v[76:79], v7, s[28:31], 0 offen offset:128
    s_endpgm
G_cd:
    buffer_load_dwordx4 v[40:43], v2, s[32:35], s50 offen offset:1024 sc1
    buffer_load_dwordx4 v[44:47], v2, s[32:35], s50 offen offset:3072 sc1
    buffer_load_dwordx4 v[48:51], v2, s[32:35], s51 offen offset:1024 sc1
    buffer_load_dwordx4 v[52:55], v2, s[32:35], s51 offen offset:3072 sc1
    buffer_load_dwordx2 v[56:57], v6, s[32:35], s50 offen offset:256 sc1
    buffer_load_dwordx2 v[58:59], v6, s[32:35], s51 offen offset:256 sc1
    buffer_load_dwordx4 v[60:63], v2, s[32:35], s52 offen offset:1024 sc1
    buffer_load_dwordx4 v[64:67], v2, s[32:35], s52 offen offset:3072 sc1
    buffer_load_dwordx4 v[68:71], v2, s[32:35], s53 offen offset:1024 sc1
    buffer_load_dwordx4 v[72:75], v2, s[32:35], s53 offen offset:3072 sc1
    buffer_load_dwordx2 v[76:77], v6, s[32:35], s52 offen offset:256 sc1
    buffer_load_dwordx2 v[78:79], v6, s[32:35], s53 offen offset:256 sc1
    s_mov_b32 s47, -1
    s_branch G_bd
G_ce:
    buffer_load_dwordx4 v[40:43], v2, s[32:35], s50 offen offset:1024 sc1
    buffer_load_dwordx4 v[44:47], v2, s[32:35], s50 offen offset:3072 sc1
    buffer_load_dwordx4 v[48:51], v2, s[32:35], s51 offen offset:1024 sc1
    buffer_load_dwordx4 v[52:55], v2, s[32:35], s51 offen offset:3072 sc1
    buffer_load_dwordx2 v[56:57], v6, s[32:35], s50 offen offset:256 sc1
    buffer_load_dwordx2 v[58:59], v6, s[32:35], s51 offen offset:256 sc1
    buffer_load_dwordx4 v[60:63], v2, s[32:35], s52 offen offset:1024 sc1
    buffer_load_dwordx4 v[64:67], v2, s[32:35], s52 offen offset:3072 sc1
    buffer_load_dwordx4 v[68:71], v2, s[32:35], s53 offen offset:1024 sc1
    buffer_load_dwordx4 v[72:75], v2, s[32:35], s53 offen offset:3072 sc1
    buffer_load_dwordx2 v[76:77], v6, s[32:35], s52 offen offset:256 sc1
    buffer_load_dwordx2 v[78:79], v6, s[32:35], s53 offen offset:256 sc1
    s_mov_b32 s47, -1
    s_branch G_be
G_r0:
    s_sub_u32 s48, s48, 1
    s_cbranch_scc1 G_x0e
    buffer_load_dwordx4 v[80:83], v2, s[32:35], s50 offen offset:0 sc1
    buffer_load_dwordx4 v[84:87], v2, s[32:35], s50 offen offset:2048 sc1
    buffer_load_dwordx4 v[88:91], v2, s[32:35], s51 offen offset:0 sc1
    buffer_load_dwordx4 v[92:95], v2, s[32:35], s51 offen offset:2048 sc1
    buffer_load_dwordx2 v[96:97], v6, s[32:35], s50 offen offset:0 sc1
    buffer_load_dwordx2 v[98:99], v6, s[32:35], s51 offen offset:0 sc1
    buffer_load_dwordx4 v[100:103], v2, s[32:35], s52 offen offset:0 sc1
    buffer_load_dwordx4 v[104:107], v2, s[32:35], s52 offen offset:2048 sc1
    buffer_load_dwordx4 v[108:111], v2, s[32:35], s53 offen offset:0 sc1
    buffer_load_dwordx4 v[112:115], v2, s[32:35], s53 offen offset:2048 sc1
    buffer_load_dwordx2 v[116:117], v6, s[32:35], s52 offen offset:0 sc1
    buffer_load_dwordx2 v[118:119], v6, s[32:35], s53 offen offset:0 sc1
    s_branch G_o0
G_x0e:
    s_mov_b32 s48, 0
    s_branch G_g0
G_r2:
    s_sub_u32 s48, s48, 1
    s_cbranch_scc1 G_x2e
    buffer_load_dwordx4 v[40:43], v2, s[32:35], s50 offen offset:1024 sc1
    buffer_load_dwordx4 v[44:47], v2, s[32:35], s50 offen offset:3072 sc1
    buffer_load_dwordx4 v[48:51], v2, s[32:35], s51 offen offset:1024 sc1
    buffer_load_dwordx4 v[52:55], v2, s[32:35], s51 offen offset:3072 sc1
    buffer_load_dwordx2 v[56:57], v6, s[32:35], s50 offen offset:256 sc1
    buffer_load_dwordx2 v[58:59], v6, s[32:35], s51 offen offset:256 sc1
    buffer_load_dwordx4 v[60:63], v2, s[32:35], s52 offen offset:1024 sc1
    buffer_load_dwordx4 v[64:67], v2, s[32:35], s52 offen offset:3072 sc1
    buffer_load_dwordx4 v[68:71], v2, s[32:35], s53 offen offset:1024 sc1
    buffer_load_dwordx4 v[72:75], v2, s[32:35], s53 offen offset:3072 sc1
    buffer_load_dwordx2 v[76:77], v6, s[32:35], s52 offen offset:256 sc1
    buffer_load_dwordx2 v[78:79], v6, s[32:35], s53 offen offset:256 sc1
    s_branch G_o2
G_x2e:
    s_mov_b32 s48, 0
    s_branch G_g2
G_r3:
    s_sub_u32 s48, s48, 1
    s_cbranch_scc1 G_x3e
    buffer_load_dwordx4 v[60:63], v2, s[32:35], s52 offen offset:1024 sc1
    buffer_load_dwordx4 v[64:67], v2, s[32:35], s52 offen offset:3072 sc1
    buffer_load_dwordx4 v[68:71], v2, s[32:35], s53 offen offset:1024 sc1
    buffer_load_dwordx4 v[72:75], v2, s[32:35], s53 offen offset:3072 sc1
    buffer_load_dwordx2 v[76:77], v6, s[32:35], s52 offen offset:256 sc1
    buffer_load_dwordx2 v[78:79], v6, s[32:35], s53 offen offset:256 sc1
    s_branch G_o3
G_x3e:
    s_mov_b32 s48, 0
    s_branch G_g3
K_ldq:
    s_and_b32 s41, s61, 1
    s_lshl_b32 s41, s41, 1
    s_mul_i32 s42, s61, 10240
    s_cmp_eq_u32 s17, 0
    s_cbranch_scc1 K_lda
    v_add_u32 v2, 0, v1
    v_mul_u32_u24 v3, 171, v2
    v_lshrrev_b32 v3, 12, v3
    v_mul_u32_u24 v9, 24, v3
    v_sub_u32 v2, v2, v9
    v_bfe_u32 v9, v3, 1, 1
    v_or_b32 v9, s41, v9
    v_lshlrev_b32 v9, 1, v9
    v_xor_b32 v2, v2, v9
    v_mul_u32_u24 v3, 1280, v3
    v_lshl_add_u32 v6, v2, 4, v3
    v_add_u32 v2, 64, v1
    v_mul_u32_u24 v3, 171, v2
    v_lshrrev_b32 v3, 12, v3
    v_mul_u32_u24 v9, 24, v3
    v_sub_u32 v2, v2, v9
    v_bfe_u32 v9, v3, 1, 1
    v_or_b32 v9, s41, v9
    v_lshlrev_b32 v9, 1, v9
    v_xor_b32 v2, v2, v9
    v_mul_u32_u24 v3, 1280, v3
    v_lshl_add_u32 v7, v2, 4, v3
    v_add_u32 v2, 128, v1
    v_mul_u32_u24 v3, 171, v2
    v_lshrrev_b32 v3, 12, v3
    v_mul_u32_u24 v9, 24, v3
    v_sub_u32 v2, v2, v9
    v_bfe_u32 v9, v3, 1, 1
    v_or_b32 v9, s41, v9
    v_lshlrev_b32 v9, 1, v9
    v_xor_b32 v2, v2, v9
    v_mul_u32_u24 v3, 1280, v3
    v_lshl_add_u32 v8, v2, 4, v3
    s_mul_i32 s41, s17, 384
    s_sub_u32 s41, s41, 256
    s_add_u32 s41, s41, s42
    s_sub_u32 s42, 819200, s41
    s_mul_i32 s44, s61, 3072
    s_waitcnt lgkmcnt(0)
    s_add_u32 s20, s4, s40
    s_addc_u32 s21, s5, 0
    s_mov_b32 s22, 163840
    s_mov_b32 s23, 0x00020000
    s_add_u32 s24, s6, s41
    s_addc_u32 s25, s7, 0
    s_mov_b32 s26, s42
    s_mov_b32 s27, 0x00020000
    s_lshl_b32 s46, s63, 7
    s_add_u32 m0, s43, 0
    s_nop 0
    buffer_load_dwordx4 v4, s[20:23], s46 offen lds
    s_add_u32 m0, s43, 1024
    s_nop 0
    buffer_load_dwordx4 v5, s[20:23], s46 offen lds
    s_add_u32 s45, s46, 20480
    s_add_u32 m0, s43, 2048
    s_nop 0
    buffer_load_dwordx4 v4, s[20:23], s45 offen lds
    s_add_u32 m0, s43, 3072
    s_nop 0
    buffer_load_dwordx4 v5, s[20:23], s45 offen lds
    s_mul_i32 s47, s63, 81920
    s_add_u32 m0, s44, 65536
    s_nop 0
    buffer_load_dwordx4 v6, s[24:27], s47 offen lds
    s_add_u32 m0, s44, 66560
    s_nop 0
    buffer_load_dwordx4 v7, s[24:27], s47 offen lds
    s_add_u32 m0, s44, 67584
    s_nop 0
    buffer_load_dwordx4 v8, s[24:27], s47 offen lds
    s_load_dwordx2 s[6:7], s[0:1], 32
    s_load_dwordx2 s[12:13], s[0:1], 64
    s_load_dwordx4 s[8:11], s[0:1], 80
    v_lshlrev_b32 v2, 2, v1
    v_add_u32 v2, 151552, v2
    v_mov_b32 v3, 0
    ds_write_b32 v2, v3
    s_add_u32 s47, s47, 40960
    s_add_u32 m0, s44, 77824
    s_nop 0
    buffer_load_dwordx4 v6, s[24:27], s47 offen lds
    s_add_u32 m0, s44, 78848
    s_nop 0
    buffer_load_dwordx4 v7, s[24:27], s47 offen lds
    s_add_u32 m0, s44, 79872
    s_nop 0
    buffer_load_dwordx4 v8, s[24:27], s47 offen lds
    s_add_u32 s46, s46, 128
    s_cmp_eq_u32 s46, 1280
    s_cselect_b32 s46, 0, s46
    s_add_u32 m0, s43, 16384
    s_nop 0
    buffer_load_dwordx4 v4, s[20:23], s46 offen lds
    s_add_u32 m0, s43, 17408
    s_nop 0
    buffer_load_dwordx4 v5, s[20:23], s46 offen lds
    s_add_u32 s45, s46, 20480
    s_add_u32 m0, s43, 18432
    s_nop 0
    buffer_load_dwordx4 v4, s[20:23], s45 offen lds
    s_add_u32 m0, s43, 19456
    s_nop 0
    buffer_load_dwordx4 v5, s[20:23], s45 offen lds
    s_add_u32 s47, s47, 40960
    s_cmp_eq_u32 s47, 819200
    s_cselect_b32 s47, 0, s47
    s_add_u32 m0, s44, 90112
    s_nop 0
    buffer_load_dwordx4 v6, s[24:27], s47 offen lds
    s_add_u32 m0, s44, 91136
    s_nop 0
    buffer_load_dwordx4 v7, s[24:27], s47 offen lds
    s_add_u32 m0, s44, 92160
    s_nop 0
    buffer_load_dwordx4 v8, s[24:27], s47 offen lds
    s_waitcnt vmcnt(10) lgkmcnt(0)
    s_barrier
    s_add_u32 s47, s47, 40960
    s_add_u32 m0, s44, 102400
    s_nop 0
    buffer_load_dwordx4 v6, s[24:27], s47 offen lds
    s_add_u32 m0, s44, 103424
    s_nop 0
    buffer_load_dwordx4 v7, s[24:27], s47 offen lds
    s_add_u32 m0, s44, 104448
    s_nop 0
    buffer_load_dwordx4 v8, s[24:27], s47 offen lds
    s_add_u32 s46, s46, 128
    s_cmp_eq_u32 s46, 1280
    s_cselect_b32 s46, 0, s46
    s_add_u32 m0, s43, 32768
    s_nop 0
    buffer_load_dwordx4 v4, s[20:23], s46 offen lds
    s_add_u32 m0, s43, 33792
    s_nop 0
    buffer_load_dwordx4 v5, s[20:23], s46 offen lds
    s_waitcnt vmcnt(12)
    s_barrier
    s_add_u32 s45, s46, 20480
    s_add_u32 m0, s43, 34816
    s_nop 0
    buffer_load_dwordx4 v4, s[20:23], s45 offen lds
    s_add_u32 m0, s43, 35840
    s_nop 0
    buffer_load_dwordx4 v5, s[20:23], s45 offen lds
    s_add_u32 s47, s47, 40960
    s_cmp_eq_u32 s47, 819200
    s_cselect_b32 s47, 0, s47
    s_add_u32 m0, s44, 114688
    s_nop 0
    buffer_load_dwordx4 v6, s[24:27], s47 offen lds
    s_add_u32 m0, s44, 115712
    s_nop 0
    buffer_load_dwordx4 v7, s[24:27], s47 offen lds
    s_add_u32 m0, s44, 116736
    s_nop 0
    buffer_load_dwordx4 v8, s[24:27], s47 offen lds
    s_waitcnt vmcnt(10)
    s_barrier
    s_add_u32 s47, s47, 40960
    s_add_u32 m0, s44, 65536
    s_nop 0
    buffer_load_dwordx4 v6, s[24:27], s47 offen lds
    s_add_u32 m0, s44, 66560
    s_nop 0
    buffer_load_dwordx4 v7, s[24:27], s47 offen lds
    s_add_u32 m0, s44, 67584
    s_nop 0
    buffer_load_dwordx4 v8, s[24:27], s47 offen lds
    s_add_u32 s46, s46, 128
    s_cmp_eq_u32 s46, 1280
    s_cselect_b32 s46, 0, s46
    s_add_u32 m0, s43, 49152
    s_nop 0
    buffer_load_dwordx4 v4, s[20:23], s46 offen lds
    s_add_u32 m0, s43, 50176
    s_nop 0
    buffer_load_dwordx4 v5, s[20:23], s46 offen lds
    s_waitcnt vmcnt(12)
    s_barrier
    s_add_u32 s45, s46, 20480
    s_add_u32 m0, s43, 51200
    s_nop 0
    buffer_load_dwordx4 v4, s[20:23], s45 offen lds
    s_add_u32 m0, s43, 52224
    s_nop 0
    buffer_load_dwordx4 v5, s[20:23], s45 offen lds
    s_add_u32 s47, s47, 40960
    s_cmp_eq_u32 s47, 819200
    s_cselect_b32 s47, 0, s47
    s_add_u32 m0, s44, 77824
    s_nop 0
    buffer_load_dwordx4 v6, s[24:27], s47 offen lds
    s_add_u32 m0, s44, 78848
    s_nop 0
    buffer_load_dwordx4 v7, s[24:27], s47 offen lds
    s_add_u32 m0, s44, 79872
    s_nop 0
    buffer_load_dwordx4 v8, s[24:27], s47 offen lds
    s_waitcnt vmcnt(10)
    s_barrier
    s_add_u32 s47, s47, 40960
    s_add_u32 m0, s44, 90112
    s_nop 0
    buffer_load_dwordx4 v6, s[24:27], s47 offen lds
    s_add_u32 m0, s44, 91136
    s_nop 0
    buffer_load_dwordx4 v7, s[24:27], s47 offen lds
    s_add_u32 m0, s44, 92160
    s_nop 0
    buffer_load_dwordx4 v8, s[24:27], s47 offen lds
    s_add_u32 s46, s46, 128
    s_cmp_eq_u32 s46, 1280
    s_cselect_b32 s46, 0, s46
    s_add_u32 m0, s43, 0
    s_nop 0
    buffer_load_dwordx4 v4, s[20:23], s46 offen lds
    s_add_u32 m0, s43, 1024
    s_nop 0
    buffer_load_dwordx4 v5, s[20:23], s46 offen lds
    s_waitcnt vmcnt(12)
    s_barrier
    s_add_u32 s45, s46, 20480
    s_add_u32 m0, s43, 2048
    s_nop 0
    buffer_load_dwordx4 v4, s[20:23], s45 offen lds
    s_add_u32 m0, s43, 3072
    s_nop 0
    buffer_load_dwordx4 v5, s[20:23], s45 offen lds
    s_add_u32 s47, s47, 40960
    s_cmp_eq_u32 s47, 819200
    s_cselect_b32 s47, 0, s47
    s_add_u32 m0, s44, 102400
    s_nop 0
    buffer_load_dwordx4 v6, s[24:27], s47 offen lds
    s_add_u32 m0, s44, 103424
    s_nop 0
    buffer_load_dwordx4 v7, s[24:27], s47 offen lds
    s_add_u32 m0, s44, 104448
    s_nop 0
    buffer_load_dwordx4 v8, s[24:27], s47 offen lds
    s_waitcnt vmcnt(10)
    s_barrier
    s_add_u32 s47, s47, 40960
    s_add_u32 m0, s44, 114688
    s_nop 0
    buffer_load_dwordx4 v6, s[24:27], s47 offen lds
    s_add_u32 m0, s44, 115712
    s_nop 0
    buffer_load_dwordx4 v7, s[24:27], s47 offen lds
    s_add_u32 m0, s44, 116736
    s_nop 0
    buffer_load_dwordx4 v8, s[24:27], s47 offen lds
    s_add_u32 s46, s46, 128
    s_cmp_eq_u32 s46, 1280
    s_cselect_b32 s46, 0, s46
    s_add_u32 m0, s43, 16384
    s_nop 0
    buffer_load_dwordx4 v4, s[20:23], s46 offen lds
    s_add_u32 m0, s43, 17408
    s_nop 0
    buffer_load_dwordx4 v5, s[20:23], s46 offen lds
    s_waitcnt vmcnt(12)
    s_barrier
    s_add_u32 s45, s46, 20480
    s_add_u32 m0, s43, 18432
    s_nop 0
    buffer_load_dwordx4 v4, s[20:23], s45 offen lds
    s_add_u32 m0, s43, 19456
    s_nop 0
    buffer_load_dwordx4 v5, s[20:23], s45 offen lds
    s_add_u32 s47, s47, 40960
    s_cmp_eq_u32 s47, 819200
    s_cselect_b32 s47, 0, s47
    s_add_u32 m0, s44, 65536
    s_nop 0
    buffer_load_dwordx4 v6, s[24:27], s47 offen lds
    s_add_u32 m0, s44, 66560
    s_nop 0
    buffer_load_dwordx4 v7, s[24:27], s47 offen lds
    s_add_u32 m0, s44, 67584
    s_nop 0
    buffer_load_dwordx4 v8, s[24:27], s47 offen lds
    s_waitcnt vmcnt(10)
    s_barrier
    s_add_u32 s47, s47, 40960
    s_add_u32 m0, s44, 77824
    s_nop 0
    buffer_load_dwordx4 v6, s[24:27], s47 offen lds
    s_add_u32 m0, s44, 78848
    s_nop 0
    buffer_load_dwordx4 v7, s[24:27], s47 offen lds
    s_add_u32 m0, s44, 79872
    s_nop 0
    buffer_load_dwordx4 v8, s[24:27], s47 offen lds
    s_add_u32 s46, s46, 128
    s_cmp_eq_u32 s46, 1280
    s_cselect_b32 s46, 0, s46
    s_add_u32 m0, s43, 32768
    s_nop 0
    buffer_load_dwordx4 v4, s[20:23], s46 offen lds
    s_add_u32 m0, s43, 33792
    s_nop 0
    buffer_load_dwordx4 v5, s[20:23], s46 offen lds
    s_waitcnt vmcnt(12)
    s_barrier
    s_add_u32 s45, s46, 20480
    s_add_u32 m0, s43, 34816
    s_nop 0
    buffer_load_dwordx4 v4, s[20:23], s45 offen lds
    s_add_u32 m0, s43, 35840
    s_nop 0
    buffer_load_dwordx4 v5, s[20:23], s45 offen lds
    s_add_u32 s47, s47, 40960
    s_cmp_eq_u32 s47, 819200
    s_cselect_b32 s47, 0, s47
    s_add_u32 m0, s44, 90112
    s_nop 0
    buffer_load_dwordx4 v6, s[24:27], s47 offen lds
    s_add_u32 m0, s44, 91136
    s_nop 0
    buffer_load_dwordx4 v7, s[24:27], s47 offen lds
    s_add_u32 m0, s44, 92160
    s_nop 0
    buffer_load_dwordx4 v8, s[24:27], s47 offen lds
    s_waitcnt vmcnt(10)
    s_barrier
    s_add_u32 s47, s47, 40960
    s_add_u32 m0, s44, 102400
    s_nop 0
    buffer_load_dwordx4 v6, s[24:27], s47 offen lds
    s_add_u32 m0, s44, 103424
    s_nop 0
    buffer_load_dwordx4 v7, s[24:27], s47 offen lds
    s_add_u32 m0, s44, 104448
    s_nop 0
    buffer_load_dwordx4 v8, s[24:27], s47 offen lds
    s_add_u32 s46, s46, 128
    s_cmp_eq_u32 s46, 1280
    s_cselect_b32 s46, 0, s46
    s_add_u32 m0, s43, 49152
    s_nop 0
    buffer_load_dwordx4 v4, s[20:23], s46 offen lds
    s_add_u32 m0, s43, 50176
    s_nop 0
    buffer_load_dwordx4 v5, s[20:23], s46 offen lds
    s_load_dword s48, s[10:11], 0
    s_waitcnt vmcnt(12)
    s_barrier
    s_add_u32 s45, s46, 20480
    s_add_u32 m0, s43, 51200
    s_nop 0
    buffer_load_dwordx4 v4, s[20:23], s45 offen lds
    s_add_u32 m0, s43, 52224
    s_nop 0
    buffer_load_dwordx4 v5, s[20:23], s45 offen lds
    s_add_u32 s47, s47, 40960
    s_cmp_eq_u32 s47, 819200
    s_cselect_b32 s47, 0, s47
    s_add_u32 m0, s44, 114688
    s_nop 0
    buffer_load_dwordx4 v6, s[24:27], s47 offen lds
    s_add_u32 m0, s44, 115712
    s_nop 0
    buffer_load_dwordx4 v7, s[24:27], s47 offen lds
    s_add_u32 m0, s44, 116736
    s_nop 0
    buffer_load_dwordx4 v8, s[24:27], s47 offen lds
    s_waitcnt vmcnt(10)
    s_barrier
    s_add_u32 s47, s47, 40960
    s_add_u32 m0, s44, 65536
    s_nop 0
    buffer_load_dwordx4 v6, s[24:27], s47 offen lds
    s_add_u32 m0, s44, 66560
    s_nop 0
    buffer_load_dwordx4 v7, s[24:27], s47 offen lds
    s_add_u32 m0, s44, 67584
    s_nop 0
    buffer_load_dwordx4 v8, s[24:27], s47 offen lds
    s_add_u32 s46, s46, 128
    s_cmp_eq_u32 s46, 1280
    s_cselect_b32 s46, 0, s46
    s_add_u32 m0, s43, 0
    s_nop 0
    buffer_load_dwordx4 v4, s[20:23], s46 offen lds
    s_add_u32 m0, s43, 1024
    s_nop 0
    buffer_load_dwordx4 v5, s[20:23], s46 offen lds
    s_waitcnt vmcnt(12)
    s_barrier
    s_add_u32 s45, s46, 20480
    s_add_u32 m0, s43, 2048
    s_nop 0
    buffer_load_dwordx4 v4, s[20:23], s45 offen lds
    s_add_u32 m0, s43, 3072
    s_nop 0
    buffer_load_dwordx4 v5, s[20:23], s45 offen lds
    s_add_u32 s47, s47, 40960
    s_cmp_eq_u32 s47, 819200
    s_cselect_b32 s47, 0, s47
    s_add_u32 m0, s44, 77824
    s_nop 0
    buffer_load_dwordx4 v6, s[24:27], s47 offen lds
    s_add_u32 m0, s44, 78848
    s_nop 0
    buffer_load_dwordx4 v7, s[24:27], s47 offen lds
    s_add_u32 m0, s44, 79872
    s_nop 0
    buffer_load_dwordx4 v8, s[24:27], s47 offen lds
    s_waitcnt lgkmcnt(0)
    s_cmp_ge_u32 s48, 64
    s_cbranch_scc0 LQ_slow
LQ_back:
    s_waitcnt vmcnt(10)
    s_barrier
    s_add_u32 s47, s47, 40960
    s_add_u32 m0, s44, 90112
    s_nop 0
    buffer_load_dwordx4 v6, s[24:27], s47 offen lds
    s_add_u32 m0, s44, 91136
    s_nop 0
    buffer_load_dwordx4 v7, s[24:27], s47 offen lds
    s_add_u32 m0, s44, 92160
    s_nop 0
    buffer_load_dwordx4 v8, s[24:27], s47 offen lds
    s_add_u32 s46, s46, 128
    s_cmp_eq_u32 s46, 1280
    s_cselect_b32 s46, 0, s46
    s_add_u32 m0, s43, 16384
    s_nop 0
    buffer_load_dwordx4 v4, s[20:23], s46 offen lds
    s_add_u32 m0, s43, 17408
    s_nop 0
    buffer_load_dwordx4 v5, s[20:23], s46 offen lds
    s_waitcnt vmcnt(12)
    s_barrier
    s_add_u32 s45, s46, 20480
    s_add_u32 m0, s43, 18432
    s_nop 0
    buffer_load_dwordx4 v4, s[20:23], s45 offen lds
    s_add_u32 m0, s43, 19456
    s_nop 0
    buffer_load_dwordx4 v5, s[20:23], s45 offen lds
    s_add_u32 s47, s47, 40960
    s_cmp_eq_u32 s47, 819200
    s_cselect_b32 s47, 0, s47
    s_add_u32 m0, s44, 102400
    s_nop 0
    buffer_load_dwordx4 v6, s[24:27], s47 offen lds
    s_add_u32 m0, s44, 103424
    s_nop 0
    buffer_load_dwordx4 v7, s[24:27], s47 offen lds
    s_add_u32 m0, s44, 104448
    s_nop 0
    buffer_load_dwordx4 v8, s[24:27], s47 offen lds
    s_waitcnt vmcnt(10)
    s_barrier
    s_add_u32 s47, s47, 40960
    s_add_u32 m0, s44, 114688
    s_nop 0
    buffer_load_dwordx4 v6, s[24:27], s47 offen lds
    s_add_u32 m0, s44, 115712
    s_nop 0
    buffer_load_dwordx4 v7, s[24:27], s47 offen lds
    s_add_u32 m0, s44, 116736
    s_nop 0
    buffer_load_dwordx4 v8, s[24:27], s47 offen lds
    s_waitcnt vmcnt(10)
    s_barrier
    s_lshr_b32 s42, s54, 1
    s_lshl_b32 s40, s42, 10
    s_add_u32 s40, s40, 3473408
    s_lshr_b32 s63, s55, 1
    s_lshl_b32 s63, s63, 8
    s_add_u32 s63, s63, s40
    s_lshl_b32 s40, s16, 10
    s_add_u32 s40, s40, 3473408
    s_lshl_b32 s56, s17, 2
    s_add_u32 s56, s56, s60
    s_lshl_b32 s56, s56, 2
    s_add_u32 s56, s56, s40
    s_mul_i32 s48, s17, 3
    s_add_u32 s48, s48, s60
    s_lshl_b32 s48, s48, 3
    s_mul_i32 s41, s16, 384
    s_add_u32 s48, s48, s41
    s_bfe_u32 s41, s18, 0x10001
    s_mul_i32 s41, s41, 192
    s_add_u32 s48, s48, s41
    s_and_b32 s41, s18, 1
    s_lshl_b32 s41, s41, 2
    s_add_u32 s48, s48, s41
    s_lshl_b32 s48, s48, 10
    s_add_u32 s48, s48, 4194304
    s_cmp_eq_u32 s60, 3
    s_cselect_b32 s48, 0, s48
    s_lshl_b32 s41, s55, 2
    s_lshr_b32 s47, 0x88c46222, s41
    s_and_b32 s47, s47, 15
    s_lshl_b32 s47, s47, 16
    s_bitset1_b32 s47, s42
    s_sub_u32 s60, s18, 8
    s_and_b32 s61, s60, 1
    s_lshr_b32 s62, s60, 1
    s_lshl_b32 s46, s54, 1
    s_add_u32 s46, s46, s61
    v_lshlrev_b32 v38, 4, v1
    v_lshlrev_b32 v39, 2, v1
    s_mov_b32 s32, s14
    s_mov_b32 s33, s15
    s_mov_b32 s34, 16777216
    s_mov_b32 s35, 0x00020000
    s_waitcnt vmcnt(3)
    s_barrier
    s_branch G_common
K_lda:
    v_lshrrev_b32 v3, 3, v1
    v_and_b32 v2, 7, v1
    v_bfe_u32 v9, v3, 1, 1
    v_or_b32 v9, s41, v9
    v_lshlrev_b32 v9, 1, v9
    v_xor_b32 v2, v2, v9
    v_mul_u32_u24 v3, 1280, v3
    v_lshl_add_u32 v6, v2, 4, v3
    s_mul_i32 s41, s41, 320
    v_lshlrev_b32 v2, 4, v1
    v_add_u32 v7, s41, v2
    s_mul_i32 s50, s61, 320
    s_lshl_b32 s41, s63, 7
    s_add_u32 s41, s41, s50
    v_add_u32 v2, s41, v2
    v_subrev_u32 v3, 1280, v2
    v_min_u32 v8, v2, v3
    s_sub_u32 s41, 819200, s42
    s_lshl_b32 s44, s61, 10
    s_lshl_b32 s51, s50, 1
    s_waitcnt lgkmcnt(0)
    s_add_u32 s20, s4, s40
    s_addc_u32 s21, s5, 0
    s_mov_b32 s22, 163840
    s_mov_b32 s23, 0x00020000
    s_add_u32 s24, s6, s42
    s_addc_u32 s25, s7, 0
    s_mov_b32 s26, s41
    s_mov_b32 s27, 0x00020000
    s_cmp_lt_u32 s61, 2
    s_cselect_b32 s28, s8, s10
    s_cselect_b32 s29, s9, s11
    s_mov_b32 s30, 25600
    s_mov_b32 s31, 0x00020000
    s_mov_b32 s36, s12
    s_mov_b32 s37, s13
    s_mov_b32 s38, 1280
    s_mov_b32 s39, 0x00020000
    s_lshl_b32 s46, s63, 7
    s_add_u32 m0, s43, 0
    s_nop 0
    buffer_load_dwordx4 v4, s[20:23], s46 offen lds
    s_add_u32 m0, s43, 1024
    s_nop 0
    buffer_load_dwordx4 v5, s[20:23], s46 offen lds
    s_add_u32 s45, s46, 20480
    s_add_u32 m0, s43, 2048
    s_nop 0
    buffer_load_dwordx4 v4, s[20:23], s45 offen lds
    s_add_u32 m0, s43, 3072
    s_nop 0
    buffer_load_dwordx4 v5, s[20:23], s45 offen lds
    s_mul_i32 s47, s63, 81920
    s_add_u32 m0, s44, 65536
    s_nop 0
    buffer_load_dwordx4 v6, s[24:27], s47 offen lds
    s_add_u32 m0, s51, 69632
    s_lshr_b32 s45, s47, 5
    s_mov_b32 exec_hi, 0xff
    buffer_load_dwordx4 v7, s[28:31], s45 offen lds
    s_add_u32 m0, s50, 98816
    s_mov_b64 exec, 0xfffff
    buffer_load_dwordx4 v8, s[36:39], 0 offen lds
    s_mov_b32 exec_lo, -1
    s_mov_b32 exec_hi, -1
    s_load_dwordx2 s[6:7], s[0:1], 32
    s_load_dwordx2 s[12:13], s[0:1], 64
    s_load_dwordx4 s[8:11], s[0:1], 80
    v_lshlrev_b32 v2, 2, v1
    v_add_u32 v2, 151552, v2
    v_mov_b32 v3, 0
    ds_write_b32 v2, v3
    s_add_u32 s47, s47, 40960
    s_add_u32 m0, s44, 72192
    s_nop 0
    buffer_load_dwordx4 v6, s[24:27], s47 offen lds
    s_add_u32 m0, s51, 76288
    s_lshr_b32 s45, s47, 5
    s_mov_b32 exec_hi, 0xff
    buffer_load_dwordx4 v7, s[28:31], s45 offen lds
    s_mov_b32 exec_hi, -1
    s_add_u32 s46, s46, 128
    s_cmp_eq_u32 s46, 1280
    s_cselect_b32 s46, 0, s46
    s_add_u32 m0, s43, 16384
    s_nop 0
    buffer_load_dwordx4 v4, s[20:23], s46 offen lds
    s_add_u32 m0, s43, 17408
    s_nop 0
    buffer_load_dwordx4 v5, s[20:23], s46 offen lds
    s_add_u32 s45, s46, 20480
    s_add_u32 m0, s43, 18432
    s_nop 0
    buffer_load_dwordx4 v4, s[20:23], s45 offen lds
    s_add_u32 m0, s43, 19456
    s_nop 0
    buffer_load_dwordx4 v5, s[20:23], s45 offen lds
    s_add_u32 s47, s47, 40960
    s_cmp_eq_u32 s47, 819200
    s_cselect_b32 s47, 0, s47
    s_add_u32 m0, s44, 78848
    s_nop 0
    buffer_load_dwordx4 v6, s[24:27], s47 offen lds
    s_add_u32 m0, s51, 82944
    s_lshr_b32 s45, s47, 5
    s_mov_b32 exec_hi, 0xff
    buffer_load_dwordx4 v7, s[28:31], s45 offen lds
    s_mov_b32 exec_hi, -1
    s_add_u32 s47, s47, 40960
    s_add_u32 m0, s44, 85504
    s_nop 0
    buffer_load_dwordx4 v6, s[24:27], s47 offen lds
    s_add_u32 m0, s51, 89600
    s_lshr_b32 s45, s47, 5
    s_mov_b32 exec_hi, 0xff
    buffer_load_dwordx4 v7, s[28:31], s45 offen lds
    s_mov_b32 exec_hi, -1
    s_add_u32 s46, s46, 128
    s_cmp_eq_u32 s46, 1280
    s_cselect_b32 s46, 0, s46
    s_add_u32 m0, s43, 32768
    s_nop 0
    buffer_load_dwordx4 v4, s[20:23], s46 offen lds
    s_add_u32 m0, s43, 33792
    s_nop 0
    buffer_load_dwordx4 v5, s[20:23], s46 offen lds
    s_waitcnt vmcnt(12) lgkmcnt(0)
    s_barrier
    s_add_u32 s45, s46, 20480
    s_add_u32 m0, s43, 34816
    s_nop 0
    buffer_load_dwordx4 v4, s[20:23], s45 offen lds
    s_add_u32 m0, s43, 35840
    s_nop 0
    buffer_load_dwordx4 v5, s[20:23], s45 offen lds
    s_add_u32 s47, s47, 40960
    s_cmp_eq_u32 s47, 819200
    s_cselect_b32 s47, 0, s47
    s_add_u32 m0, s44, 92160
    s_nop 0
    buffer_load_dwordx4 v6, s[24:27], s47 offen lds
    s_add_u32 m0, s51, 96256
    s_lshr_b32 s45, s47, 5
    s_mov_b32 exec_hi, 0xff
    buffer_load_dwordx4 v7, s[28:31], s45 offen lds
    s_mov_b32 exec_hi, -1
    s_waitcnt vmcnt(14)
    s_barrier
    s_add_u32 s47, s47, 40960
    s_add_u32 m0, s44, 65536
    s_nop 0
    buffer_load_dwordx4 v6, s[24:27], s47 offen lds
    s_add_u32 m0, s51, 69632
    s_lshr_b32 s45, s47, 5
    s_mov_b32 exec_hi, 0xff
    buffer_load_dwordx4 v7, s[28:31], s45 offen lds
    s_mov_b32 exec_hi, -1
    s_add_u32 s46, s46, 128
    s_cmp_eq_u32 s46, 1280
    s_cselect_b32 s46, 0, s46
    s_add_u32 m0, s43, 49152
    s_nop 0
    buffer_load_dwordx4 v4, s[20:23], s46 offen lds
    s_add_u32 m0, s43, 50176
    s_nop 0
    buffer_load_dwordx4 v5, s[20:23], s46 offen lds
    s_waitcnt vmcnt(12)
    s_barrier
    s_add_u32 s45, s46, 20480
    s_add_u32 m0, s43, 51200
    s_nop 0
    buffer_load_dwordx4 v4, s[20:23], s45 offen lds
    s_add_u32 m0, s43, 52224
    s_nop 0
    buffer_load_dwordx4 v5, s[20:23], s45 offen lds
    s_add_u32 s47, s47, 40960
    s_cmp_eq_u32 s47, 819200
    s_cselect_b32 s47, 0, s47
    s_add_u32 m0, s44, 72192
    s_nop 0
    buffer_load_dwordx4 v6, s[24:27], s47 offen lds
    s_add_u32 m0, s51, 76288
    s_lshr_b32 s45, s47, 5
    s_mov_b32 exec_hi, 0xff
    buffer_load_dwordx4 v7, s[28:31], s45 offen lds
    s_mov_b32 exec_hi, -1
    s_waitcnt vmcnt(14)
    s_barrier
    s_add_u32 s47, s47, 40960
    s_add_u32 m0, s44, 78848
    s_nop 0
    buffer_load_dwordx4 v6, s[24:27], s47 offen lds
    s_add_u32 m0, s51, 82944
    s_lshr_b32 s45, s47, 5
    s_mov_b32 exec_hi, 0xff
    buffer_load_dwordx4 v7, s[28:31], s45 offen lds
    s_mov_b32 exec_hi, -1
    s_add_u32 s46, s46, 128
    s_cmp_eq_u32 s46, 1280
    s_cselect_b32 s46, 0, s46
    s_add_u32 m0, s43, 0
    s_nop 0
    buffer_load_dwordx4 v4, s[20:23], s46 offen lds
    s_add_u32 m0, s43, 1024
    s_nop 0
    buffer_load_dwordx4 v5, s[20:23], s46 offen lds
    s_waitcnt vmcnt(12)
    s_barrier
    s_add_u32 s45, s46, 20480
    s_add_u32 m0, s43, 2048
    s_nop 0
    buffer_load_dwordx4 v4, s[20:23], s45 offen lds
    s_add_u32 m0, s43, 3072
    s_nop 0
    buffer_load_dwordx4 v5, s[20:23], s45 offen lds
    s_add_u32 s47, s47, 40960
    s_cmp_eq_u32 s47, 819200
    s_cselect_b32 s47, 0, s47
    s_add_u32 m0, s44, 85504
    s_nop 0
    buffer_load_dwordx4 v6, s[24:27], s47 offen lds
    s_add_u32 m0, s51, 89600
    s_lshr_b32 s45, s47, 5
    s_mov_b32 exec_hi, 0xff
    buffer_load_dwordx4 v7, s[28:31], s45 offen lds
    s_mov_b32 exec_hi, -1
    s_waitcnt vmcnt(14)
    s_barrier
    s_add_u32 s47, s47, 40960
    s_add_u32 m0, s44, 92160
    s_nop 0
    buffer_load_dwordx4 v6, s[24:27], s47 offen lds
    s_add_u32 m0, s51, 96256
    s_lshr_b32 s45, s47, 5
    s_mov_b32 exec_hi, 0xff
    buffer_load_dwordx4 v7, s[28:31], s45 offen lds
    s_mov_b32 exec_hi, -1
    s_add_u32 s46, s46, 128
    s_cmp_eq_u32 s46, 1280
    s_cselect_b32 s46, 0, s46
    s_add_u32 m0, s43, 16384
    s_nop 0
    buffer_load_dwordx4 v4, s[20:23], s46 offen lds
    s_add_u32 m0, s43, 17408
    s_nop 0
    buffer_load_dwordx4 v5, s[20:23], s46 offen lds
    s_waitcnt vmcnt(12)
    s_barrier
    s_add_u32 s45, s46, 20480
    s_add_u32 m0, s43, 18432
    s_nop 0
    buffer_load_dwordx4 v4, s[20:23], s45 offen lds
    s_add_u32 m0, s43, 19456
    s_nop 0
    buffer_load_dwordx4 v5, s[20:23], s45 offen lds
    s_add_u32 s47, s47, 40960
    s_cmp_eq_u32 s47, 819200
    s_cselect_b32 s47, 0, s47
    s_add_u32 m0, s44, 65536
    s_nop 0
    buffer_load_dwordx4 v6, s[24:27], s47 offen lds
    s_add_u32 m0, s51, 69632
    s_lshr_b32 s45, s47, 5
    s_mov_b32 exec_hi, 0xff
    buffer_load_dwordx4 v7, s[28:31], s45 offen lds
    s_mov_b32 exec_hi, -1
    s_waitcnt vmcnt(14)
    s_barrier
    s_add_u32 s47, s47, 40960
    s_add_u32 m0, s44, 72192
    s_nop 0
    buffer_load_dwordx4 v6, s[24:27], s47 offen lds
    s_add_u32 m0, s51, 76288
    s_lshr_b32 s45, s47, 5
    s_mov_b32 exec_hi, 0xff
    buffer_load_dwordx4 v7, s[28:31], s45 offen lds
    s_mov_b32 exec_hi, -1
    s_add_u32 s46, s46, 128
    s_cmp_eq_u32 s46, 1280
    s_cselect_b32 s46, 0, s46
    s_add_u32 m0, s43, 32768
    s_nop 0
    buffer_load_dwordx4 v4, s[20:23], s46 offen lds
    s_add_u32 m0, s43, 33792
    s_nop 0
    buffer_load_dwordx4 v5, s[20:23], s46 offen lds
    s_waitcnt vmcnt(12)
    s_barrier
    s_add_u32 s45, s46, 20480
    s_add_u32 m0, s43, 34816
    s_nop 0
    buffer_load_dwordx4 v4, s[20:23], s45 offen lds
    s_add_u32 m0, s43, 35840
    s_nop 0
    buffer_load_dwordx4 v5, s[20:23], s45 offen lds
    s_add_u32 s47, s47, 40960
    s_cmp_eq_u32 s47, 819200
    s_cselect_b32 s47, 0, s47
    s_add_u32 m0, s44, 78848
    s_nop 0
    buffer_load_dwordx4 v6, s[24:27], s47 offen lds
    s_add_u32 m0, s51, 82944
    s_lshr_b32 s45, s47, 5
    s_mov_b32 exec_hi, 0xff
    buffer_load_dwordx4 v7, s[28:31], s45 offen lds
    s_mov_b32 exec_hi, -1
    s_waitcnt vmcnt(14)
    s_barrier
    s_add_u32 s47, s47, 40960
    s_add_u32 m0, s44, 85504
    s_nop 0
    buffer_load_dwordx4 v6, s[24:27], s47 offen lds
    s_add_u32 m0, s51, 89600
    s_lshr_b32 s45, s47, 5
    s_mov_b32 exec_hi, 0xff
    buffer_load_dwordx4 v7, s[28:31], s45 offen lds
    s_mov_b32 exec_hi, -1
    s_add_u32 s46, s46, 128
    s_cmp_eq_u32 s46, 1280
    s_cselect_b32 s46, 0, s46
    s_add_u32 m0, s43, 49152
    s_nop 0
    buffer_load_dwordx4 v4, s[20:23], s46 offen lds
    s_add_u32 m0, s43, 50176
    s_nop 0
    buffer_load_dwordx4 v5, s[20:23], s46 offen lds
    s_waitcnt vmcnt(12)
    s_barrier
    s_add_u32 s45, s46, 20480
    s_add_u32 m0, s43, 51200
    s_nop 0
    buffer_load_dwordx4 v4, s[20:23], s45 offen lds
    s_add_u32 m0, s43, 52224
    s_nop 0
    buffer_load_dwordx4 v5, s[20:23], s45 offen lds
    s_add_u32 s47, s47, 40960
    s_cmp_eq_u32 s47, 819200
    s_cselect_b32 s47, 0, s47
    s_add_u32 m0, s44, 92160
    s_nop 0
    buffer_load_dwordx4 v6, s[24:27], s47 offen lds
    s_add_u32 m0, s51, 96256
    s_lshr_b32 s45, s47, 5
    s_mov_b32 exec_hi, 0xff
    buffer_load_dwordx4 v7, s[28:31], s45 offen lds
    s_mov_b32 exec_hi, -1
    s_waitcnt vmcnt(14)
    s_barrier
    s_add_u32 s47, s47, 40960
    s_add_u32 m0, s44, 65536
    s_nop 0
    buffer_load_dwordx4 v6, s[24:27], s47 offen lds
    s_add_u32 m0, s51, 69632
    s_lshr_b32 s45, s47, 5
    s_mov_b32 exec_hi, 0xff
    buffer_load_dwordx4 v7, s[28:31], s45 offen lds
    s_mov_b32 exec_hi, -1
    s_add_u32 s46, s46, 128
    s_cmp_eq_u32 s46, 1280
    s_cselect_b32 s46, 0, s46
    s_add_u32 m0, s43, 0
    s_nop 0
    buffer_load_dwordx4 v4, s[20:23], s46 offen lds
    s_add_u32 m0, s43, 1024
    s_nop 0
    buffer_load_dwordx4 v5, s[20:23], s46 offen lds
    s_waitcnt vmcnt(12)
    s_barrier
    s_add_u32 s45, s46, 20480
    s_add_u32 m0, s43, 2048
    s_nop 0
    buffer_load_dwordx4 v4, s[20:23], s45 offen lds
    s_add_u32 m0, s43, 3072
    s_nop 0
    buffer_load_dwordx4 v5, s[20:23], s45 offen lds
    s_add_u32 s47, s47, 40960
    s_cmp_eq_u32 s47, 819200
    s_cselect_b32 s47, 0, s47
    s_add_u32 m0, s44, 72192
    s_nop 0
    buffer_load_dwordx4 v6, s[24:27], s47 offen lds
    s_add_u32 m0, s51, 76288
    s_lshr_b32 s45, s47, 5
    s_mov_b32 exec_hi, 0xff
    buffer_load_dwordx4 v7, s[28:31], s45 offen lds
    s_mov_b32 exec_hi, -1
    s_waitcnt vmcnt(14)
    s_barrier
    s_add_u32 s47, s47, 40960
    s_add_u32 m0, s44, 78848
    s_nop 0
    buffer_load_dwordx4 v6, s[24:27], s47 offen lds
    s_add_u32 m0, s51, 82944
    s_lshr_b32 s45, s47, 5
    s_mov_b32 exec_hi, 0xff
    buffer_load_dwordx4 v7, s[28:31], s45 offen lds
    s_mov_b32 exec_hi, -1
    s_add_u32 s46, s46, 128
    s_cmp_eq_u32 s46, 1280
    s_cselect_b32 s46, 0, s46
    s_add_u32 m0, s43, 16384
    s_nop 0
    buffer_load_dwordx4 v4, s[20:23], s46 offen lds
    s_add_u32 m0, s43, 17408
    s_nop 0
    buffer_load_dwordx4 v5, s[20:23], s46 offen lds
    s_waitcnt vmcnt(12)
    s_barrier
    s_add_u32 s45, s46, 20480
    s_add_u32 m0, s43, 18432
    s_nop 0
    buffer_load_dwordx4 v4, s[20:23], s45 offen lds
    s_add_u32 m0, s43, 19456
    s_nop 0
    buffer_load_dwordx4 v5, s[20:23], s45 offen lds
    s_add_u32 s47, s47, 40960
    s_cmp_eq_u32 s47, 819200
    s_cselect_b32 s47, 0, s47
    s_add_u32 m0, s44, 85504
    s_nop 0
    buffer_load_dwordx4 v6, s[24:27], s47 offen lds
    s_add_u32 m0, s51, 89600
    s_lshr_b32 s45, s47, 5
    s_mov_b32 exec_hi, 0xff
    buffer_load_dwordx4 v7, s[28:31], s45 offen lds
    s_mov_b32 exec_hi, -1
    s_load_dword s48, s[10:11], 0
    s_waitcnt vmcnt(14)
    s_barrier
    s_add_u32 s47, s47, 40960
    s_add_u32 m0, s44, 92160
    s_nop 0
    buffer_load_dwordx4 v6, s[24:27], s47 offen lds
    s_add_u32 m0, s51, 96256
    s_lshr_b32 s45, s47, 5
    s_mov_b32 exec_hi, 0xff
    buffer_load_dwordx4 v7, s[28:31], s45 offen lds
    s_mov_b32 exec_hi, -1
    s_waitcnt vmcnt(10)
    s_barrier
    s_waitcnt vmcnt(8)
    s_barrier
    s_waitcnt lgkmcnt(0)
    s_cmp_ge_u32 s48, 64
    s_cbranch_scc0 LA_slow
LA_back:
    s_lshr_b32 s42, s54, 1
    s_lshl_b32 s40, s42, 10
    s_add_u32 s40, s40, 3473408
    s_lshr_b32 s63, s55, 1
    s_lshl_b32 s63, s63, 8
    s_add_u32 s63, s63, s40
    s_lshl_b32 s40, s16, 10
    s_add_u32 s40, s40, 3473408
    s_lshl_b32 s56, s17, 2
    s_add_u32 s56, s56, s60
    s_lshl_b32 s56, s56, 2
    s_add_u32 s56, s56, s40
    s_mul_i32 s48, s17, 3
    s_add_u32 s48, s48, s60
    s_lshl_b32 s48, s48, 3
    s_mul_i32 s41, s16, 384
    s_add_u32 s48, s48, s41
    s_bfe_u32 s41, s18, 0x10001
    s_mul_i32 s41, s41, 192
    s_add_u32 s48, s48, s41
    s_and_b32 s41, s18, 1
    s_lshl_b32 s41, s41, 2
    s_add_u32 s48, s48, s41
    s_lshl_b32 s48, s48, 10
    s_add_u32 s48, s48, 4194304
    s_cmp_eq_u32 s60, 3
    s_cselect_b32 s48, 0, s48
    s_lshl_b32 s41, s55, 2
    s_lshr_b32 s47, 0x88c46222, s41
    s_and_b32 s47, s47, 15
    s_lshl_b32 s47, s47, 16
    s_bitset1_b32 s47, s42
    s_sub_u32 s60, s18, 8
    s_and_b32 s61, s60, 1
    s_lshr_b32 s62, s60, 1
    s_lshl_b32 s46, s54, 1
    s_add_u32 s46, s46, s61
    v_lshlrev_b32 v38, 4, v1
    v_lshlrev_b32 v39, 2, v1
    s_mov_b32 s32, s14
    s_mov_b32 s33, s15
    s_mov_b32 s34, 16777216
    s_mov_b32 s35, 0x00020000
    s_waitcnt vmcnt(2)
    s_barrier
    s_branch G_common
LF_slow:
    s_mov_b32 s36, s10
    s_mov_b32 s37, s11
    s_mov_b32 s38, 256
    s_mov_b32 s39, 0x00020000
    s_mov_b32 s49, 131072
LF_spin:
    s_sleep 8
    buffer_load_dword v2, off, s[36:39], 0 sc1
    s_sub_u32 s49, s49, 1
    s_waitcnt vmcnt(0)
    s_cbranch_scc1 LF_back
    v_readfirstlane_b32 s48, v2
    s_cmp_ge_u32 s48, 64
    s_cbranch_scc0 LF_spin
    s_branch LF_back
LQ_slow:
    s_mov_b32 s36, s10
    s_mov_b32 s37, s11
    s_mov_b32 s38, 256
    s_mov_b32 s39, 0x00020000
    s_mov_b32 s49, 131072
LQ_spin:
    s_sleep 8
    buffer_load_dword v2, off, s[36:39], 0 sc1
    s_sub_u32 s49, s49, 1
    s_waitcnt vmcnt(0)
    s_cbranch_scc1 LQ_back
    v_readfirstlane_b32 s48, v2
    s_cmp_ge_u32 s48, 64
    s_cbranch_scc0 LQ_spin
    s_branch LQ_back
LA_slow:
    s_mov_b32 s36, s10
    s_mov_b32 s37, s11
    s_mov_b32 s38, 256
    s_mov_b32 s39, 0x00020000
    s_mov_b32 s49, 131072
LA_spin:
    s_sleep 8
    buffer_load_dword v2, off, s[36:39], 0 sc1
    s_sub_u32 s49, s49, 1
    s_waitcnt vmcnt(0)
    s_cbranch_scc1 LA_back
    v_readfirstlane_b32 s48, v2
    s_cmp_ge_u32 s48, 64
    s_cbranch_scc0 LA_spin
    s_branch LA_back
K_comp:
    v_mov_b32 v4, v1
    s_lshr_b32 s61, s18, 2
    s_and_b32 s62, s18, 3
    v_and_b32 v5, 15, v4
    v_lshrrev_b32 v6, 4, v4
    v_lshrrev_b32 v14, 1, v5
    v_xor_b32 v14, v14, v6
    v_lshlrev_b32 v14, 4, v14
    v_lshl_add_u32 v8, v5, 7, v14
    s_lshl_b32 s40, s61, 13
    v_add_u32 v8, s40, v8
    v_xor_b32 v9, 64, v8
    v_bfe_u32 v14, v4, 2, 2
    v_lshl_add_u32 v15, v6, 3, v14
    v_and_b32 v16, 3, v4
    s_lshl_b32 s46, s16, 2
    s_lshl_b32 s40, s61, 1
    s_add_u32 s46, s46, s40
    s_cmp_eq_u32 s60, 3
    s_cbranch_scc1 K_cq
    v_and_b32 v17, 1, v6
    v_lshl_or_b32 v17, v17, 2, v14
    s_lshl_b32 s40, s62, 1
    v_xor_b32 v17, s40, v17
    v_lshlrev_b32 v17, 5, v17
    v_lshl_add_u32 v17, v16, 3, v17
    v_lshl_add_u32 v17, v15, 8, v17
    v_add_u32 v10, 65536, v17
    v_xor_b32 v11, 32, v10
    v_add_u32 v12, 49152, v10
    v_add_u32 v13, 49152, v11
    v_lshlrev_b32 v160, 9, v6
    v_lshl_add_u32 v160, v5, 4, v160
    s_lshr_b32 s40, s18, 1
    s_mul_i32 s40, s40, 25600
    s_and_b32 s41, s18, 1
    s_lshl_b32 s41, s41, 11
    s_add_u32 s40, s40, s41
    s_add_u32 s40, s40, 33792
    v_add_u32 v160, s40, v160
    s_mov_b32 s52, 0xbdd2d3e8
    s_mov_b32 s53, s52
    v_mov_b32 v162, 0xc0135761
    v_mov_b32 v163, v162
    v_lshlrev_b32 v1, 4, v4
    v_lshlrev_b32 v2, 3, v4
    s_lshl_b32 s21, s18, 13
    s_add_u32 s21, s21, 3145728
    s_lshl_b32 s22, s18, 11
    s_add_u32 s22, s22, 3211264
    s_mul_i32 s23, s18, 12288
    s_add_u32 s23, s23, 3276800
    s_lshl_b32 s40, s18, 1
    s_lshl_b32 s25, 3, s40
    s_add_u32 s40, s18, 3
    s_lshl_b32 s40, s40, 1
    s_bfe_u32 s41, s40, 0x10002
    s_and_b32 s40, s40, 3
    s_lshl_b32 s26, s54, 1
    s_add_u32 s41, s41, s26
    s_mul_i32 s41, s41, 40
    s_mul_i32 s26, s55, 5
    s_add_u32 s41, s41, s26
    s_lshl_b32 s41, s41, 10
    s_add_u32 s41, s41, 0
    s_lshl_b32 s26, s40, 10
    s_add_u32 s26, s26, s41
    s_lshl_b32 s27, s40, 8
    s_add_u32 s27, s27, s41
    s_add_u32 s27, s27, 4096
    v_lshrrev_b32 v3, 2, v1
    v_and_b32 v3, 128, v3
    v_and_b32 v0, 256, v1
    v_max_u32 v0, v0, v3
    v_add_u32 v3, v0, v3
    v_and_b32 v0, 0x1f0, v1
    v_cmp_lt_u32 vcc, 320, v0
    v_add_u32 v3, v0, v3
    s_nop 0
    v_cndmask_b32 v3, v3, 2.0, vcc
    v_mov_b32 v164, 0
    v_mov_b32 v165, 0
    v_mov_b32 v166, 0
    v_mov_b32 v167, 0
    s_waitcnt lgkmcnt(0)
    s_mov_b32 s32, s14
    s_mov_b32 s33, s15
    s_mov_b32 s34, 16777216
    s_mov_b32 s35, 0x00020000
    s_barrier
    ds_read_b64_tr_b16 v[36:37], v10 offset:0
    ds_read_b64_tr_b16 v[38:39], v10 offset:1024
    ds_read_b128 v[20:23], v8 offset:0
    ds_read_b128 v[24:27], v8 offset:2048
    ds_read_b128 v[28:31], v8 offset:4096
    ds_read_b128 v[32:35], v8 offset:6144
    ds_read_b64_tr_b16 v[40:41], v11 offset:0
    ds_read_b64_tr_b16 v[42:43], v11 offset:1024
    ds_read_b64_tr_b16 v[44:45], v10 offset:8192
    ds_read_b64_tr_b16 v[46:47], v10 offset:9216
    ds_read_b64_tr_b16 v[48:49], v11 offset:8192
    ds_read_b64_tr_b16 v[50:51], v11 offset:9216
    s_waitcnt lgkmcnt(0)
    s_barrier
    v_mfma_f32_16x16x32_bf16 v[92:95], v[36:39], v[20:23], 0
    ds_read_b64_tr_b16 v[68:69], v10 offset:16384
    v_mfma_f32_16x16x32_bf16 v[96:99], v[36:39], v[24:27], 0
    ds_read_b64_tr_b16 v[70:71], v10 offset:17408
    v_mfma_f32_16x16x32_bf16 v[100:103], v[36:39], v[28:31], 0
    ds_read_b128 v[52:55], v9 offset:0
    v_mfma_f32_16x16x32_bf16 v[104:107], v[36:39], v[32:35], 0
    ds_read_b128 v[56:59], v9 offset:2048
    v_mfma_f32_16x16x32_bf16 v[108:111], v[40:43], v[20:23], 0
    ds_read_b128 v[60:63], v9 offset:4096
    v_mfma_f32_16x16x32_bf16 v[112:115], v[40:43], v[24:27], 0
    ds_read_b128 v[64:67], v9 offset:6144
    v_mfma_f32_16x16x32_bf16 v[116:119], v[40:43], v[28:31], 0
    ds_read_b64_tr_b16 v[72:73], v11 offset:16384
    v_mfma_f32_16x16x32_bf16 v[120:123], v[40:43], v[32:35], 0
    ds_read_b64_tr_b16 v[74:75], v11 offset:17408
    v_mfma_f32_16x16x32_bf16 v[124:127], v[44:47], v[20:23], 0
    ds_read_b64_tr_b16 v[76:77], v10 offset:24576
    v_mfma_f32_16x16x32_bf16 v[128:131], v[44:47], v[24:27], 0
    ds_read_b64_tr_b16 v[78:79], v10 offset:25600
    v_mfma_f32_16x16x32_bf16 v[132:135], v[44:47], v[28:31], 0
    ds_read_b64_tr_b16 v[80:81], v11 offset:24576
    v_mfma_f32_16x16x32_bf16 v[136:139], v[44:47], v[32:35], 0
    ds_read_b64_tr_b16 v[82:83], v11 offset:25600
    v_mfma_f32_16x16x32_bf16 v[140:143], v[48:51], v[20:23], 0
    v_mfma_f32_16x16x32_bf16 v[144:147], v[48:51], v[24:27], 0
    v_mfma_f32_16x16x32_bf16 v[148:151], v[48:51], v[28:31], 0
    v_mfma_f32_16x16x32_bf16 v[152:155], v[48:51], v[32:35], 0
    s_waitcnt lgkmcnt(0)
    s_barrier
    v_mfma_f32_16x16x32_bf16 v[92:95], v[68:71], v[52:55], v[92:95]
    ds_read_b64_tr_b16 v[36:37], v10 offset:32768
    v_mfma_f32_16x16x32_bf16 v[96:99], v[68:71], v[56:59], v[96:99]
    ds_read_b64_tr_b16 v[38:39], v10 offset:33792
    v_mfma_f32_16x16x32_bf16 v[100:103], v[68:71], v[60:63], v[100:103]
    ds_read_b128 v[20:23], v8 offset:16384
    v_mfma_f32_16x16x32_bf16 v[104:107], v[68:71], v[64:67], v[104:107]
    ds_read_b128 v[24:27], v8 offset:18432
    v_mfma_f32_16x16x32_bf16 v[108:111], v[72:75], v[52:55], v[108:111]
    ds_read_b128 v[28:31], v8 offset:20480
    v_mfma_f32_16x16x32_bf16 v[112:115], v[72:75], v[56:59], v[112:115]
    ds_read_b128 v[32:35], v8 offset:22528
    v_mfma_f32_16x16x32_bf16 v[116:119], v[72:75], v[60:63], v[116:119]
    ds_read_b64_tr_b16 v[40:41], v11 offset:32768
    v_mfma_f32_16x16x32_bf16 v[120:123], v[72:75], v[64:67], v[120:123]
    ds_read_b64_tr_b16 v[42:43], v11 offset:33792
    v_mfma_f32_16x16x32_bf16 v[124:127], v[76:79], v[52:55], v[124:127]
    ds_read_b64_tr_b16 v[44:45], v10 offset:40960
    v_mfma_f32_16x16x32_bf16 v[128:131], v[76:79], v[56:59], v[128:131]
    ds_read_b64_tr_b16 v[46:47], v10 offset:41984
    v_mfma_f32_16x16x32_bf16 v[132:135], v[76:79], v[60:63], v[132:135]
    ds_read_b64_tr_b16 v[48:49], v11 offset:40960
    v_mfma_f32_16x16x32_bf16 v[136:139], v[76:79], v[64:67], v[136:139]
    ds_read_b64_tr_b16 v[50:51], v11 offset:41984
    v_mfma_f32_16x16x32_bf16 v[140:143], v[80:83], v[52:55], v[140:143]
    v_mfma_f32_16x16x32_bf16 v[144:147], v[80:83], v[56:59], v[144:147]
    v_mfma_f32_16x16x32_bf16 v[148:151], v[80:83], v[60:63], v[148:151]
    v_mfma_f32_16x16x32_bf16 v[152:155], v[80:83], v[64:67], v[152:155]
    s_waitcnt lgkmcnt(0)
    s_barrier
    v_mfma_f32_16x16x32_bf16 v[92:95], v[36:39], v[20:23], v[92:95]
    ds_read_b64_tr_b16 v[68:69], v12 offset:0
    v_mfma_f32_16x16x32_bf16 v[96:99], v[36:39], v[24:27], v[96:99]
    ds_read_b64_tr_b16 v[70:71], v12 offset:1024
    v_mfma_f32_16x16x32_bf16 v[100:103], v[36:39], v[28:31], v[100:103]
    ds_read_b128 v[52:55], v9 offset:16384
    v_mfma_f32_16x16x32_bf16 v[104:107], v[36:39], v[32:35], v[104:107]
    ds_read_b128 v[56:59], v9 offset:18432
    v_mfma_f32_16x16x32_bf16 v[108:111], v[40:43], v[20:23], v[108:111]
    ds_read_b128 v[60:63], v9 offset:20480
    v_mfma_f32_16x16x32_bf16 v[112:115], v[40:43], v[24:27], v[112:115]
    ds_read_b128 v[64:67], v9 offset:22528
    v_mfma_f32_16x16x32_bf16 v[116:119], v[40:43], v[28:31], v[116:119]
    ds_read_b64_tr_b16 v[72:73], v13 offset:0
    v_mfma_f32_16x16x32_bf16 v[120:123], v[40:43], v[32:35], v[120:123]
    ds_read_b64_tr_b16 v[74:75], v13 offset:1024
    v_mfma_f32_16x16x32_bf16 v[124:127], v[44:47], v[20:23], v[124:127]
    ds_read_b64_tr_b16 v[76:77], v12 offset:8192
    v_mfma_f32_16x16x32_bf16 v[128:131], v[44:47], v[24:27], v[128:131]
    ds_read_b64_tr_b16 v[78:79], v12 offset:9216
    v_mfma_f32_16x16x32_bf16 v[132:135], v[44:47], v[28:31], v[132:135]
    ds_read_b64_tr_b16 v[80:81], v13 offset:8192
    v_mfma_f32_16x16x32_bf16 v[136:139], v[44:47], v[32:35], v[136:139]
    ds_read_b64_tr_b16 v[82:83], v13 offset:9216
    v_mfma_f32_16x16x32_bf16 v[140:143], v[48:51], v[20:23], v[140:143]
    v_mfma_f32_16x16x32_bf16 v[144:147], v[48:51], v[24:27], v[144:147]
    v_mfma_f32_16x16x32_bf16 v[148:151], v[48:51], v[28:31], v[148:151]
    v_mfma_f32_16x16x32_bf16 v[152:155], v[48:51], v[32:35], v[152:155]
    s_waitcnt lgkmcnt(0)
    s_barrier
    v_mfma_f32_16x16x32_bf16 v[92:95], v[68:71], v[52:55], v[92:95]
    ds_read_b64_tr_b16 v[36:37], v12 offset:16384
    v_mfma_f32_16x16x32_bf16 v[96:99], v[68:71], v[56:59], v[96:99]
    ds_read_b64_tr_b16 v[38:39], v12 offset:17408
    v_mfma_f32_16x16x32_bf16 v[100:103], v[68:71], v[60:63], v[100:103]
    ds_read_b128 v[20:23], v8 offset:32768
    v_mfma_f32_16x16x32_bf16 v[104:107], v[68:71], v[64:67], v[104:107]
    ds_read_b128 v[24:27], v8 offset:34816
    v_mfma_f32_16x16x32_bf16 v[108:111], v[72:75], v[52:55], v[108:111]
    ds_read_b128 v[28:31], v8 offset:36864
    v_mfma_f32_16x16x32_bf16 v[112:115], v[72:75], v[56:59], v[112:115]
    ds_read_b128 v[32:35], v8 offset:38912
    v_mfma_f32_16x16x32_bf16 v[116:119], v[72:75], v[60:63], v[116:119]
    ds_read_b64_tr_b16 v[40:41], v13 offset:16384
    v_mfma_f32_16x16x32_bf16 v[120:123], v[72:75], v[64:67], v[120:123]
    ds_read_b64_tr_b16 v[42:43], v13 offset:17408
    v_mfma_f32_16x16x32_bf16 v[124:127], v[76:79], v[52:55], v[124:127]
    ds_read_b64_tr_b16 v[44:45], v12 offset:24576
    v_mfma_f32_16x16x32_bf16 v[128:131], v[76:79], v[56:59], v[128:131]
    ds_read_b64_tr_b16 v[46:47], v12 offset:25600
    v_mfma_f32_16x16x32_bf16 v[132:135], v[76:79], v[60:63], v[132:135]
    ds_read_b64_tr_b16 v[48:49], v13 offset:24576
    v_mfma_f32_16x16x32_bf16 v[136:139], v[76:79], v[64:67], v[136:139]
    ds_read_b64_tr_b16 v[50:51], v13 offset:25600
    v_mfma_f32_16x16x32_bf16 v[140:143], v[80:83], v[52:55], v[140:143]
    v_mfma_f32_16x16x32_bf16 v[144:147], v[80:83], v[56:59], v[144:147]
    v_mfma_f32_16x16x32_bf16 v[148:151], v[80:83], v[60:63], v[148:151]
    v_mfma_f32_16x16x32_bf16 v[152:155], v[80:83], v[64:67], v[152:155]
    s_waitcnt lgkmcnt(0)
    s_barrier
    v_mfma_f32_16x16x32_bf16 v[92:95], v[36:39], v[20:23], v[92:95]
    ds_read_b64_tr_b16 v[68:69], v10 offset:0
    v_mfma_f32_16x16x32_bf16 v[96:99], v[36:39], v[24:27], v[96:99]
    ds_read_b64_tr_b16 v[70:71], v10 offset:1024
    v_mfma_f32_16x16x32_bf16 v[100:103], v[36:39], v[28:31], v[100:103]
    ds_read_b128 v[52:55], v9 offset:32768
    v_mfma_f32_16x16x32_bf16 v[104:107], v[36:39], v[32:35], v[104:107]
    ds_read_b128 v[56:59], v9 offset:34816
    v_mfma_f32_16x16x32_bf16 v[108:111], v[40:43], v[20:23], v[108:111]
    ds_read_b128 v[60:63], v9 offset:36864
    v_mfma_f32_16x16x32_bf16 v[112:115], v[40:43], v[24:27], v[112:115]
    ds_read_b128 v[64:67], v9 offset:38912
    v_mfma_f32_16x16x32_bf16 v[116:119], v[40:43], v[28:31], v[116:119]
    ds_read_b64_tr_b16 v[72:73], v11 offset:0
    v_mfma_f32_16x16x32_bf16 v[120:123], v[40:43], v[32:35], v[120:123]
    ds_read_b64_tr_b16 v[74:75], v11 offset:1024
    v_mfma_f32_16x16x32_bf16 v[124:127], v[44:47], v[20:23], v[124:127]
    ds_read_b64_tr_b16 v[76:77], v10 offset:8192
    v_mfma_f32_16x16x32_bf16 v[128:131], v[44:47], v[24:27], v[128:131]
    ds_read_b64_tr_b16 v[78:79], v10 offset:9216
    v_mfma_f32_16x16x32_bf16 v[132:135], v[44:47], v[28:31], v[132:135]
    ds_read_b64_tr_b16 v[80:81], v11 offset:8192
    v_mfma_f32_16x16x32_bf16 v[136:139], v[44:47], v[32:35], v[136:139]
    ds_read_b64_tr_b16 v[82:83], v11 offset:9216
    v_mfma_f32_16x16x32_bf16 v[140:143], v[48:51], v[20:23], v[140:143]
    v_mfma_f32_16x16x32_bf16 v[144:147], v[48:51], v[24:27], v[144:147]
    v_mfma_f32_16x16x32_bf16 v[148:151], v[48:51], v[28:31], v[148:151]
    v_mfma_f32_16x16x32_bf16 v[152:155], v[48:51], v[32:35], v[152:155]
    s_waitcnt lgkmcnt(0)
    s_barrier
    v_mfma_f32_16x16x32_bf16 v[92:95], v[68:71], v[52:55], v[92:95]
    ds_read_b64_tr_b16 v[36:37], v10 offset:16384
    v_mfma_f32_16x16x32_bf16 v[96:99], v[68:71], v[56:59], v[96:99]
    ds_read_b64_tr_b16 v[38:39], v10 offset:17408
    v_mfma_f32_16x16x32_bf16 v[100:103], v[68:71], v[60:63], v[100:103]
    ds_read_b128 v[20:23], v8 offset:49152
    v_mfma_f32_16x16x32_bf16 v[104:107], v[68:71], v[64:67], v[104:107]
    ds_read_b128 v[24:27], v8 offset:51200
    v_mfma_f32_16x16x32_bf16 v[108:111], v[72:75], v[52:55], v[108:111]
    ds_read_b128 v[28:31], v8 offset:53248
    v_mfma_f32_16x16x32_bf16 v[112:115], v[72:75], v[56:59], v[112:115]
    ds_read_b128 v[32:35], v8 offset:55296
    v_mfma_f32_16x16x32_bf16 v[116:119], v[72:75], v[60:63], v[116:119]
    ds_read_b64_tr_b16 v[40:41], v11 offset:16384
    v_mfma_f32_16x16x32_bf16 v[120:123], v[72:75], v[64:67], v[120:123]
    ds_read_b64_tr_b16 v[42:43], v11 offset:17408
    v_mfma_f32_16x16x32_bf16 v[124:127], v[76:79], v[52:55], v[124:127]
    ds_read_b64_tr_b16 v[44:45], v10 offset:24576
    v_mfma_f32_16x16x32_bf16 v[128:131], v[76:79], v[56:59], v[128:131]
    ds_read_b64_tr_b16 v[46:47], v10 offset:25600
    v_mfma_f32_16x16x32_bf16 v[132:135], v[76:79], v[60:63], v[132:135]
    ds_read_b64_tr_b16 v[48:49], v11 offset:24576
    v_mfma_f32_16x16x32_bf16 v[136:139], v[76:79], v[64:67], v[136:139]
    ds_read_b64_tr_b16 v[50:51], v11 offset:25600
    v_mfma_f32_16x16x32_bf16 v[140:143], v[80:83], v[52:55], v[140:143]
    v_mfma_f32_16x16x32_bf16 v[144:147], v[80:83], v[56:59], v[144:147]
    v_mfma_f32_16x16x32_bf16 v[148:151], v[80:83], v[60:63], v[148:151]
    v_mfma_f32_16x16x32_bf16 v[152:155], v[80:83], v[64:67], v[152:155]
    s_waitcnt lgkmcnt(0)
    s_barrier
    v_mfma_f32_16x16x32_bf16 v[92:95], v[36:39], v[20:23], v[92:95]
    ds_read_b64_tr_b16 v[68:69], v10 offset:32768
    v_mfma_f32_16x16x32_bf16 v[96:99], v[36:39], v[24:27], v[96:99]
    ds_read_b64_tr_b16 v[70:71], v10 offset:33792
    v_mfma_f32_16x16x32_bf16 v[100:103], v[36:39], v[28:31], v[100:103]
    ds_read_b128 v[52:55], v9 offset:49152
    v_mfma_f32_16x16x32_bf16 v[104:107], v[36:39], v[32:35], v[104:107]
    ds_read_b128 v[56:59], v9 offset:51200
    v_mfma_f32_16x16x32_bf16 v[108:111], v[40:43], v[20:23], v[108:111]
    ds_read_b128 v[60:63], v9 offset:53248
    v_mfma_f32_16x16x32_bf16 v[112:115], v[40:43], v[24:27], v[112:115]
    ds_read_b128 v[64:67], v9 offset:55296
    v_mfma_f32_16x16x32_bf16 v[116:119], v[40:43], v[28:31], v[116:119]
    ds_read_b64_tr_b16 v[72:73], v11 offset:32768
    v_mfma_f32_16x16x32_bf16 v[120:123], v[40:43], v[32:35], v[120:123]
    ds_read_b64_tr_b16 v[74:75], v11 offset:33792
    v_mfma_f32_16x16x32_bf16 v[124:127], v[44:47], v[20:23], v[124:127]
    ds_read_b64_tr_b16 v[76:77], v10 offset:40960
    v_mfma_f32_16x16x32_bf16 v[128:131], v[44:47], v[24:27], v[128:131]
    ds_read_b64_tr_b16 v[78:79], v10 offset:41984
    v_mfma_f32_16x16x32_bf16 v[132:135], v[44:47], v[28:31], v[132:135]
    ds_read_b64_tr_b16 v[80:81], v11 offset:40960
    v_mfma_f32_16x16x32_bf16 v[136:139], v[44:47], v[32:35], v[136:139]
    ds_read_b64_tr_b16 v[82:83], v11 offset:41984
    v_mfma_f32_16x16x32_bf16 v[140:143], v[48:51], v[20:23], v[140:143]
    v_mfma_f32_16x16x32_bf16 v[144:147], v[48:51], v[24:27], v[144:147]
    v_mfma_f32_16x16x32_bf16 v[148:151], v[48:51], v[28:31], v[148:151]
    v_mfma_f32_16x16x32_bf16 v[152:155], v[48:51], v[32:35], v[152:155]
    s_waitcnt lgkmcnt(0)
    s_barrier
    v_mfma_f32_16x16x32_bf16 v[92:95], v[68:71], v[52:55], v[92:95]
    ds_read_b64_tr_b16 v[36:37], v12 offset:0
    v_mfma_f32_16x16x32_bf16 v[96:99], v[68:71], v[56:59], v[96:99]
    ds_read_b64_tr_b16 v[38:39], v12 offset:1024
    v_mfma_f32_16x16x32_bf16 v[100:103], v[68:71], v[60:63], v[100:103]
    ds_read_b128 v[20:23], v8 offset:0
    v_mfma_f32_16x16x32_bf16 v[104:107], v[68:71], v[64:67], v[104:107]
    ds_read_b128 v[24:27], v8 offset:2048
    v_mfma_f32_16x16x32_bf16 v[108:111], v[72:75], v[52:55], v[108:111]
    ds_read_b128 v[28:31], v8 offset:4096
    v_mfma_f32_16x16x32_bf16 v[112:115], v[72:75], v[56:59], v[112:115]
    ds_read_b128 v[32:35], v8 offset:6144
    v_mfma_f32_16x16x32_bf16 v[116:119], v[72:75], v[60:63], v[116:119]
    ds_read_b64_tr_b16 v[40:41], v13 offset:0
    v_mfma_f32_16x16x32_bf16 v[120:123], v[72:75], v[64:67], v[120:123]
    ds_read_b64_tr_b16 v[42:43], v13 offset:1024
    v_mfma_f32_16x16x32_bf16 v[124:127], v[76:79], v[52:55], v[124:127]
    ds_read_b64_tr_b16 v[44:45], v12 offset:8192
    v_mfma_f32_16x16x32_bf16 v[128:131], v[76:79], v[56:59], v[128:131]
    ds_read_b64_tr_b16 v[46:47], v12 offset:9216
    v_mfma_f32_16x16x32_bf16 v[132:135], v[76:79], v[60:63], v[132:135]
    ds_read_b64_tr_b16 v[48:49], v13 offset:8192
    v_mfma_f32_16x16x32_bf16 v[136:139], v[76:79], v[64:67], v[136:139]
    ds_read_b64_tr_b16 v[50:51], v13 offset:9216
    v_mfma_f32_16x16x32_bf16 v[140:143], v[80:83], v[52:55], v[140:143]
    v_mfma_f32_16x16x32_bf16 v[144:147], v[80:83], v[56:59], v[144:147]
    v_mfma_f32_16x16x32_bf16 v[148:151], v[80:83], v[60:63], v[148:151]
    v_mfma_f32_16x16x32_bf16 v[152:155], v[80:83], v[64:67], v[152:155]
    s_waitcnt lgkmcnt(0)
    s_barrier
    v_mfma_f32_16x16x32_bf16 v[92:95], v[36:39], v[20:23], v[92:95]
    ds_read_b64_tr_b16 v[68:69], v12 offset:16384
    v_mfma_f32_16x16x32_bf16 v[96:99], v[36:39], v[24:27], v[96:99]
    ds_read_b64_tr_b16 v[70:71], v12 offset:17408
    v_mfma_f32_16x16x32_bf16 v[100:103], v[36:39], v[28:31], v[100:103]
    ds_read_b128 v[52:55], v9 offset:0
    v_mfma_f32_16x16x32_bf16 v[104:107], v[36:39], v[32:35], v[104:107]
    ds_read_b128 v[56:59], v9 offset:2048
    v_mfma_f32_16x16x32_bf16 v[108:111], v[40:43], v[20:23], v[108:111]
    ds_read_b128 v[60:63], v9 offset:4096
    v_mfma_f32_16x16x32_bf16 v[112:115], v[40:43], v[24:27], v[112:115]
    ds_read_b128 v[64:67], v9 offset:6144
    v_mfma_f32_16x16x32_bf16 v[116:119], v[40:43], v[28:31], v[116:119]
    ds_read_b64_tr_b16 v[72:73], v13 offset:16384
    v_mfma_f32_16x16x32_bf16 v[120:123], v[40:43], v[32:35], v[120:123]
    ds_read_b64_tr_b16 v[74:75], v13 offset:17408
    v_mfma_f32_16x16x32_bf16 v[124:127], v[44:47], v[20:23], v[124:127]
    ds_read_b64_tr_b16 v[76:77], v12 offset:24576
    v_mfma_f32_16x16x32_bf16 v[128:131], v[44:47], v[24:27], v[128:131]
    ds_read_b64_tr_b16 v[78:79], v12 offset:25600
    v_mfma_f32_16x16x32_bf16 v[132:135], v[44:47], v[28:31], v[132:135]
    ds_read_b64_tr_b16 v[80:81], v13 offset:24576
    v_mfma_f32_16x16x32_bf16 v[136:139], v[44:47], v[32:35], v[136:139]
    ds_read_b64_tr_b16 v[82:83], v13 offset:25600
    v_mfma_f32_16x16x32_bf16 v[140:143], v[48:51], v[20:23], v[140:143]
    v_mfma_f32_16x16x32_bf16 v[144:147], v[48:51], v[24:27], v[144:147]
    v_mfma_f32_16x16x32_bf16 v[148:151], v[48:51], v[28:31], v[148:151]
    v_mfma_f32_16x16x32_bf16 v[152:155], v[48:51], v[32:35], v[152:155]
    s_waitcnt lgkmcnt(0)
    s_barrier
    v_mfma_f32_16x16x32_bf16 v[92:95], v[68:71], v[52:55], v[92:95]
    ds_read_b64_tr_b16 v[36:37], v10 offset:0
    v_mfma_f32_16x16x32_bf16 v[96:99], v[68:71], v[56:59], v[96:99]
    ds_read_b64_tr_b16 v[38:39], v10 offset:1024
    v_mfma_f32_16x16x32_bf16 v[100:103], v[68:71], v[60:63], v[100:103]
    ds_read_b128 v[20:23], v8 offset:16384
    v_mfma_f32_16x16x32_bf16 v[104:107], v[68:71], v[64:67], v[104:107]
    ds_read_b128 v[24:27], v8 offset:18432
    v_mfma_f32_16x16x32_bf16 v[108:111], v[72:75], v[52:55], v[108:111]
    ds_read_b128 v[28:31], v8 offset:20480
    v_mfma_f32_16x16x32_bf16 v[112:115], v[72:75], v[56:59], v[112:115]
    ds_read_b128 v[32:35], v8 offset:22528
    v_mfma_f32_16x16x32_bf16 v[116:119], v[72:75], v[60:63], v[116:119]
    ds_read_b64_tr_b16 v[40:41], v11 offset:0
    v_mfma_f32_16x16x32_bf16 v[120:123], v[72:75], v[64:67], v[120:123]
    ds_read_b64_tr_b16 v[42:43], v11 offset:1024
    v_mfma_f32_16x16x32_bf16 v[124:127], v[76:79], v[52:55], v[124:127]
    ds_read_b64_tr_b16 v[44:45], v10 offset:8192
    v_mfma_f32_16x16x32_bf16 v[128:131], v[76:79], v[56:59], v[128:131]
    ds_read_b64_tr_b16 v[46:47], v10 offset:9216
    v_mfma_f32_16x16x32_bf16 v[132:135], v[76:79], v[60:63], v[132:135]
    ds_read_b64_tr_b16 v[48:49], v11 offset:8192
    v_mfma_f32_16x16x32_bf16 v[136:139], v[76:79], v[64:67], v[136:139]
    ds_read_b64_tr_b16 v[50:51], v11 offset:9216
    v_mfma_f32_16x16x32_bf16 v[140:143], v[80:83], v[52:55], v[140:143]
    v_mfma_f32_16x16x32_bf16 v[144:147], v[80:83], v[56:59], v[144:147]
    v_mfma_f32_16x16x32_bf16 v[148:151], v[80:83], v[60:63], v[148:151]
    v_mfma_f32_16x16x32_bf16 v[152:155], v[80:83], v[64:67], v[152:155]
    s_waitcnt lgkmcnt(0)
    s_barrier
    v_mfma_f32_16x16x32_bf16 v[92:95], v[36:39], v[20:23], v[92:95]
    ds_read_b64_tr_b16 v[68:69], v10 offset:16384
    v_mfma_f32_16x16x32_bf16 v[96:99], v[36:39], v[24:27], v[96:99]
    ds_read_b64_tr_b16 v[70:71], v10 offset:17408
    v_mfma_f32_16x16x32_bf16 v[100:103], v[36:39], v[28:31], v[100:103]
    ds_read_b128 v[52:55], v9 offset:16384
    v_mfma_f32_16x16x32_bf16 v[104:107], v[36:39], v[32:35], v[104:107]
    ds_read_b128 v[56:59], v9 offset:18432
    v_mfma_f32_16x16x32_bf16 v[108:111], v[40:43], v[20:23], v[108:111]
    ds_read_b128 v[60:63], v9 offset:20480
    v_mfma_f32_16x16x32_bf16 v[112:115], v[40:43], v[24:27], v[112:115]
    ds_read_b128 v[64:67], v9 offset:22528
    v_mfma_f32_16x16x32_bf16 v[116:119], v[40:43], v[28:31], v[116:119]
    ds_read_b64_tr_b16 v[72:73], v11 offset:16384
    v_mfma_f32_16x16x32_bf16 v[120:123], v[40:43], v[32:35], v[120:123]
    ds_read_b64_tr_b16 v[74:75], v11 offset:17408
    v_mfma_f32_16x16x32_bf16 v[124:127], v[44:47], v[20:23], v[124:127]
    ds_read_b64_tr_b16 v[76:77], v10 offset:24576
    v_mfma_f32_16x16x32_bf16 v[128:131], v[44:47], v[24:27], v[128:131]
    ds_read_b64_tr_b16 v[78:79], v10 offset:25600
    v_mfma_f32_16x16x32_bf16 v[132:135], v[44:47], v[28:31], v[132:135]
    ds_read_b64_tr_b16 v[80:81], v11 offset:24576
    v_mfma_f32_16x16x32_bf16 v[136:139], v[44:47], v[32:35], v[136:139]
    ds_read_b64_tr_b16 v[82:83], v11 offset:25600
    v_mfma_f32_16x16x32_bf16 v[140:143], v[48:51], v[20:23], v[140:143]
    v_mfma_f32_16x16x32_bf16 v[144:147], v[48:51], v[24:27], v[144:147]
    v_mfma_f32_16x16x32_bf16 v[148:151], v[48:51], v[28:31], v[148:151]
    v_mfma_f32_16x16x32_bf16 v[152:155], v[48:51], v[32:35], v[152:155]
    s_waitcnt lgkmcnt(0)
    s_barrier
    v_mfma_f32_16x16x32_bf16 v[92:95], v[68:71], v[52:55], v[92:95]
    ds_read_b64_tr_b16 v[36:37], v10 offset:32768
    v_mfma_f32_16x16x32_bf16 v[96:99], v[68:71], v[56:59], v[96:99]
    ds_read_b64_tr_b16 v[38:39], v10 offset:33792
    v_mfma_f32_16x16x32_bf16 v[100:103], v[68:71], v[60:63], v[100:103]
    ds_read_b128 v[20:23], v8 offset:32768
    v_mfma_f32_16x16x32_bf16 v[104:107], v[68:71], v[64:67], v[104:107]
    ds_read_b128 v[24:27], v8 offset:34816
    v_mfma_f32_16x16x32_bf16 v[108:111], v[72:75], v[52:55], v[108:111]
    ds_read_b128 v[28:31], v8 offset:36864
    v_mfma_f32_16x16x32_bf16 v[112:115], v[72:75], v[56:59], v[112:115]
    ds_read_b128 v[32:35], v8 offset:38912
    v_mfma_f32_16x16x32_bf16 v[116:119], v[72:75], v[60:63], v[116:119]
    ds_read_b64_tr_b16 v[40:41], v11 offset:32768
    v_mfma_f32_16x16x32_bf16 v[120:123], v[72:75], v[64:67], v[120:123]
    ds_read_b64_tr_b16 v[42:43], v11 offset:33792
    v_mfma_f32_16x16x32_bf16 v[124:127], v[76:79], v[52:55], v[124:127]
    ds_read_b64_tr_b16 v[44:45], v10 offset:40960
    v_mfma_f32_16x16x32_bf16 v[128:131], v[76:79], v[56:59], v[128:131]
    ds_read_b64_tr_b16 v[46:47], v10 offset:41984
    v_mfma_f32_16x16x32_bf16 v[132:135], v[76:79], v[60:63], v[132:135]
    ds_read_b64_tr_b16 v[48:49], v11 offset:40960
    v_mfma_f32_16x16x32_bf16 v[136:139], v[76:79], v[64:67], v[136:139]
    ds_read_b64_tr_b16 v[50:51], v11 offset:41984
    v_mfma_f32_16x16x32_bf16 v[140:143], v[80:83], v[52:55], v[140:143]
    v_mfma_f32_16x16x32_bf16 v[144:147], v[80:83], v[56:59], v[144:147]
    v_mfma_f32_16x16x32_bf16 v[148:151], v[80:83], v[60:63], v[148:151]
    v_mfma_f32_16x16x32_bf16 v[152:155], v[80:83], v[64:67], v[152:155]
    s_waitcnt lgkmcnt(0)
    s_barrier
    v_mfma_f32_16x16x32_bf16 v[92:95], v[36:39], v[20:23], v[92:95]
    ds_read_b64_tr_b16 v[68:69], v12 offset:0
    v_mfma_f32_16x16x32_bf16 v[96:99], v[36:39], v[24:27], v[96:99]
    ds_read_b64_tr_b16 v[70:71], v12 offset:1024
    v_mfma_f32_16x16x32_bf16 v[100:103], v[36:39], v[28:31], v[100:103]
    ds_read_b128 v[52:55], v9 offset:32768
    v_mfma_f32_16x16x32_bf16 v[104:107], v[36:39], v[32:35], v[104:107]
    ds_read_b128 v[56:59], v9 offset:34816
    v_mfma_f32_16x16x32_bf16 v[108:111], v[40:43], v[20:23], v[108:111]
    ds_read_b128 v[60:63], v9 offset:36864
    v_mfma_f32_16x16x32_bf16 v[112:115], v[40:43], v[24:27], v[112:115]
    ds_read_b128 v[64:67], v9 offset:38912
    v_mfma_f32_16x16x32_bf16 v[116:119], v[40:43], v[28:31], v[116:119]
    ds_read_b64_tr_b16 v[72:73], v13 offset:0
    v_mfma_f32_16x16x32_bf16 v[120:123], v[40:43], v[32:35], v[120:123]
    ds_read_b64_tr_b16 v[74:75], v13 offset:1024
    v_mfma_f32_16x16x32_bf16 v[124:127], v[44:47], v[20:23], v[124:127]
    ds_read_b64_tr_b16 v[76:77], v12 offset:8192
    v_mfma_f32_16x16x32_bf16 v[128:131], v[44:47], v[24:27], v[128:131]
    ds_read_b64_tr_b16 v[78:79], v12 offset:9216
    v_mfma_f32_16x16x32_bf16 v[132:135], v[44:47], v[28:31], v[132:135]
    ds_read_b64_tr_b16 v[80:81], v13 offset:8192
    v_mfma_f32_16x16x32_bf16 v[136:139], v[44:47], v[32:35], v[136:139]
    ds_read_b64_tr_b16 v[82:83], v13 offset:9216
    v_mfma_f32_16x16x32_bf16 v[140:143], v[48:51], v[20:23], v[140:143]
    v_mfma_f32_16x16x32_bf16 v[144:147], v[48:51], v[24:27], v[144:147]
    v_mfma_f32_16x16x32_bf16 v[148:151], v[48:51], v[28:31], v[148:151]
    v_mfma_f32_16x16x32_bf16 v[152:155], v[48:51], v[32:35], v[152:155]
    s_waitcnt lgkmcnt(0)
    s_barrier
    v_mfma_f32_16x16x32_bf16 v[92:95], v[68:71], v[52:55], v[92:95]
    ds_read_b64_tr_b16 v[36:37], v12 offset:16384
    v_mfma_f32_16x16x32_bf16 v[96:99], v[68:71], v[56:59], v[96:99]
    ds_read_b64_tr_b16 v[38:39], v12 offset:17408
    v_mfma_f32_16x16x32_bf16 v[100:103], v[68:71], v[60:63], v[100:103]
    ds_read_b128 v[20:23], v8 offset:49152
    v_mfma_f32_16x16x32_bf16 v[104:107], v[68:71], v[64:67], v[104:107]
    ds_read_b128 v[24:27], v8 offset:51200
    v_mfma_f32_16x16x32_bf16 v[108:111], v[72:75], v[52:55], v[108:111]
    ds_read_b128 v[28:31], v8 offset:53248
    v_mfma_f32_16x16x32_bf16 v[112:115], v[72:75], v[56:59], v[112:115]
    ds_read_b128 v[32:35], v8 offset:55296
    v_mfma_f32_16x16x32_bf16 v[116:119], v[72:75], v[60:63], v[116:119]
    ds_read_b64_tr_b16 v[40:41], v13 offset:16384
    v_mfma_f32_16x16x32_bf16 v[120:123], v[72:75], v[64:67], v[120:123]
    ds_read_b64_tr_b16 v[42:43], v13 offset:17408
    v_mfma_f32_16x16x32_bf16 v[124:127], v[76:79], v[52:55], v[124:127]
    ds_read_b64_tr_b16 v[44:45], v12 offset:24576
    v_mfma_f32_16x16x32_bf16 v[128:131], v[76:79], v[56:59], v[128:131]
    ds_read_b64_tr_b16 v[46:47], v12 offset:25600
    v_mfma_f32_16x16x32_bf16 v[132:135], v[76:79], v[60:63], v[132:135]
    ds_read_b64_tr_b16 v[48:49], v13 offset:24576
    v_mfma_f32_16x16x32_bf16 v[136:139], v[76:79], v[64:67], v[136:139]
    ds_read_b64_tr_b16 v[50:51], v13 offset:25600
    v_mfma_f32_16x16x32_bf16 v[140:143], v[80:83], v[52:55], v[140:143]
    v_mfma_f32_16x16x32_bf16 v[144:147], v[80:83], v[56:59], v[144:147]
    v_mfma_f32_16x16x32_bf16 v[148:151], v[80:83], v[60:63], v[148:151]
    v_mfma_f32_16x16x32_bf16 v[152:155], v[80:83], v[64:67], v[152:155]
    s_waitcnt lgkmcnt(0)
    s_barrier
    v_mfma_f32_16x16x32_bf16 v[92:95], v[36:39], v[20:23], v[92:95]
    ds_read_b64_tr_b16 v[68:69], v10 offset:0
    v_mfma_f32_16x16x32_bf16 v[96:99], v[36:39], v[24:27], v[96:99]
    ds_read_b64_tr_b16 v[70:71], v10 offset:1024
    v_mfma_f32_16x16x32_bf16 v[100:103], v[36:39], v[28:31], v[100:103]
    ds_read_b128 v[52:55], v9 offset:49152
    v_mfma_f32_16x16x32_bf16 v[104:107], v[36:39], v[32:35], v[104:107]
    ds_read_b128 v[56:59], v9 offset:51200
    v_mfma_f32_16x16x32_bf16 v[108:111], v[40:43], v[20:23], v[108:111]
    ds_read_b128 v[60:63], v9 offset:53248
    v_mfma_f32_16x16x32_bf16 v[112:115], v[40:43], v[24:27], v[112:115]
    ds_read_b128 v[64:67], v9 offset:55296
    v_mfma_f32_16x16x32_bf16 v[116:119], v[40:43], v[28:31], v[116:119]
    ds_read_b64_tr_b16 v[72:73], v11 offset:0
    v_mfma_f32_16x16x32_bf16 v[120:123], v[40:43], v[32:35], v[120:123]
    ds_read_b64_tr_b16 v[74:75], v11 offset:1024
    v_mfma_f32_16x16x32_bf16 v[124:127], v[44:47], v[20:23], v[124:127]
    ds_read_b64_tr_b16 v[76:77], v10 offset:8192
    v_mfma_f32_16x16x32_bf16 v[128:131], v[44:47], v[24:27], v[128:131]
    ds_read_b64_tr_b16 v[78:79], v10 offset:9216
    v_mfma_f32_16x16x32_bf16 v[132:135], v[44:47], v[28:31], v[132:135]
    ds_read_b64_tr_b16 v[80:81], v11 offset:8192
    v_mfma_f32_16x16x32_bf16 v[136:139], v[44:47], v[32:35], v[136:139]
    ds_read_b64_tr_b16 v[82:83], v11 offset:9216
    v_mfma_f32_16x16x32_bf16 v[140:143], v[48:51], v[20:23], v[140:143]
    v_mfma_f32_16x16x32_bf16 v[144:147], v[48:51], v[24:27], v[144:147]
    v_mfma_f32_16x16x32_bf16 v[148:151], v[48:51], v[28:31], v[148:151]
    v_mfma_f32_16x16x32_bf16 v[152:155], v[48:51], v[32:35], v[152:155]
    s_waitcnt lgkmcnt(0)
    s_barrier
    v_mfma_f32_16x16x32_bf16 v[92:95], v[68:71], v[52:55], v[92:95]
    ds_read_b64_tr_b16 v[36:37], v10 offset:16384
    v_mfma_f32_16x16x32_bf16 v[96:99], v[68:71], v[56:59], v[96:99]
    ds_read_b64_tr_b16 v[38:39], v10 offset:17408
    v_mfma_f32_16x16x32_bf16 v[100:103], v[68:71], v[60:63], v[100:103]
    ds_read_b128 v[20:23], v8 offset:0
    v_mfma_f32_16x16x32_bf16 v[104:107], v[68:71], v[64:67], v[104:107]
    ds_read_b128 v[24:27], v8 offset:2048
    v_mfma_f32_16x16x32_bf16 v[108:111], v[72:75], v[52:55], v[108:111]
    ds_read_b128 v[28:31], v8 offset:4096
    v_mfma_f32_16x16x32_bf16 v[112:115], v[72:75], v[56:59], v[112:115]
    ds_read_b128 v[32:35], v8 offset:6144
    v_mfma_f32_16x16x32_bf16 v[116:119], v[72:75], v[60:63], v[116:119]
    ds_read_b64_tr_b16 v[40:41], v11 offset:16384
    v_mfma_f32_16x16x32_bf16 v[120:123], v[72:75], v[64:67], v[120:123]
    ds_read_b64_tr_b16 v[42:43], v11 offset:17408
    v_mfma_f32_16x16x32_bf16 v[124:127], v[76:79], v[52:55], v[124:127]
    ds_read_b64_tr_b16 v[44:45], v10 offset:24576
    v_mfma_f32_16x16x32_bf16 v[128:131], v[76:79], v[56:59], v[128:131]
    ds_read_b64_tr_b16 v[46:47], v10 offset:25600
    v_mfma_f32_16x16x32_bf16 v[132:135], v[76:79], v[60:63], v[132:135]
    ds_read_b64_tr_b16 v[48:49], v11 offset:24576
    v_mfma_f32_16x16x32_bf16 v[136:139], v[76:79], v[64:67], v[136:139]
    ds_read_b64_tr_b16 v[50:51], v11 offset:25600
    v_mfma_f32_16x16x32_bf16 v[140:143], v[80:83], v[52:55], v[140:143]
    v_mfma_f32_16x16x32_bf16 v[144:147], v[80:83], v[56:59], v[144:147]
    v_mfma_f32_16x16x32_bf16 v[148:151], v[80:83], v[60:63], v[148:151]
    v_mfma_f32_16x16x32_bf16 v[152:155], v[80:83], v[64:67], v[152:155]
    s_waitcnt lgkmcnt(0)
    s_barrier
    v_mfma_f32_16x16x32_bf16 v[92:95], v[36:39], v[20:23], v[92:95]
    ds_read_b64_tr_b16 v[68:69], v10 offset:32768
    v_mfma_f32_16x16x32_bf16 v[96:99], v[36:39], v[24:27], v[96:99]
    ds_read_b64_tr_b16 v[70:71], v10 offset:33792
    v_mfma_f32_16x16x32_bf16 v[100:103], v[36:39], v[28:31], v[100:103]
    ds_read_b128 v[52:55], v9 offset:0
    v_mfma_f32_16x16x32_bf16 v[104:107], v[36:39], v[32:35], v[104:107]
    ds_read_b128 v[56:59], v9 offset:2048
    v_mfma_f32_16x16x32_bf16 v[108:111], v[40:43], v[20:23], v[108:111]
    ds_read_b128 v[60:63], v9 offset:4096
    v_mfma_f32_16x16x32_bf16 v[112:115], v[40:43], v[24:27], v[112:115]
    ds_read_b128 v[64:67], v9 offset:6144
    v_mfma_f32_16x16x32_bf16 v[116:119], v[40:43], v[28:31], v[116:119]
    ds_read_b64_tr_b16 v[72:73], v11 offset:32768
    v_mfma_f32_16x16x32_bf16 v[120:123], v[40:43], v[32:35], v[120:123]
    ds_read_b64_tr_b16 v[74:75], v11 offset:33792
    v_mfma_f32_16x16x32_bf16 v[124:127], v[44:47], v[20:23], v[124:127]
    ds_read_b64_tr_b16 v[76:77], v10 offset:40960
    v_mfma_f32_16x16x32_bf16 v[128:131], v[44:47], v[24:27], v[128:131]
    ds_read_b64_tr_b16 v[78:79], v10 offset:41984
    v_mfma_f32_16x16x32_bf16 v[132:135], v[44:47], v[28:31], v[132:135]
    ds_read_b64_tr_b16 v[80:81], v11 offset:40960
    v_mfma_f32_16x16x32_bf16 v[136:139], v[44:47], v[32:35], v[136:139]
    ds_read_b64_tr_b16 v[82:83], v11 offset:41984
    v_mfma_f32_16x16x32_bf16 v[140:143], v[48:51], v[20:23], v[140:143]
    v_mfma_f32_16x16x32_bf16 v[144:147], v[48:51], v[24:27], v[144:147]
    v_mfma_f32_16x16x32_bf16 v[148:151], v[48:51], v[28:31], v[148:151]
    v_mfma_f32_16x16x32_bf16 v[152:155], v[48:51], v[32:35], v[152:155]
    s_waitcnt lgkmcnt(0)
    s_barrier
    v_mfma_f32_16x16x32_bf16 v[92:95], v[68:71], v[52:55], v[92:95]
    ds_read_b64_tr_b16 v[36:37], v12 offset:0
    v_mfma_f32_16x16x32_bf16 v[96:99], v[68:71], v[56:59], v[96:99]
    ds_read_b64_tr_b16 v[38:39], v12 offset:1024
    v_mfma_f32_16x16x32_bf16 v[100:103], v[68:71], v[60:63], v[100:103]
    ds_read_b128 v[20:23], v8 offset:16384
    v_mfma_f32_16x16x32_bf16 v[104:107], v[68:71], v[64:67], v[104:107]
    ds_read_b128 v[24:27], v8 offset:18432
    v_mfma_f32_16x16x32_bf16 v[108:111], v[72:75], v[52:55], v[108:111]
    ds_read_b128 v[28:31], v8 offset:20480
    v_mfma_f32_16x16x32_bf16 v[112:115], v[72:75], v[56:59], v[112:115]
    ds_read_b128 v[32:35], v8 offset:22528
    v_mfma_f32_16x16x32_bf16 v[116:119], v[72:75], v[60:63], v[116:119]
    ds_read_b64_tr_b16 v[40:41], v13 offset:0
    v_mfma_f32_16x16x32_bf16 v[120:123], v[72:75], v[64:67], v[120:123]
    ds_read_b64_tr_b16 v[42:43], v13 offset:1024
    v_mfma_f32_16x16x32_bf16 v[124:127], v[76:79], v[52:55], v[124:127]
    ds_read_b64_tr_b16 v[44:45], v12 offset:8192
    v_mfma_f32_16x16x32_bf16 v[128:131], v[76:79], v[56:59], v[128:131]
    ds_read_b64_tr_b16 v[46:47], v12 offset:9216
    v_mfma_f32_16x16x32_bf16 v[132:135], v[76:79], v[60:63], v[132:135]
    ds_read_b64_tr_b16 v[48:49], v13 offset:8192
    v_mfma_f32_16x16x32_bf16 v[136:139], v[76:79], v[64:67], v[136:139]
    ds_read_b64_tr_b16 v[50:51], v13 offset:9216
    v_mfma_f32_16x16x32_bf16 v[140:143], v[80:83], v[52:55], v[140:143]
    v_mfma_f32_16x16x32_bf16 v[144:147], v[80:83], v[56:59], v[144:147]
    v_mfma_f32_16x16x32_bf16 v[148:151], v[80:83], v[60:63], v[148:151]
    v_mfma_f32_16x16x32_bf16 v[152:155], v[80:83], v[64:67], v[152:155]
    s_waitcnt lgkmcnt(0)
    s_barrier
    v_mfma_f32_16x16x32_bf16 v[92:95], v[36:39], v[20:23], v[92:95]
    ds_read_b64_tr_b16 v[68:69], v12 offset:16384
    v_mfma_f32_16x16x32_bf16 v[96:99], v[36:39], v[24:27], v[96:99]
    ds_read_b64_tr_b16 v[70:71], v12 offset:17408
    v_mfma_f32_16x16x32_bf16 v[100:103], v[36:39], v[28:31], v[100:103]
    ds_read_b128 v[52:55], v9 offset:16384
    v_mfma_f32_16x16x32_bf16 v[104:107], v[36:39], v[32:35], v[104:107]
    ds_read_b128 v[56:59], v9 offset:18432
    v_mfma_f32_16x16x32_bf16 v[108:111], v[40:43], v[20:23], v[108:111]
    ds_read_b128 v[60:63], v9 offset:20480
    v_mfma_f32_16x16x32_bf16 v[112:115], v[40:43], v[24:27], v[112:115]
    ds_read_b128 v[64:67], v9 offset:22528
    v_mfma_f32_16x16x32_bf16 v[116:119], v[40:43], v[28:31], v[116:119]
    ds_read_b64_tr_b16 v[72:73], v13 offset:16384
    v_mfma_f32_16x16x32_bf16 v[120:123], v[40:43], v[32:35], v[120:123]
    ds_read_b64_tr_b16 v[74:75], v13 offset:17408
    v_mfma_f32_16x16x32_bf16 v[124:127], v[44:47], v[20:23], v[124:127]
    ds_read_b64_tr_b16 v[76:77], v12 offset:24576
    v_mfma_f32_16x16x32_bf16 v[128:131], v[44:47], v[24:27], v[128:131]
    ds_read_b64_tr_b16 v[78:79], v12 offset:25600
    v_mfma_f32_16x16x32_bf16 v[132:135], v[44:47], v[28:31], v[132:135]
    ds_read_b64_tr_b16 v[80:81], v13 offset:24576
    v_mfma_f32_16x16x32_bf16 v[136:139], v[44:47], v[32:35], v[136:139]
    ds_read_b64_tr_b16 v[82:83], v13 offset:25600
    v_mfma_f32_16x16x32_bf16 v[140:143], v[48:51], v[20:23], v[140:143]
    v_mfma_f32_16x16x32_bf16 v[144:147], v[48:51], v[24:27], v[144:147]
    v_mfma_f32_16x16x32_bf16 v[148:151], v[48:51], v[28:31], v[148:151]
    v_mfma_f32_16x16x32_bf16 v[152:155], v[48:51], v[32:35], v[152:155]
    s_waitcnt lgkmcnt(0)
    v_mfma_f32_16x16x32_bf16 v[92:95], v[68:71], v[52:55], v[92:95]
    v_mfma_f32_16x16x32_bf16 v[108:111], v[72:75], v[52:55], v[108:111]
    v_mfma_f32_16x16x32_bf16 v[124:127], v[76:79], v[52:55], v[124:127]
    v_mfma_f32_16x16x32_bf16 v[140:143], v[80:83], v[52:55], v[140:143]
    v_mfma_f32_16x16x32_bf16 v[96:99], v[68:71], v[56:59], v[96:99]
    v_mfma_f32_16x16x32_bf16 v[112:115], v[72:75], v[56:59], v[112:115]
    v_mfma_f32_16x16x32_bf16 v[128:131], v[76:79], v[56:59], v[128:131]
    v_mfma_f32_16x16x32_bf16 v[144:147], v[80:83], v[56:59], v[144:147]
    v_mfma_f32_16x16x32_bf16 v[100:103], v[68:71], v[60:63], v[100:103]
    v_mfma_f32_16x16x32_bf16 v[116:119], v[72:75], v[60:63], v[116:119]
    v_mfma_f32_16x16x32_bf16 v[132:135], v[76:79], v[60:63], v[132:135]
    v_mfma_f32_16x16x32_bf16 v[148:151], v[80:83], v[60:63], v[148:151]
    v_mov_b32 v0, 151608
    ds_read_b32 v0, v0
    v_mfma_f32_16x16x32_bf16 v[104:107], v[68:71], v[64:67], v[104:107]
    v_mfma_f32_16x16x32_bf16 v[120:123], v[72:75], v[64:67], v[120:123]
    v_mfma_f32_16x16x32_bf16 v[136:139], v[76:79], v[64:67], v[136:139]
    v_mfma_f32_16x16x32_bf16 v[152:155], v[80:83], v[64:67], v[152:155]
    s_waitcnt lgkmcnt(0)
    v_readfirstlane_b32 s49, v0
    v_mov_b32 v0, 151608
    ds_read_b32 v0, v0
    s_andn2_b32 s49, s25, s49
    s_cbranch_scc1 E_s0
E_g0:
    buffer_load_dwordx4 v[4:7], v1, s[32:35], s21 offen offset:0 sc1
    buffer_load_dwordx2 v[36:37], v2, s[32:35], s22 offen offset:0 sc1
    buffer_load_dwordx4 v[44:47], v3, s[32:35], s23 offen offset:0 sc1
    buffer_load_dwordx4 v[48:51], v3, s[32:35], s23 offen offset:768 sc1
E_s0:
    v_mul_f32 v84, v92, v92
    v_mul_f32 v85, v93, v93
    v_mul_f32 v86, v94, v94
    v_mul_f32 v87, v95, v95
    v_mul_f32 v88, v108, v108
    v_mul_f32 v89, v109, v109
    v_mul_f32 v90, v110, v110
    v_mul_f32 v91, v111, v111
    v_fma_f32 v84, v84, s52, v162
    v_fma_f32 v85, v85, s52, v162
    v_fma_f32 v86, v86, s52, v162
    v_fma_f32 v87, v87, s52, v162
    v_fma_f32 v88, v88, s52, v162
    v_fma_f32 v89, v89, s52, v162
    v_fma_f32 v90, v90, s52, v162
    v_fma_f32 v91, v91, s52, v162
    v_mul_f32 v84, v84, v92
    v_mul_f32 v85, v85, v93
    v_mul_f32 v86, v86, v94
    v_mul_f32 v87, v87, v95
    v_mul_f32 v88, v88, v108
    v_mul_f32 v89, v89, v109
    v_mul_f32 v90, v90, v110
    v_mul_f32 v91, v91, v111
    v_exp_f32 v84, v84
    v_exp_f32 v85, v85
    v_exp_f32 v86, v86
    v_exp_f32 v87, v87
    v_exp_f32 v88, v88
    v_exp_f32 v89, v89
    v_exp_f32 v90, v90
    v_exp_f32 v91, v91
    v_mul_f32 v92, v92, v124
    v_mul_f32 v93, v93, v125
    v_mul_f32 v94, v94, v126
    v_mul_f32 v95, v95, v127
    v_mul_f32 v108, v108, v140
    v_mul_f32 v109, v109, v141
    v_mul_f32 v110, v110, v142
    v_mul_f32 v111, v111, v143
    v_add_f32 v84, 1.0, v84
    v_add_f32 v85, 1.0, v85
    v_add_f32 v86, 1.0, v86
    v_add_f32 v87, 1.0, v87
    v_add_f32 v88, 1.0, v88
    v_add_f32 v89, 1.0, v89
    v_add_f32 v90, 1.0, v90
    v_add_f32 v91, 1.0, v91
    v_rcp_f32 v84, v84
    v_rcp_f32 v85, v85
    v_rcp_f32 v86, v86
    v_rcp_f32 v87, v87
    v_rcp_f32 v88, v88
    v_rcp_f32 v89, v89
    v_rcp_f32 v90, v90
    v_rcp_f32 v91, v91
    v_mul_f32 v84, v92, v84
    v_mul_f32 v85, v93, v85
    v_mul_f32 v86, v94, v86
    v_mul_f32 v87, v95, v87
    v_mul_f32 v88, v108, v88
    v_mul_f32 v89, v109, v89
    v_mul_f32 v90, v110, v90
    v_mul_f32 v91, v111, v91
    v_cvt_pk_bf16_f32 v124, v84, v85
    v_cvt_pk_bf16_f32 v125, v86, v87
    v_cvt_pk_bf16_f32 v126, v88, v89
    v_cvt_pk_bf16_f32 v127, v90, v91
    ds_write_b128 v160, v[124:127] offset:0
    s_cmp_eq_u32 s49, 0
    s_cbranch_scc1 E_g1
    s_waitcnt lgkmcnt(0)
    v_readfirstlane_b32 s49, v0
    v_mov_b32 v0, 151608
    ds_read_b32 v0, v0
    s_andn2_b32 s49, s25, s49
    s_cbranch_scc1 E_s1
    s_branch E_c1
E_g1:
    buffer_load_dwordx4 v[8:11], v1, s[32:35], s21 offen offset:1024 sc1
    buffer_load_dwordx4 v[52:55], v3, s[32:35], s23 offen offset:1536 sc1
    buffer_load_dwordx4 v[56:59], v3, s[32:35], s23 offen offset:2304 sc1
E_s1:
    v_mul_f32 v84, v96, v96
    v_mul_f32 v85, v97, v97
    v_mul_f32 v86, v98, v98
    v_mul_f32 v87, v99, v99
    v_mul_f32 v88, v112, v112
    v_mul_f32 v89, v113, v113
    v_mul_f32 v90, v114, v114
    v_mul_f32 v91, v115, v115
    v_fma_f32 v84, v84, s52, v162
    v_fma_f32 v85, v85, s52, v162
    v_fma_f32 v86, v86, s52, v162
    v_fma_f32 v87, v87, s52, v162
    v_fma_f32 v88, v88, s52, v162
    v_fma_f32 v89, v89, s52, v162
    v_fma_f32 v90, v90, s52, v162
    v_fma_f32 v91, v91, s52, v162
    v_mul_f32 v84, v84, v96
    v_mul_f32 v85, v85, v97
    v_mul_f32 v86, v86, v98
    v_mul_f32 v87, v87, v99
    v_mul_f32 v88, v88, v112
    v_mul_f32 v89, v89, v113
    v_mul_f32 v90, v90, v114
    v_mul_f32 v91, v91, v115
    v_exp_f32 v84, v84
    v_exp_f32 v85, v85
    v_exp_f32 v86, v86
    v_exp_f32 v87, v87
    v_exp_f32 v88, v88
    v_exp_f32 v89, v89
    v_exp_f32 v90, v90
    v_exp_f32 v91, v91
    v_mul_f32 v96, v96, v128
    v_mul_f32 v97, v97, v129
    v_mul_f32 v98, v98, v130
    v_mul_f32 v99, v99, v131
    v_mul_f32 v112, v112, v144
    v_mul_f32 v113, v113, v145
    v_mul_f32 v114, v114, v146
    v_mul_f32 v115, v115, v147
    v_add_f32 v84, 1.0, v84
    v_add_f32 v85, 1.0, v85
    v_add_f32 v86, 1.0, v86
    v_add_f32 v87, 1.0, v87
    v_add_f32 v88, 1.0, v88
    v_add_f32 v89, 1.0, v89
    v_add_f32 v90, 1.0, v90
    v_add_f32 v91, 1.0, v91
    v_rcp_f32 v84, v84
    v_rcp_f32 v85, v85
    v_rcp_f32 v86, v86
    v_rcp_f32 v87, v87
    v_rcp_f32 v88, v88
    v_rcp_f32 v89, v89
    v_rcp_f32 v90, v90
    v_rcp_f32 v91, v91
    v_mul_f32 v84, v96, v84
    v_mul_f32 v85, v97, v85
    v_mul_f32 v86, v98, v86
    v_mul_f32 v87, v99, v87
    v_mul_f32 v88, v112, v88
    v_mul_f32 v89, v113, v89
    v_mul_f32 v90, v114, v90
    v_mul_f32 v91, v115, v91
    v_cvt_pk_bf16_f32 v128, v84, v85
    v_cvt_pk_bf16_f32 v129, v86, v87
    v_cvt_pk_bf16_f32 v130, v88, v89
    v_cvt_pk_bf16_f32 v131, v90, v91
    ds_write_b128 v160, v[128:131] offset:256
    s_cmp_eq_u32 s49, 0
    s_cbranch_scc1 E_g2
    s_waitcnt lgkmcnt(0)
    v_readfirstlane_b32 s49, v0
    v_mov_b32 v0, 151608
    ds_read_b32 v0, v0
    s_andn2_b32 s49, s25, s49
    s_cbranch_scc1 E_s2
    s_branch E_c2
E_g2:
    buffer_load_dwordx4 v[12:15], v1, s[32:35], s21 offen offset:2048 sc1
    buffer_load_dwordx2 v[38:39], v2, s[32:35], s22 offen offset:512 sc1
    s_add_u32 s23, s23, 3072
    buffer_load_dwordx4 v[60:63], v3, s[32:35], s23 offen offset:0 sc1
    buffer_load_dwordx4 v[64:67], v3, s[32:35], s23 offen offset:768 sc1
E_s2:
    v_mul_f32 v84, v100, v100
    v_mul_f32 v85, v101, v101
    v_mul_f32 v86, v102, v102
    v_mul_f32 v87, v103, v103
    v_mul_f32 v88, v116, v116
    v_mul_f32 v89, v117, v117
    v_mul_f32 v90, v118, v118
    v_mul_f32 v91, v119, v119
    v_fma_f32 v84, v84, s52, v162
    v_fma_f32 v85, v85, s52, v162
    v_fma_f32 v86, v86, s52, v162
    v_fma_f32 v87, v87, s52, v162
    v_fma_f32 v88, v88, s52, v162
    v_fma_f32 v89, v89, s52, v162
    v_fma_f32 v90, v90, s52, v162
    v_fma_f32 v91, v91, s52, v162
    v_mul_f32 v84, v84, v100
    v_mul_f32 v85, v85, v101
    v_mul_f32 v86, v86, v102
    v_mul_f32 v87, v87, v103
    v_mul_f32 v88, v88, v116
    v_mul_f32 v89, v89, v117
    v_mul_f32 v90, v90, v118
    v_mul_f32 v91, v91, v119
    v_exp_f32 v84, v84
    v_exp_f32 v85, v85
    v_exp_f32 v86, v86
    v_exp_f32 v87, v87
    v_exp_f32 v88, v88
    v_exp_f32 v89, v89
    v_exp_f32 v90, v90
    v_exp_f32 v91, v91
    v_mul_f32 v100, v100, v132
    v_mul_f32 v101, v101, v133
    v_mul_f32 v102, v102, v134
    v_mul_f32 v103, v103, v135
    v_mul_f32 v116, v116, v148
    v_mul_f32 v117, v117, v149
    v_mul_f32 v118, v118, v150
    v_mul_f32 v119, v119, v151
    v_add_f32 v84, 1.0, v84
    v_add_f32 v85, 1.0, v85
    v_add_f32 v86, 1.0, v86
    v_add_f32 v87, 1.0, v87
    v_add_f32 v88, 1.0, v88
    v_add_f32 v89, 1.0, v89
    v_add_f32 v90, 1.0, v90
    v_add_f32 v91, 1.0, v91
    v_rcp_f32 v84, v84
    v_rcp_f32 v85, v85
    v_rcp_f32 v86, v86
    v_rcp_f32 v87, v87
    v_rcp_f32 v88, v88
    v_rcp_f32 v89, v89
    v_rcp_f32 v90, v90
    v_rcp_f32 v91, v91
    v_mul_f32 v84, v100, v84
    v_mul_f32 v85, v101, v85
    v_mul_f32 v86, v102, v86
    v_mul_f32 v87, v103, v87
    v_mul_f32 v88, v116, v88
    v_mul_f32 v89, v117, v89
    v_mul_f32 v90, v118, v90
    v_mul_f32 v91, v119, v91
    v_cvt_pk_bf16_f32 v132, v84, v85
    v_cvt_pk_bf16_f32 v133, v86, v87
    v_cvt_pk_bf16_f32 v134, v88, v89
    v_cvt_pk_bf16_f32 v135, v90, v91
    ds_write_b128 v160, v[132:135] offset:4096
    s_cmp_eq_u32 s49, 0
    s_cbranch_scc1 E_g3
    s_waitcnt lgkmcnt(0)
    v_readfirstlane_b32 s49, v0
    v_mov_b32 v0, 151608
    ds_read_b32 v0, v0
    s_andn2_b32 s49, s25, s49
    s_cbranch_scc1 E_s3
    s_branch E_c3
E_g3:
    buffer_load_dwordx4 v[16:19], v1, s[32:35], s21 offen offset:3072 sc1
    buffer_load_dwordx4 v[68:71], v3, s[32:35], s23 offen offset:1536 sc1
    buffer_load_dwordx4 v[72:75], v3, s[32:35], s23 offen offset:2304 sc1
E_s3:
    v_mul_f32 v84, v104, v104
    v_mul_f32 v85, v105, v105
    v_mul_f32 v86, v106, v106
    v_mul_f32 v87, v107, v107
    v_mul_f32 v88, v120, v120
    v_mul_f32 v89, v121, v121
    v_mul_f32 v90, v122, v122
    v_mul_f32 v91, v123, v123
    v_fma_f32 v84, v84, s52, v162
    v_fma_f32 v85, v85, s52, v162
    v_fma_f32 v86, v86, s52, v162
    v_fma_f32 v87, v87, s52, v162
    v_fma_f32 v88, v88, s52, v162
    v_fma_f32 v89, v89, s52, v162
    v_fma_f32 v90, v90, s52, v162
    v_fma_f32 v91, v91, s52, v162
    v_mul_f32 v84, v84, v104
    v_mul_f32 v85, v85, v105
    v_mul_f32 v86, v86, v106
    v_mul_f32 v87, v87, v107
    v_mul_f32 v88, v88, v120
    v_mul_f32 v89, v89, v121
    v_mul_f32 v90, v90, v122
    v_mul_f32 v91, v91, v123
    v_exp_f32 v84, v84
    v_exp_f32 v85, v85
    v_exp_f32 v86, v86
    v_exp_f32 v87, v87
    v_exp_f32 v88, v88
    v_exp_f32 v89, v89
    v_exp_f32 v90, v90
    v_exp_f32 v91, v91
    v_mul_f32 v104, v104, v136
    v_mul_f32 v105, v105, v137
    v_mul_f32 v106, v106, v138
    v_mul_f32 v107, v107, v139
    v_mul_f32 v120, v120, v152
    v_mul_f32 v121, v121, v153
    v_mul_f32 v122, v122, v154
    v_mul_f32 v123, v123, v155
    v_add_f32 v84, 1.0, v84
    v_add_f32 v85, 1.0, v85
    v_add_f32 v86, 1.0, v86
    v_add_f32 v87, 1.0, v87
    v_add_f32 v88, 1.0, v88
    v_add_f32 v89, 1.0, v89
    v_add_f32 v90, 1.0, v90
    v_add_f32 v91, 1.0, v91
    v_rcp_f32 v84, v84
    v_rcp_f32 v85, v85
    v_rcp_f32 v86, v86
    v_rcp_f32 v87, v87
    v_rcp_f32 v88, v88
    v_rcp_f32 v89, v89
    v_rcp_f32 v90, v90
    v_rcp_f32 v91, v91
    v_mul_f32 v84, v104, v84
    v_mul_f32 v85, v105, v85
    v_mul_f32 v86, v106, v86
    v_mul_f32 v87, v107, v87
    v_mul_f32 v88, v120, v88
    v_mul_f32 v89, v121, v89
    v_mul_f32 v90, v122, v90
    v_mul_f32 v91, v123, v91
    v_cvt_pk_bf16_f32 v136, v84, v85
    v_cvt_pk_bf16_f32 v137, v86, v87
    v_cvt_pk_bf16_f32 v138, v88, v89
    v_cvt_pk_bf16_f32 v139, v90, v91
    ds_write_b128 v160, v[136:139] offset:4352
    s_cmp_eq_u32 s49, 0
    s_cbranch_scc0 E_w
E_g4:
    s_waitcnt lgkmcnt(0)
    s_add_u32 s24, s18, 0
    s_and_b32 s24, s24, 3
    s_mul_i32 s24, s24, 2560
    s_add_u32 s24, s24, 151808
AT_q:
    v_mov_b32 v0, 151620
    ds_read_b32 v0, v0
    v_add_u32 v156, s24, v1
    ds_read_b128 v[156:159], v156
    s_mov_b32 exec_hi, 0
    v_add_u32 v164, s24, v2
    ds_read_b64 v[164:165], v164 offset:1024
    s_mov_b32 exec_hi, -1
    s_mov_b32 exec_lo, 0
    v_add_u32 v166, s24, v2
    ds_read_b64 v[166:167], v166 offset:768
    s_mov_b32 exec_lo, -1
    s_waitcnt lgkmcnt(0)
    v_readfirstlane_b32 s49, v0
    s_cmp_ge_u32 s49, 4
    s_cbranch_scc0 AT_qs
    s_waitcnt vmcnt(12)
    s_mov_b32 s28, 0
    v_mfma_f32_32x32x16_bf16 v[108:123], v[4:7], v[156:159], 0
    v_mfma_f32_32x32x8bf16_1k v[108:123], v[36:37], v[164:165], v[108:123]
    s_cmp_lt_u32 s18, 4
    s_nop 0
    s_cbranch_scc1 AT_bal0_0
    s_setprio 0
AT_bal0_0:
    s_nop 8
    v_exp_f32 v108, v108
    v_exp_f32 v109, v109
    v_exp_f32 v110, v110
    v_exp_f32 v111, v111
    s_waitcnt vmcnt(9)
    v_mfma_f32_32x32x16_bf16 v[124:139], v[8:11], v[156:159], 0
    v_exp_f32 v112, v112
    v_exp_f32 v113, v113
    v_cvt_pk_bf16_f32 v108, v108, v109
    v_exp_f32 v114, v114
    v_exp_f32 v115, v115
    v_cvt_pk_bf16_f32 v109, v110, v111
    v_mfma_f32_32x32x8bf16_1k v[124:139], v[36:37], v[166:167], v[124:139]
    v_exp_f32 v116, v116
    v_cvt_pk_bf16_f32 v110, v112, v113
    s_add_u32 s21, s21, 4096
    buffer_load_dwordx4 v[20:23], v1, s[32:35], s21 offen offset:0 sc1
    buffer_load_dwordx2 v[40:41], v2, s[32:35], s22 offen offset:1024 sc1
    s_add_u32 s23, s23, 3072
    buffer_load_dwordx4 v[76:79], v3, s[32:35], s23 offen offset:0 sc1
    buffer_load_dwordx4 v[80:83], v3, s[32:35], s23 offen offset:768 sc1
    v_cvt_pk_bf16_f32 v111, v114, v115
    v_exp_f32 v117, v117
    v_exp_f32 v118, v118
    v_exp_f32 v119, v119
    s_waitcnt vmcnt(14)
    v_mfma_f32_32x32x16_bf16 v[140:155], v[44:47], v[108:111], 0
    v_exp_f32 v120, v120
    v_exp_f32 v121, v121
    v_cvt_pk_bf16_f32 v116, v116, v117
    v_exp_f32 v122, v122
    v_exp_f32 v123, v123
    v_cvt_pk_bf16_f32 v117, v118, v119
    v_cvt_pk_bf16_f32 v118, v120, v121
    v_cvt_pk_bf16_f32 v119, v122, v123
    v_exp_f32 v124, v124
    v_exp_f32 v125, v125
    v_mfma_f32_32x32x16_bf16 v[140:155], v[48:51], v[116:119], v[140:155]
    v_exp_f32 v126, v126
    v_exp_f32 v127, v127
    s_waitcnt vmcnt(9)
    v_mfma_f32_32x32x16_bf16 v[108:123], v[12:15], v[156:159], 0
    v_exp_f32 v128, v128
    v_exp_f32 v129, v129
    v_cvt_pk_bf16_f32 v124, v124, v125
    v_exp_f32 v130, v130
    v_exp_f32 v131, v131
    v_cvt_pk_bf16_f32 v125, v126, v127
    v_mfma_f32_32x32x8bf16_1k v[108:123], v[38:39], v[164:165], v[108:123]
    v_exp_f32 v132, v132
    v_cvt_pk_bf16_f32 v126, v128, v129
    buffer_load_dwordx4 v[24:27], v1, s[32:35], s21 offen offset:1024 sc1
    buffer_load_dwordx4 v[84:87], v3, s[32:35], s23 offen offset:1536 sc1
    buffer_load_dwordx4 v[88:91], v3, s[32:35], s23 offen offset:2304 sc1
    s_barrier
    v_cvt_pk_bf16_f32 v127, v130, v131
    v_exp_f32 v133, v133
    v_exp_f32 v134, v134
    v_exp_f32 v135, v135
    s_waitcnt vmcnt(14)
    v_mfma_f32_32x32x16_bf16 v[140:155], v[52:55], v[124:127], v[140:155]
    v_exp_f32 v136, v136
    v_exp_f32 v137, v137
    v_cvt_pk_bf16_f32 v132, v132, v133
    v_exp_f32 v138, v138
    v_exp_f32 v139, v139
    v_cvt_pk_bf16_f32 v133, v134, v135
    v_cvt_pk_bf16_f32 v134, v136, v137
    v_cvt_pk_bf16_f32 v135, v138, v139
    s_cmp_lt_u32 s18, 4
    s_cbranch_scc1 AT_bal0_2
    s_setprio 1
AT_bal0_2:
    v_exp_f32 v108, v108
    v_exp_f32 v109, v109
    v_mfma_f32_32x32x16_bf16 v[140:155], v[56:59], v[132:135], v[140:155]
    v_exp_f32 v110, v110
    v_exp_f32 v111, v111
    s_waitcnt vmcnt(9)
    v_mfma_f32_32x32x16_bf16 v[124:139], v[16:19], v[156:159], 0
    v_exp_f32 v112, v112
    v_exp_f32 v113, v113
    v_cvt_pk_bf16_f32 v108, v108, v109
    v_exp_f32 v114, v114
    v_exp_f32 v115, v115
    v_cvt_pk_bf16_f32 v109, v110, v111
    v_mfma_f32_32x32x8bf16_1k v[124:139], v[38:39], v[166:167], v[124:139]
    v_exp_f32 v116, v116
    v_cvt_pk_bf16_f32 v110, v112, v113
    buffer_load_dwordx4 v[28:31], v1, s[32:35], s21 offen offset:2048 sc1
    buffer_load_dwordx2 v[42:43], v2, s[32:35], s22 offen offset:1536 sc1
    s_add_u32 s23, s23, 3072
    buffer_load_dwordx4 v[92:95], v3, s[32:35], s23 offen offset:0 sc1
    buffer_load_dwordx4 v[96:99], v3, s[32:35], s23 offen offset:768 sc1
    v_cvt_pk_bf16_f32 v111, v114, v115
    v_exp_f32 v117, v117
    v_exp_f32 v118, v118
    v_exp_f32 v119, v119
    s_waitcnt vmcnt(14)
    v_mfma_f32_32x32x16_bf16 v[140:155], v[60:63], v[108:111], v[140:155]
    v_exp_f32 v120, v120
    v_exp_f32 v121, v121
    v_cvt_pk_bf16_f32 v116, v116, v117
    v_exp_f32 v122, v122
    v_exp_f32 v123, v123
    v_cvt_pk_bf16_f32 v117, v118, v119
    v_cvt_pk_bf16_f32 v118, v120, v121
    v_cvt_pk_bf16_f32 v119, v122, v123
    v_exp_f32 v124, v124
    v_exp_f32 v125, v125
    v_mfma_f32_32x32x16_bf16 v[140:155], v[64:67], v[116:119], v[140:155]
    v_exp_f32 v126, v126
    v_exp_f32 v127, v127
    s_waitcnt vmcnt(9)
    v_mfma_f32_32x32x16_bf16 v[108:123], v[20:23], v[156:159], 0
    v_exp_f32 v128, v128
    v_exp_f32 v129, v129
    v_cvt_pk_bf16_f32 v124, v124, v125
    v_exp_f32 v130, v130
    v_exp_f32 v131, v131
    v_cvt_pk_bf16_f32 v125, v126, v127
    v_mfma_f32_32x32x8bf16_1k v[108:123], v[40:41], v[164:165], v[108:123]
    v_exp_f32 v132, v132
    v_cvt_pk_bf16_f32 v126, v128, v129
    buffer_load_dwordx4 v[32:35], v1, s[32:35], s21 offen offset:3072 sc1
    buffer_load_dwordx4 v[100:103], v3, s[32:35], s23 offen offset:1536 sc1
    buffer_load_dwordx4 v[104:107], v3, s[32:35], s23 offen offset:2304 sc1
    v_cvt_pk_bf16_f32 v127, v130, v131
    v_exp_f32 v133, v133
    v_exp_f32 v134, v134
    v_exp_f32 v135, v135
    s_waitcnt vmcnt(14)
    v_mfma_f32_32x32x16_bf16 v[140:155], v[68:71], v[124:127], v[140:155]
    v_exp_f32 v136, v136
    v_exp_f32 v137, v137
    v_cvt_pk_bf16_f32 v132, v132, v133
    v_exp_f32 v138, v138
    v_exp_f32 v139, v139
    v_cvt_pk_bf16_f32 v133, v134, v135
    v_cvt_pk_bf16_f32 v134, v136, v137
    v_cvt_pk_bf16_f32 v135, v138, v139
    v_exp_f32 v108, v108
    v_exp_f32 v109, v109
    v_mfma_f32_32x32x16_bf16 v[140:155], v[72:75], v[132:135], v[140:155]
    v_exp_f32 v110, v110
    v_exp_f32 v111, v111
    s_waitcnt vmcnt(9)
    v_mfma_f32_32x32x16_bf16 v[124:139], v[24:27], v[156:159], 0
    v_exp_f32 v112, v112
    v_exp_f32 v113, v113
    v_cvt_pk_bf16_f32 v108, v108, v109
    v_exp_f32 v114, v114
    v_exp_f32 v115, v115
    v_cvt_pk_bf16_f32 v109, v110, v111
    v_mfma_f32_32x32x8bf16_1k v[124:139], v[40:41], v[166:167], v[124:139]
    v_exp_f32 v116, v116
    v_cvt_pk_bf16_f32 v110, v112, v113
    v_cvt_pk_bf16_f32 v111, v114, v115
    v_exp_f32 v117, v117
    v_exp_f32 v118, v118
    v_exp_f32 v119, v119
    s_waitcnt vmcnt(10)
    v_mfma_f32_32x32x16_bf16 v[140:155], v[76:79], v[108:111], v[140:155]
    v_exp_f32 v120, v120
    v_exp_f32 v121, v121
    v_cvt_pk_bf16_f32 v116, v116, v117
    v_exp_f32 v122, v122
    v_exp_f32 v123, v123
    v_cvt_pk_bf16_f32 v117, v118, v119
    v_cvt_pk_bf16_f32 v118, v120, v121
    v_cvt_pk_bf16_f32 v119, v122, v123
    v_exp_f32 v124, v124
    v_exp_f32 v125, v125
    v_mfma_f32_32x32x16_bf16 v[140:155], v[80:83], v[116:119], v[140:155]
    v_exp_f32 v126, v126
    v_exp_f32 v127, v127
    s_waitcnt vmcnt(5)
    v_mfma_f32_32x32x16_bf16 v[108:123], v[28:31], v[156:159], 0
    v_exp_f32 v128, v128
    v_exp_f32 v129, v129
    v_cvt_pk_bf16_f32 v124, v124, v125
    v_exp_f32 v130, v130
    v_exp_f32 v131, v131
    v_cvt_pk_bf16_f32 v125, v126, v127
    v_mfma_f32_32x32x8bf16_1k v[108:123], v[42:43], v[164:165], v[108:123]
    v_exp_f32 v132, v132
    v_cvt_pk_bf16_f32 v126, v128, v129
    s_add_u32 s24, s18, 1
    s_and_b32 s24, s24, 3
    s_mul_i32 s24, s24, 2560
    s_add_u32 s24, s24, 151808
    v_add_u32 v160, s24, v1
    ds_read_b128 v[160:163], v160
    s_mov_b32 exec_hi, 0
    v_add_u32 v164, s24, v2
    ds_read_b64 v[164:165], v164 offset:1024
    s_mov_b32 exec_hi, -1
    v_cvt_pk_bf16_f32 v127, v130, v131
    v_exp_f32 v133, v133
    v_exp_f32 v134, v134
    v_exp_f32 v135, v135
    s_waitcnt vmcnt(7)
    v_mfma_f32_32x32x16_bf16 v[140:155], v[84:87], v[124:127], v[140:155]
    v_exp_f32 v136, v136
    v_exp_f32 v137, v137
    v_cvt_pk_bf16_f32 v132, v132, v133
    v_exp_f32 v138, v138
    v_exp_f32 v139, v139
    v_cvt_pk_bf16_f32 v133, v134, v135
    v_cvt_pk_bf16_f32 v134, v136, v137
    v_cvt_pk_bf16_f32 v135, v138, v139
    v_exp_f32 v108, v108
    v_exp_f32 v109, v109
    v_mfma_f32_32x32x16_bf16 v[140:155], v[88:91], v[132:135], v[140:155]
    v_exp_f32 v110, v110
    v_exp_f32 v111, v111
    s_waitcnt vmcnt(2)
    v_mfma_f32_32x32x16_bf16 v[124:139], v[32:35], v[156:159], 0
    v_exp_f32 v112, v112
    v_exp_f32 v113, v113
    v_cvt_pk_bf16_f32 v108, v108, v109
    v_exp_f32 v114, v114
    v_exp_f32 v115, v115
    v_cvt_pk_bf16_f32 v109, v110, v111
    v_mfma_f32_32x32x8bf16_1k v[124:139], v[42:43], v[166:167], v[124:139]
    v_exp_f32 v116, v116
    v_cvt_pk_bf16_f32 v110, v112, v113
    s_mov_b32 exec_lo, 0
    v_add_u32 v166, s24, v2
    ds_read_b64 v[166:167], v166 offset:768
    s_mov_b32 exec_lo, -1
    v_cvt_pk_bf16_f32 v111, v114, v115
    v_exp_f32 v117, v117
    v_exp_f32 v118, v118
    v_exp_f32 v119, v119
    s_waitcnt vmcnt(3)
    v_mfma_f32_32x32x16_bf16 v[140:155], v[92:95], v[108:111], v[140:155]
    v_exp_f32 v120, v120
    v_exp_f32 v121, v121
    v_cvt_pk_bf16_f32 v116, v116, v117
    v_exp_f32 v122, v122
    v_exp_f32 v123, v123
    v_cvt_pk_bf16_f32 v117, v118, v119
    v_cvt_pk_bf16_f32 v118, v120, v121
    v_cvt_pk_bf16_f32 v119, v122, v123
    v_exp_f32 v124, v124
    v_exp_f32 v125, v125
    v_mfma_f32_32x32x16_bf16 v[140:155], v[96:99], v[116:119], v[140:155]
    v_exp_f32 v126, v126
    v_exp_f32 v127, v127
    s_waitcnt lgkmcnt(0)
    v_mfma_f32_32x32x16_bf16 v[108:123], v[4:7], v[160:163], 0
    v_exp_f32 v128, v128
    v_exp_f32 v129, v129
    v_cvt_pk_bf16_f32 v124, v124, v125
    v_exp_f32 v130, v130
    v_exp_f32 v131, v131
    v_cvt_pk_bf16_f32 v125, v126, v127
    v_mfma_f32_32x32x8bf16_1k v[108:123], v[36:37], v[164:165], v[108:123]
    v_exp_f32 v132, v132
    v_cvt_pk_bf16_f32 v126, v128, v129
    s_add_u32 s47, s18, 0
    s_and_b32 s47, s47, 3
    s_and_b32 s48, s18, 4
    s_or_b32 s47, s47, s48
    s_mul_i32 s48, s47, 3072
    s_add_u32 s48, s48, 0
    s_lshl_b32 s47, s47, 2
    s_add_u32 s47, s47, 151552
    v_add_u32 v3, s48, v2
    v_mov_b32 v0, s47
    v_cvt_pk_bf16_f32 v127, v130, v131
    v_exp_f32 v133, v133
    v_exp_f32 v134, v134
    v_exp_f32 v135, v135
    s_waitcnt vmcnt(0)
    v_mfma_f32_32x32x16_bf16 v[140:155], v[100:103], v[124:127], v[140:155]
    v_exp_f32 v136, v136
    v_exp_f32 v137, v137
    v_cvt_pk_bf16_f32 v132, v132, v133
    v_exp_f32 v138, v138
    v_exp_f32 v139, v139
    v_cvt_pk_bf16_f32 v133, v134, v135
    v_cvt_pk_bf16_f32 v134, v136, v137
    v_cvt_pk_bf16_f32 v135, v138, v139
    s_cmp_lt_u32 s18, 4
    s_cbranch_scc1 AT_bal1_0
    s_setprio 0
AT_bal1_0:
    v_exp_f32 v108, v108
    v_exp_f32 v109, v109
    v_mfma_f32_32x32x16_bf16 v[140:155], v[104:107], v[132:135], v[140:155]
    v_exp_f32 v110, v110
    v_exp_f32 v111, v111
    v_mfma_f32_32x32x16_bf16 v[124:139], v[8:11], v[160:163], 0
    v_exp_f32 v112, v112
    v_exp_f32 v113, v113
    v_cvt_pk_bf16_f32 v108, v108, v109
    v_exp_f32 v114, v114
    v_exp_f32 v115, v115
    v_cvt_pk_bf16_f32 v109, v110, v111
    v_mfma_f32_32x32x8bf16_1k v[124:139], v[36:37], v[166:167], v[124:139]
    v_exp_f32 v116, v116
    v_cvt_pk_bf16_f32 v110, v112, v113
    ds_write2st64_b64 v3, v[140:141], v[142:143] offset0:0 offset1:1
    ds_write2st64_b64 v3, v[144:145], v[146:147] offset0:2 offset1:3
    ds_write2st64_b64 v3, v[148:149], v[150:151] offset0:4 offset1:5
    v_mov_b32 v0, s47
    v_mov_b32 v3, 1
    ds_write_b32 v0, v3
    v_cvt_pk_bf16_f32 v111, v114, v115
    v_exp_f32 v117, v117
    v_exp_f32 v118, v118
    v_exp_f32 v119, v119
    v_mfma_f32_32x32x16_bf16 v[140:155], v[44:47], v[108:111], 0
    v_exp_f32 v120, v120
    v_exp_f32 v121, v121
    v_cvt_pk_bf16_f32 v116, v116, v117
    v_exp_f32 v122, v122
    v_exp_f32 v123, v123
    v_cvt_pk_bf16_f32 v117, v118, v119
    v_cvt_pk_bf16_f32 v118, v120, v121
    v_cvt_pk_bf16_f32 v119, v122, v123
    v_exp_f32 v124, v124
    v_exp_f32 v125, v125
    v_mfma_f32_32x32x16_bf16 v[140:155], v[48:51], v[116:119], v[140:155]
    v_exp_f32 v126, v126
    v_exp_f32 v127, v127
    v_mfma_f32_32x32x16_bf16 v[108:123], v[12:15], v[160:163], 0
    v_exp_f32 v128, v128
    v_exp_f32 v129, v129
    v_cvt_pk_bf16_f32 v124, v124, v125
    v_exp_f32 v130, v130
    v_exp_f32 v131, v131
    v_cvt_pk_bf16_f32 v125, v126, v127
    v_mfma_f32_32x32x8bf16_1k v[108:123], v[38:39], v[164:165], v[108:123]
    v_exp_f32 v132, v132
    v_cvt_pk_bf16_f32 v126, v128, v129
    v_cvt_pk_bf16_f32 v127, v130, v131
    v_exp_f32 v133, v133
    v_exp_f32 v134, v134
    v_exp_f32 v135, v135
    v_mfma_f32_32x32x16_bf16 v[140:155], v[52:55], v[124:127], v[140:155]
    v_exp_f32 v136, v136
    v_exp_f32 v137, v137
    v_cvt_pk_bf16_f32 v132, v132, v133
    v_exp_f32 v138, v138
    v_exp_f32 v139, v139
    v_cvt_pk_bf16_f32 v133, v134, v135
    v_cvt_pk_bf16_f32 v134, v136, v137
    v_cvt_pk_bf16_f32 v135, v138, v139
    s_cmp_lt_u32 s18, 4
    s_cbranch_scc1 AT_bal1_2
    s_setprio 1
AT_bal1_2:
    v_exp_f32 v108, v108
    v_exp_f32 v109, v109
    v_mfma_f32_32x32x16_bf16 v[140:155], v[56:59], v[132:135], v[140:155]
    v_exp_f32 v110, v110
    v_exp_f32 v111, v111
    v_mfma_f32_32x32x16_bf16 v[124:139], v[16:19], v[160:163], 0
    v_exp_f32 v112, v112
    v_exp_f32 v113, v113
    v_cvt_pk_bf16_f32 v108, v108, v109
    v_exp_f32 v114, v114
    v_exp_f32 v115, v115
    v_cvt_pk_bf16_f32 v109, v110, v111
    v_mfma_f32_32x32x8bf16_1k v[124:139], v[38:39], v[166:167], v[124:139]
    v_exp_f32 v116, v116
    v_cvt_pk_bf16_f32 v110, v112, v113
    v_cvt_pk_bf16_f32 v111, v114, v115
    v_exp_f32 v117, v117
    v_exp_f32 v118, v118
    v_exp_f32 v119, v119
    v_mfma_f32_32x32x16_bf16 v[140:155], v[60:63], v[108:111], v[140:155]
    v_exp_f32 v120, v120
    v_exp_f32 v121, v121
    v_cvt_pk_bf16_f32 v116, v116, v117
    v_exp_f32 v122, v122
    v_exp_f32 v123, v123
    v_cvt_pk_bf16_f32 v117, v118, v119
    v_cvt_pk_bf16_f32 v118, v120, v121
    v_cvt_pk_bf16_f32 v119, v122, v123
    v_exp_f32 v124, v124
    v_exp_f32 v125, v125
    v_mfma_f32_32x32x16_bf16 v[140:155], v[64:67], v[116:119], v[140:155]
    v_exp_f32 v126, v126
    v_exp_f32 v127, v127
    v_mfma_f32_32x32x16_bf16 v[108:123], v[20:23], v[160:163], 0
    v_exp_f32 v128, v128
    v_exp_f32 v129, v129
    v_cvt_pk_bf16_f32 v124, v124, v125
    v_exp_f32 v130, v130
    v_exp_f32 v131, v131
    v_cvt_pk_bf16_f32 v125, v126, v127
    v_mfma_f32_32x32x8bf16_1k v[108:123], v[40:41], v[164:165], v[108:123]
    v_exp_f32 v132, v132
    v_cvt_pk_bf16_f32 v126, v128, v129
    v_cvt_pk_bf16_f32 v127, v130, v131
    v_exp_f32 v133, v133
    v_exp_f32 v134, v134
    v_exp_f32 v135, v135
    v_mfma_f32_32x32x16_bf16 v[140:155], v[68:71], v[124:127], v[140:155]
    v_exp_f32 v136, v136
    v_exp_f32 v137, v137
    v_cvt_pk_bf16_f32 v132, v132, v133
    v_exp_f32 v138, v138
    v_exp_f32 v139, v139
    v_cvt_pk_bf16_f32 v133, v134, v135
    v_cvt_pk_bf16_f32 v134, v136, v137
    v_cvt_pk_bf16_f32 v135, v138, v139
    v_exp_f32 v108, v108
    v_exp_f32 v109, v109
    v_mfma_f32_32x32x16_bf16 v[140:155], v[72:75], v[132:135], v[140:155]
    v_exp_f32 v110, v110
    v_exp_f32 v111, v111
    v_mfma_f32_32x32x16_bf16 v[124:139], v[24:27], v[160:163], 0
    v_exp_f32 v112, v112
    v_exp_f32 v113, v113
    v_cvt_pk_bf16_f32 v108, v108, v109
    v_exp_f32 v114, v114
    v_exp_f32 v115, v115
    v_cvt_pk_bf16_f32 v109, v110, v111
    v_mfma_f32_32x32x8bf16_1k v[124:139], v[40:41], v[166:167], v[124:139]
    v_exp_f32 v116, v116
    v_cvt_pk_bf16_f32 v110, v112, v113
    v_cvt_pk_bf16_f32 v111, v114, v115
    v_exp_f32 v117, v117
    v_exp_f32 v118, v118
    v_exp_f32 v119, v119
    v_mfma_f32_32x32x16_bf16 v[140:155], v[76:79], v[108:111], v[140:155]
    v_exp_f32 v120, v120
    v_exp_f32 v121, v121
    v_cvt_pk_bf16_f32 v116, v116, v117
    v_exp_f32 v122, v122
    v_exp_f32 v123, v123
    v_cvt_pk_bf16_f32 v117, v118, v119
    v_cvt_pk_bf16_f32 v118, v120, v121
    v_cvt_pk_bf16_f32 v119, v122, v123
    v_exp_f32 v124, v124
    v_exp_f32 v125, v125
    v_mfma_f32_32x32x16_bf16 v[140:155], v[80:83], v[116:119], v[140:155]
    v_exp_f32 v126, v126
    v_exp_f32 v127, v127
    v_mfma_f32_32x32x16_bf16 v[108:123], v[28:31], v[160:163], 0
    v_exp_f32 v128, v128
    v_exp_f32 v129, v129
    v_cvt_pk_bf16_f32 v124, v124, v125
    v_exp_f32 v130, v130
    v_exp_f32 v131, v131
    v_cvt_pk_bf16_f32 v125, v126, v127
    v_mfma_f32_32x32x8bf16_1k v[108:123], v[42:43], v[164:165], v[108:123]
    v_exp_f32 v132, v132
    v_cvt_pk_bf16_f32 v126, v128, v129
    s_add_u32 s24, s18, 2
    s_and_b32 s24, s24, 3
    s_mul_i32 s24, s24, 2560
    s_add_u32 s24, s24, 151808
    v_add_u32 v156, s24, v1
    ds_read_b128 v[156:159], v156
    s_mov_b32 exec_hi, 0
    v_add_u32 v164, s24, v2
    ds_read_b64 v[164:165], v164 offset:1024
    s_mov_b32 exec_hi, -1
    v_cvt_pk_bf16_f32 v127, v130, v131
    v_exp_f32 v133, v133
    v_exp_f32 v134, v134
    v_exp_f32 v135, v135
    v_mfma_f32_32x32x16_bf16 v[140:155], v[84:87], v[124:127], v[140:155]
    v_exp_f32 v136, v136
    v_exp_f32 v137, v137
    v_cvt_pk_bf16_f32 v132, v132, v133
    v_exp_f32 v138, v138
    v_exp_f32 v139, v139
    v_cvt_pk_bf16_f32 v133, v134, v135
    v_cvt_pk_bf16_f32 v134, v136, v137
    v_cvt_pk_bf16_f32 v135, v138, v139
    v_exp_f32 v108, v108
    v_exp_f32 v109, v109
    v_mfma_f32_32x32x16_bf16 v[140:155], v[88:91], v[132:135], v[140:155]
    v_exp_f32 v110, v110
    v_exp_f32 v111, v111
    v_mfma_f32_32x32x16_bf16 v[124:139], v[32:35], v[160:163], 0
    v_exp_f32 v112, v112
    v_exp_f32 v113, v113
    v_cvt_pk_bf16_f32 v108, v108, v109
    v_exp_f32 v114, v114
    v_exp_f32 v115, v115
    v_cvt_pk_bf16_f32 v109, v110, v111
    v_mfma_f32_32x32x8bf16_1k v[124:139], v[42:43], v[166:167], v[124:139]
    v_exp_f32 v116, v116
    v_cvt_pk_bf16_f32 v110, v112, v113
    s_mov_b32 exec_lo, 0
    v_add_u32 v166, s24, v2
    ds_read_b64 v[166:167], v166 offset:768
    s_mov_b32 exec_lo, -1
    v_cvt_pk_bf16_f32 v111, v114, v115
    v_exp_f32 v117, v117
    v_exp_f32 v118, v118
    v_exp_f32 v119, v119
    v_mfma_f32_32x32x16_bf16 v[140:155], v[92:95], v[108:111], v[140:155]
    v_exp_f32 v120, v120
    v_exp_f32 v121, v121
    v_cvt_pk_bf16_f32 v116, v116, v117
    v_exp_f32 v122, v122
    v_exp_f32 v123, v123
    v_cvt_pk_bf16_f32 v117, v118, v119
    v_cvt_pk_bf16_f32 v118, v120, v121
    v_cvt_pk_bf16_f32 v119, v122, v123
    v_exp_f32 v124, v124
    v_exp_f32 v125, v125
    v_mfma_f32_32x32x16_bf16 v[140:155], v[96:99], v[116:119], v[140:155]
    v_exp_f32 v126, v126
    v_exp_f32 v127, v127
    s_waitcnt lgkmcnt(0)
    v_mfma_f32_32x32x16_bf16 v[108:123], v[4:7], v[156:159], 0
    v_exp_f32 v128, v128
    v_exp_f32 v129, v129
    v_cvt_pk_bf16_f32 v124, v124, v125
    v_exp_f32 v130, v130
    v_exp_f32 v131, v131
    v_cvt_pk_bf16_f32 v125, v126, v127
    v_mfma_f32_32x32x8bf16_1k v[108:123], v[36:37], v[164:165], v[108:123]
    v_exp_f32 v132, v132
    v_cvt_pk_bf16_f32 v126, v128, v129
    s_add_u32 s47, s18, 2
    s_and_b32 s47, s47, 3
    s_and_b32 s48, s18, 4
    s_or_b32 s47, s47, s48
    s_mul_i32 s48, s47, 3072
    s_add_u32 s48, s48, 0
    s_lshl_b32 s47, s47, 2
    s_add_u32 s47, s47, 151552
    v_add_u32 v3, s48, v2
    v_mov_b32 v0, s47
    ds_read_b32 v0, v0
    v_cvt_pk_bf16_f32 v127, v130, v131
    v_exp_f32 v133, v133
    v_exp_f32 v134, v134
    v_exp_f32 v135, v135
    v_mfma_f32_32x32x16_bf16 v[140:155], v[100:103], v[124:127], v[140:155]
    v_exp_f32 v136, v136
    v_exp_f32 v137, v137
    v_cvt_pk_bf16_f32 v132, v132, v133
    v_exp_f32 v138, v138
    v_exp_f32 v139, v139
    v_cvt_pk_bf16_f32 v133, v134, v135
    v_cvt_pk_bf16_f32 v134, v136, v137
    v_cvt_pk_bf16_f32 v135, v138, v139
    s_cmp_lt_u32 s18, 4
    s_cbranch_scc1 AT_bal2_0
    s_setprio 0
AT_bal2_0:
    v_exp_f32 v108, v108
    v_exp_f32 v109, v109
    v_mfma_f32_32x32x16_bf16 v[140:155], v[104:107], v[132:135], v[140:155]
    v_exp_f32 v110, v110
    v_exp_f32 v111, v111
    v_mfma_f32_32x32x16_bf16 v[124:139], v[8:11], v[156:159], 0
    v_exp_f32 v112, v112
    v_exp_f32 v113, v113
    v_cvt_pk_bf16_f32 v108, v108, v109
    v_exp_f32 v114, v114
    v_exp_f32 v115, v115
    v_cvt_pk_bf16_f32 v109, v110, v111
    v_mfma_f32_32x32x8bf16_1k v[124:139], v[36:37], v[166:167], v[124:139]
    v_exp_f32 v116, v116
    v_cvt_pk_bf16_f32 v110, v112, v113
    s_waitcnt lgkmcnt(0)
    v_readfirstlane_b32 s49, v0
    s_cmp_ge_u32 s49, 1
    s_cbranch_scc0 AT_slow2
AT_back2:
    ds_wrxchg2st64_rtn_b64 v[140:143], v3, v[140:141], v[142:143] offset0:0 offset1:1
    ds_wrxchg2st64_rtn_b64 v[144:147], v3, v[144:145], v[146:147] offset0:2 offset1:3
    ds_wrxchg2st64_rtn_b64 v[148:151], v3, v[148:149], v[150:151] offset0:4 offset1:5
    v_mov_b32 v0, s47
    v_mov_b32 v3, 2
    ds_write_b32 v0, v3
    v_cvt_pk_bf16_f32 v111, v114, v115
    v_exp_f32 v117, v117
    v_exp_f32 v118, v118
    v_exp_f32 v119, v119
    v_exp_f32 v120, v120
    v_exp_f32 v121, v121
    v_cvt_pk_bf16_f32 v116, v116, v117
    v_exp_f32 v122, v122
    v_exp_f32 v123, v123
    v_cvt_pk_bf16_f32 v117, v118, v119
    v_cvt_pk_bf16_f32 v118, v120, v121
    v_cvt_pk_bf16_f32 v119, v122, v123
    s_waitcnt lgkmcnt(1)
    v_mfma_f32_32x32x16_bf16 v[140:155], v[44:47], v[108:111], v[140:155]
    v_exp_f32 v124, v124
    v_exp_f32 v125, v125
    v_mfma_f32_32x32x16_bf16 v[140:155], v[48:51], v[116:119], v[140:155]
    v_exp_f32 v126, v126
    v_exp_f32 v127, v127
    v_mfma_f32_32x32x16_bf16 v[108:123], v[12:15], v[156:159], 0
    v_exp_f32 v128, v128
    v_exp_f32 v129, v129
    v_cvt_pk_bf16_f32 v124, v124, v125
    v_exp_f32 v130, v130
    v_exp_f32 v131, v131
    v_cvt_pk_bf16_f32 v125, v126, v127
    v_mfma_f32_32x32x8bf16_1k v[108:123], v[38:39], v[164:165], v[108:123]
    v_exp_f32 v132, v132
    v_cvt_pk_bf16_f32 v126, v128, v129
    v_cvt_pk_bf16_f32 v127, v130, v131
    v_exp_f32 v133, v133
    v_exp_f32 v134, v134
    v_exp_f32 v135, v135
    v_mfma_f32_32x32x16_bf16 v[140:155], v[52:55], v[124:127], v[140:155]
    v_exp_f32 v136, v136
    v_exp_f32 v137, v137
    v_cvt_pk_bf16_f32 v132, v132, v133
    v_exp_f32 v138, v138
    v_exp_f32 v139, v139
    v_cvt_pk_bf16_f32 v133, v134, v135
    v_cvt_pk_bf16_f32 v134, v136, v137
    v_cvt_pk_bf16_f32 v135, v138, v139
    s_cmp_lt_u32 s18, 4
    s_cbranch_scc1 AT_bal2_2
    s_setprio 1
AT_bal2_2:
    v_exp_f32 v108, v108
    v_exp_f32 v109, v109
    v_mfma_f32_32x32x16_bf16 v[140:155], v[56:59], v[132:135], v[140:155]
    v_exp_f32 v110, v110
    v_exp_f32 v111, v111
    v_mfma_f32_32x32x16_bf16 v[124:139], v[16:19], v[156:159], 0
    v_exp_f32 v112, v112
    v_exp_f32 v113, v113
    v_cvt_pk_bf16_f32 v108, v108, v109
    v_exp_f32 v114, v114
    v_exp_f32 v115, v115
    v_cvt_pk_bf16_f32 v109, v110, v111
    v_mfma_f32_32x32x8bf16_1k v[124:139], v[38:39], v[166:167], v[124:139]
    v_exp_f32 v116, v116
    v_cvt_pk_bf16_f32 v110, v112, v113
    v_cvt_pk_bf16_f32 v111, v114, v115
    v_exp_f32 v117, v117
    v_exp_f32 v118, v118
    v_exp_f32 v119, v119
    v_mfma_f32_32x32x16_bf16 v[140:155], v[60:63], v[108:111], v[140:155]
    v_exp_f32 v120, v120
    v_exp_f32 v121, v121
    v_cvt_pk_bf16_f32 v116, v116, v117
    v_exp_f32 v122, v122
    v_exp_f32 v123, v123
    v_cvt_pk_bf16_f32 v117, v118, v119
    v_cvt_pk_bf16_f32 v118, v120, v121
    v_cvt_pk_bf16_f32 v119, v122, v123
    v_exp_f32 v124, v124
    v_exp_f32 v125, v125
    v_mfma_f32_32x32x16_bf16 v[140:155], v[64:67], v[116:119], v[140:155]
    v_exp_f32 v126, v126
    v_exp_f32 v127, v127
    v_mfma_f32_32x32x16_bf16 v[108:123], v[20:23], v[156:159], 0
    v_exp_f32 v128, v128
    v_exp_f32 v129, v129
    v_cvt_pk_bf16_f32 v124, v124, v125
    v_exp_f32 v130, v130
    v_exp_f32 v131, v131
    v_cvt_pk_bf16_f32 v125, v126, v127
    v_mfma_f32_32x32x8bf16_1k v[108:123], v[40:41], v[164:165], v[108:123]
    v_exp_f32 v132, v132
    v_cvt_pk_bf16_f32 v126, v128, v129
    v_cvt_pk_bf16_f32 v127, v130, v131
    v_exp_f32 v133, v133
    v_exp_f32 v134, v134
    v_exp_f32 v135, v135
    v_mfma_f32_32x32x16_bf16 v[140:155], v[68:71], v[124:127], v[140:155]
    v_exp_f32 v136, v136
    v_exp_f32 v137, v137
    v_cvt_pk_bf16_f32 v132, v132, v133
    v_exp_f32 v138, v138
    v_exp_f32 v139, v139
    v_cvt_pk_bf16_f32 v133, v134, v135
    v_cvt_pk_bf16_f32 v134, v136, v137
    v_cvt_pk_bf16_f32 v135, v138, v139
    v_exp_f32 v108, v108
    v_exp_f32 v109, v109
    v_mfma_f32_32x32x16_bf16 v[140:155], v[72:75], v[132:135], v[140:155]
    v_exp_f32 v110, v110
    v_exp_f32 v111, v111
    v_mfma_f32_32x32x16_bf16 v[124:139], v[24:27], v[156:159], 0
    v_exp_f32 v112, v112
    v_exp_f32 v113, v113
    v_cvt_pk_bf16_f32 v108, v108, v109
    v_exp_f32 v114, v114
    v_exp_f32 v115, v115
    v_cvt_pk_bf16_f32 v109, v110, v111
    v_mfma_f32_32x32x8bf16_1k v[124:139], v[40:41], v[166:167], v[124:139]
    v_exp_f32 v116, v116
    v_cvt_pk_bf16_f32 v110, v112, v113
    v_cvt_pk_bf16_f32 v111, v114, v115
    v_exp_f32 v117, v117
    v_exp_f32 v118, v118
    v_exp_f32 v119, v119
    v_mfma_f32_32x32x16_bf16 v[140:155], v[76:79], v[108:111], v[140:155]
    v_exp_f32 v120, v120
    v_exp_f32 v121, v121
    v_cvt_pk_bf16_f32 v116, v116, v117
    v_exp_f32 v122, v122
    v_exp_f32 v123, v123
    v_cvt_pk_bf16_f32 v117, v118, v119
    v_cvt_pk_bf16_f32 v118, v120, v121
    v_cvt_pk_bf16_f32 v119, v122, v123
    v_exp_f32 v124, v124
    v_exp_f32 v125, v125
    v_mfma_f32_32x32x16_bf16 v[140:155], v[80:83], v[116:119], v[140:155]
    v_exp_f32 v126, v126
    v_exp_f32 v127, v127
    v_mfma_f32_32x32x16_bf16 v[108:123], v[28:31], v[156:159], 0
    v_exp_f32 v128, v128
    v_exp_f32 v129, v129
    v_cvt_pk_bf16_f32 v124, v124, v125
    v_exp_f32 v130, v130
    v_exp_f32 v131, v131
    v_cvt_pk_bf16_f32 v125, v126, v127
    v_mfma_f32_32x32x8bf16_1k v[108:123], v[42:43], v[164:165], v[108:123]
    v_exp_f32 v132, v132
    v_cvt_pk_bf16_f32 v126, v128, v129
    s_add_u32 s24, s18, 3
    s_and_b32 s24, s24, 3
    s_mul_i32 s24, s24, 2560
    s_add_u32 s24, s24, 151808
    v_add_u32 v160, s24, v1
    ds_read_b128 v[160:163], v160
    s_mov_b32 exec_hi, 0
    v_add_u32 v164, s24, v2
    ds_read_b64 v[164:165], v164 offset:1024
    s_mov_b32 exec_hi, -1
    v_cvt_pk_bf16_f32 v127, v130, v131
    v_exp_f32 v133, v133
    v_exp_f32 v134, v134
    v_exp_f32 v135, v135
    v_mfma_f32_32x32x16_bf16 v[140:155], v[84:87], v[124:127], v[140:155]
    v_exp_f32 v136, v136
    v_exp_f32 v137, v137
    v_cvt_pk_bf16_f32 v132, v132, v133
    v_exp_f32 v138, v138
    v_exp_f32 v139, v139
    v_cvt_pk_bf16_f32 v133, v134, v135
    v_cvt_pk_bf16_f32 v134, v136, v137
    v_cvt_pk_bf16_f32 v135, v138, v139
    v_exp_f32 v108, v108
    v_exp_f32 v109, v109
    v_mfma_f32_32x32x16_bf16 v[140:155], v[88:91], v[132:135], v[140:155]
    v_exp_f32 v110, v110
    v_exp_f32 v111, v111
    v_mfma_f32_32x32x16_bf16 v[124:139], v[32:35], v[156:159], 0
    v_exp_f32 v112, v112
    v_exp_f32 v113, v113
    v_cvt_pk_bf16_f32 v108, v108, v109
    v_exp_f32 v114, v114
    v_exp_f32 v115, v115
    v_cvt_pk_bf16_f32 v109, v110, v111
    v_mfma_f32_32x32x8bf16_1k v[124:139], v[42:43], v[166:167], v[124:139]
    v_exp_f32 v116, v116
    v_cvt_pk_bf16_f32 v110, v112, v113
    s_mov_b32 exec_lo, 0
    v_add_u32 v166, s24, v2
    ds_read_b64 v[166:167], v166 offset:768
    s_mov_b32 exec_lo, -1
    v_cvt_pk_bf16_f32 v111, v114, v115
    v_exp_f32 v117, v117
    v_exp_f32 v118, v118
    v_exp_f32 v119, v119
    v_mfma_f32_32x32x16_bf16 v[140:155], v[92:95], v[108:111], v[140:155]
    v_exp_f32 v120, v120
    v_exp_f32 v121, v121
    v_cvt_pk_bf16_f32 v116, v116, v117
    v_exp_f32 v122, v122
    v_exp_f32 v123, v123
    v_cvt_pk_bf16_f32 v117, v118, v119
    v_cvt_pk_bf16_f32 v118, v120, v121
    v_cvt_pk_bf16_f32 v119, v122, v123
    v_exp_f32 v124, v124
    v_exp_f32 v125, v125
    v_mfma_f32_32x32x16_bf16 v[140:155], v[96:99], v[116:119], v[140:155]
    v_exp_f32 v126, v126
    v_exp_f32 v127, v127
    s_waitcnt lgkmcnt(0)
    v_mfma_f32_32x32x16_bf16 v[108:123], v[4:7], v[160:163], 0
    v_exp_f32 v128, v128
    v_exp_f32 v129, v129
    v_cvt_pk_bf16_f32 v124, v124, v125
    v_exp_f32 v130, v130
    v_exp_f32 v131, v131
    v_cvt_pk_bf16_f32 v125, v126, v127
    v_mfma_f32_32x32x8bf16_1k v[108:123], v[36:37], v[164:165], v[108:123]
    v_exp_f32 v132, v132
    v_cvt_pk_bf16_f32 v126, v128, v129
    s_add_u32 s47, s18, 4
    s_and_b32 s47, s47, 3
    s_and_b32 s48, s18, 4
    s_or_b32 s47, s47, s48
    s_mul_i32 s48, s47, 3072
    s_add_u32 s48, s48, 0
    s_lshl_b32 s47, s47, 2
    s_add_u32 s47, s47, 151552
    v_add_u32 v3, s48, v2
    v_mov_b32 v0, s47
    ds_read_b32 v0, v0
    v_cvt_pk_bf16_f32 v127, v130, v131
    v_exp_f32 v133, v133
    v_exp_f32 v134, v134
    v_exp_f32 v135, v135
    v_mfma_f32_32x32x16_bf16 v[140:155], v[100:103], v[124:127], v[140:155]
    v_exp_f32 v136, v136
    v_exp_f32 v137, v137
    v_cvt_pk_bf16_f32 v132, v132, v133
    v_exp_f32 v138, v138
    v_exp_f32 v139, v139
    v_cvt_pk_bf16_f32 v133, v134, v135
    v_cvt_pk_bf16_f32 v134, v136, v137
    v_cvt_pk_bf16_f32 v135, v138, v139
    s_cmp_lt_u32 s18, 4
    s_cbranch_scc1 AT_bal3_0
    s_setprio 0
AT_bal3_0:
    v_exp_f32 v108, v108
    v_exp_f32 v109, v109
    v_mfma_f32_32x32x16_bf16 v[140:155], v[104:107], v[132:135], v[140:155]
    v_exp_f32 v110, v110
    v_exp_f32 v111, v111
    v_mfma_f32_32x32x16_bf16 v[124:139], v[8:11], v[160:163], 0
    v_exp_f32 v112, v112
    v_exp_f32 v113, v113
    v_cvt_pk_bf16_f32 v108, v108, v109
    v_exp_f32 v114, v114
    v_exp_f32 v115, v115
    v_cvt_pk_bf16_f32 v109, v110, v111
    v_mfma_f32_32x32x8bf16_1k v[124:139], v[36:37], v[166:167], v[124:139]
    v_exp_f32 v116, v116
    v_cvt_pk_bf16_f32 v110, v112, v113
    s_waitcnt lgkmcnt(0)
    v_readfirstlane_b32 s49, v0
    s_cmp_ge_u32 s49, 2
    s_cbranch_scc0 AT_slow3
AT_back3:
    ds_wrxchg2st64_rtn_b64 v[140:143], v3, v[140:141], v[142:143] offset0:0 offset1:1
    ds_wrxchg2st64_rtn_b64 v[144:147], v3, v[144:145], v[146:147] offset0:2 offset1:3
    ds_wrxchg2st64_rtn_b64 v[148:151], v3, v[148:149], v[150:151] offset0:4 offset1:5
    v_mov_b32 v0, s47
    v_mov_b32 v3, 3
    ds_write_b32 v0, v3
    v_cvt_pk_bf16_f32 v111, v114, v115
    v_exp_f32 v117, v117
    v_exp_f32 v118, v118
    v_exp_f32 v119, v119
    v_exp_f32 v120, v120
    v_exp_f32 v121, v121
    v_cvt_pk_bf16_f32 v116, v116, v117
    v_exp_f32 v122, v122
    v_exp_f32 v123, v123
    v_cvt_pk_bf16_f32 v117, v118, v119
    v_cvt_pk_bf16_f32 v118, v120, v121
    v_cvt_pk_bf16_f32 v119, v122, v123
    s_waitcnt lgkmcnt(1)
    v_mfma_f32_32x32x16_bf16 v[140:155], v[44:47], v[108:111], v[140:155]
    v_exp_f32 v124, v124
    v_exp_f32 v125, v125
    v_mfma_f32_32x32x16_bf16 v[140:155], v[48:51], v[116:119], v[140:155]
    v_exp_f32 v126, v126
    v_exp_f32 v127, v127
    v_mfma_f32_32x32x16_bf16 v[108:123], v[12:15], v[160:163], 0
    v_exp_f32 v128, v128
    v_exp_f32 v129, v129
    v_cvt_pk_bf16_f32 v124, v124, v125
    v_exp_f32 v130, v130
    v_exp_f32 v131, v131
    v_cvt_pk_bf16_f32 v125, v126, v127
    v_mfma_f32_32x32x8bf16_1k v[108:123], v[38:39], v[164:165], v[108:123]
    v_exp_f32 v132, v132
    v_cvt_pk_bf16_f32 v126, v128, v129
    s_add_u32 s44, s18, 3
    s_bfe_u32 s45, s44, 0x10001
    s_lshl_b32 s50, s45, 7
    s_add_u32 s50, s50, 162048
    v_lshrrev_b32 v156, 1, v2
    v_and_b32 v156, 127, v156
    v_add_u32 v156, s50, v156
    ds_read_b32 v156, v156
    v_mov_b32 v158, 151584
    v_mov_b32 v159, 1
    v_cvt_pk_bf16_f32 v127, v130, v131
    v_exp_f32 v133, v133
    v_exp_f32 v134, v134
    v_exp_f32 v135, v135
    v_mfma_f32_32x32x16_bf16 v[140:155], v[52:55], v[124:127], v[140:155]
    v_exp_f32 v136, v136
    v_exp_f32 v137, v137
    v_cvt_pk_bf16_f32 v132, v132, v133
    v_exp_f32 v138, v138
    v_exp_f32 v139, v139
    v_cvt_pk_bf16_f32 v133, v134, v135
    v_cvt_pk_bf16_f32 v134, v136, v137
    v_cvt_pk_bf16_f32 v135, v138, v139
    s_cmp_lt_u32 s18, 4
    s_cbranch_scc1 AT_bal3_2
    s_setprio 1
AT_bal3_2:
    v_exp_f32 v108, v108
    v_exp_f32 v109, v109
    v_mfma_f32_32x32x16_bf16 v[140:155], v[56:59], v[132:135], v[140:155]
    v_exp_f32 v110, v110
    v_exp_f32 v111, v111
    v_mfma_f32_32x32x16_bf16 v[124:139], v[16:19], v[160:163], 0
    v_exp_f32 v112, v112
    v_exp_f32 v113, v113
    v_cvt_pk_bf16_f32 v108, v108, v109
    v_exp_f32 v114, v114
    v_exp_f32 v115, v115
    v_cvt_pk_bf16_f32 v109, v110, v111
    v_mfma_f32_32x32x8bf16_1k v[124:139], v[38:39], v[166:167], v[124:139]
    v_exp_f32 v116, v116
    v_cvt_pk_bf16_f32 v110, v112, v113
    v_cvt_pk_bf16_f32 v111, v114, v115
    v_exp_f32 v117, v117
    v_exp_f32 v118, v118
    v_exp_f32 v119, v119
    v_mfma_f32_32x32x16_bf16 v[140:155], v[60:63], v[108:111], v[140:155]
    v_exp_f32 v120, v120
    v_exp_f32 v121, v121
    v_cvt_pk_bf16_f32 v116, v116, v117
    v_exp_f32 v122, v122
    v_exp_f32 v123, v123
    v_cvt_pk_bf16_f32 v117, v118, v119
    v_cvt_pk_bf16_f32 v118, v120, v121
    v_cvt_pk_bf16_f32 v119, v122, v123
    v_exp_f32 v124, v124
    v_exp_f32 v125, v125
    v_mfma_f32_32x32x16_bf16 v[140:155], v[64:67], v[116:119], v[140:155]
    v_exp_f32 v126, v126
    v_exp_f32 v127, v127
    v_mfma_f32_32x32x16_bf16 v[108:123], v[20:23], v[160:163], 0
    v_exp_f32 v128, v128
    v_exp_f32 v129, v129
    v_cvt_pk_bf16_f32 v124, v124, v125
    v_exp_f32 v130, v130
    v_exp_f32 v131, v131
    v_cvt_pk_bf16_f32 v125, v126, v127
    v_mfma_f32_32x32x8bf16_1k v[108:123], v[40:41], v[164:165], v[108:123]
    v_exp_f32 v132, v132
    v_cvt_pk_bf16_f32 v126, v128, v129
    v_cvt_pk_bf16_f32 v127, v130, v131
    v_exp_f32 v133, v133
    v_exp_f32 v134, v134
    v_exp_f32 v135, v135
    v_mfma_f32_32x32x16_bf16 v[140:155], v[68:71], v[124:127], v[140:155]
    v_exp_f32 v136, v136
    v_exp_f32 v137, v137
    v_cvt_pk_bf16_f32 v132, v132, v133
    v_exp_f32 v138, v138
    v_exp_f32 v139, v139
    v_cvt_pk_bf16_f32 v133, v134, v135
    v_cvt_pk_bf16_f32 v134, v136, v137
    v_cvt_pk_bf16_f32 v135, v138, v139
    v_exp_f32 v108, v108
    v_exp_f32 v109, v109
    v_mfma_f32_32x32x16_bf16 v[140:155], v[72:75], v[132:135], v[140:155]
    v_exp_f32 v110, v110
    v_exp_f32 v111, v111
    v_mfma_f32_32x32x16_bf16 v[124:139], v[24:27], v[160:163], 0
    v_exp_f32 v112, v112
    v_exp_f32 v113, v113
    v_cvt_pk_bf16_f32 v108, v108, v109
    v_exp_f32 v114, v114
    v_exp_f32 v115, v115
    v_cvt_pk_bf16_f32 v109, v110, v111
    v_mfma_f32_32x32x8bf16_1k v[124:139], v[40:41], v[166:167], v[124:139]
    v_exp_f32 v116, v116
    v_cvt_pk_bf16_f32 v110, v112, v113
    v_cvt_pk_bf16_f32 v111, v114, v115
    v_exp_f32 v117, v117
    v_exp_f32 v118, v118
    v_exp_f32 v119, v119
    v_mfma_f32_32x32x16_bf16 v[140:155], v[76:79], v[108:111], v[140:155]
    v_exp_f32 v120, v120
    v_exp_f32 v121, v121
    v_cvt_pk_bf16_f32 v116, v116, v117
    v_exp_f32 v122, v122
    v_exp_f32 v123, v123
    v_cvt_pk_bf16_f32 v117, v118, v119
    v_cvt_pk_bf16_f32 v118, v120, v121
    v_cvt_pk_bf16_f32 v119, v122, v123
    v_exp_f32 v124, v124
    v_exp_f32 v125, v125
    v_mfma_f32_32x32x16_bf16 v[140:155], v[80:83], v[116:119], v[140:155]
    v_exp_f32 v126, v126
    v_exp_f32 v127, v127
    v_mfma_f32_32x32x16_bf16 v[108:123], v[28:31], v[160:163], 0
    v_exp_f32 v128, v128
    v_exp_f32 v129, v129
    v_cvt_pk_bf16_f32 v124, v124, v125
    v_exp_f32 v130, v130
    v_exp_f32 v131, v131
    v_cvt_pk_bf16_f32 v125, v126, v127
    v_mfma_f32_32x32x8bf16_1k v[108:123], v[42:43], v[164:165], v[108:123]
    v_exp_f32 v132, v132
    v_cvt_pk_bf16_f32 v126, v128, v129
    v_cvt_pk_bf16_f32 v127, v130, v131
    v_exp_f32 v133, v133
    v_exp_f32 v134, v134
    v_exp_f32 v135, v135
    v_mfma_f32_32x32x16_bf16 v[140:155], v[84:87], v[124:127], v[140:155]
    v_exp_f32 v136, v136
    v_exp_f32 v137, v137
    v_cvt_pk_bf16_f32 v132, v132, v133
    v_exp_f32 v138, v138
    v_exp_f32 v139, v139
    v_cvt_pk_bf16_f32 v133, v134, v135
    v_cvt_pk_bf16_f32 v134, v136, v137
    v_cvt_pk_bf16_f32 v135, v138, v139
    v_exp_f32 v108, v108
    v_exp_f32 v109, v109
    v_mfma_f32_32x32x16_bf16 v[140:155], v[88:91], v[132:135], v[140:155]
    v_exp_f32 v110, v110
    v_exp_f32 v111, v111
    v_mfma_f32_32x32x16_bf16 v[124:139], v[32:35], v[160:163], 0
    v_exp_f32 v112, v112
    v_exp_f32 v113, v113
    v_cvt_pk_bf16_f32 v108, v108, v109
    v_exp_f32 v114, v114
    v_exp_f32 v115, v115
    v_cvt_pk_bf16_f32 v109, v110, v111
    v_mfma_f32_32x32x8bf16_1k v[124:139], v[42:43], v[166:167], v[124:139]
    v_exp_f32 v116, v116
    v_cvt_pk_bf16_f32 v110, v112, v113
    v_cvt_pk_bf16_f32 v111, v114, v115
    v_exp_f32 v117, v117
    v_exp_f32 v118, v118
    v_exp_f32 v119, v119
    v_mfma_f32_32x32x16_bf16 v[140:155], v[92:95], v[108:111], v[140:155]
    v_exp_f32 v120, v120
    v_exp_f32 v121, v121
    v_cvt_pk_bf16_f32 v116, v116, v117
    v_exp_f32 v122, v122
    v_exp_f32 v123, v123
    v_cvt_pk_bf16_f32 v117, v118, v119
    v_cvt_pk_bf16_f32 v118, v120, v121
    v_cvt_pk_bf16_f32 v119, v122, v123
    v_exp_f32 v124, v124
    v_exp_f32 v125, v125
    v_mfma_f32_32x32x16_bf16 v[140:155], v[96:99], v[116:119], v[140:155]
    v_exp_f32 v126, v126
    v_exp_f32 v127, v127
    v_exp_f32 v128, v128
    v_exp_f32 v129, v129
    v_cvt_pk_bf16_f32 v124, v124, v125
    v_exp_f32 v130, v130
    v_exp_f32 v131, v131
    v_cvt_pk_bf16_f32 v125, v126, v127
    v_exp_f32 v132, v132
    v_cvt_pk_bf16_f32 v126, v128, v129
    s_add_u32 s47, s18, 1
    s_and_b32 s47, s47, 3
    s_mul_i32 s48, s47, 3072
    s_add_u32 s48, s48, 0
    s_lshl_b32 s47, s47, 2
    s_add_u32 s47, s47, 151552
    v_add_u32 v3, s48, v2
    v_mov_b32 v0, s47
    s_mov_b64 exec, 1
    ds_add_rtn_u32 v157, v0, v159 offset:96
    s_mov_b64 exec, -1
    ds_read2_b32 v[120:121], v0 offset0:0 offset1:4
    v_cvt_pk_bf16_f32 v127, v130, v131
    v_exp_f32 v133, v133
    v_exp_f32 v134, v134
    v_exp_f32 v135, v135
    v_mfma_f32_32x32x16_bf16 v[140:155], v[100:103], v[124:127], v[140:155]
    v_exp_f32 v136, v136
    v_exp_f32 v137, v137
    v_cvt_pk_bf16_f32 v132, v132, v133
    v_exp_f32 v138, v138
    v_exp_f32 v139, v139
    v_cvt_pk_bf16_f32 v133, v134, v135
    v_cvt_pk_bf16_f32 v134, v136, v137
    v_cvt_pk_bf16_f32 v135, v138, v139
    s_nop 1
    v_mfma_f32_32x32x16_bf16 v[140:155], v[104:107], v[132:135], v[140:155]
    s_branch AT_epi
AT_h1:
    s_add_u32 s24, s18, 0
    s_and_b32 s24, s24, 3
    s_mul_i32 s24, s24, 2560
    s_add_u32 s24, s24, 153088
    v_add_u32 v156, s24, v1
    ds_read_b128 v[156:159], v156
    s_mov_b32 exec_hi, 0
    v_add_u32 v164, s24, v2
    ds_read_b64 v[164:165], v164 offset:1024
    s_mov_b32 exec_hi, -1
    s_mov_b32 exec_lo, 0
    v_add_u32 v166, s24, v2
    ds_read_b64 v[166:167], v166 offset:768
    s_mov_b32 exec_lo, -1
    s_mov_b32 s28, 8
    s_add_u32 s26, s26, 1024
    s_add_u32 s27, s27, 256
    s_waitcnt lgkmcnt(0)
    v_mfma_f32_32x32x16_bf16 v[108:123], v[4:7], v[156:159], 0
    v_mfma_f32_32x32x8bf16_1k v[108:123], v[36:37], v[164:165], v[108:123]
    s_cmp_lt_u32 s18, 4
    s_nop 0
    s_cbranch_scc1 AT_bal4_0
    s_setprio 0
AT_bal4_0:
    s_nop 8
    v_exp_f32 v108, v108
    v_exp_f32 v109, v109
    v_exp_f32 v110, v110
    v_exp_f32 v111, v111
    v_mfma_f32_32x32x16_bf16 v[124:139], v[8:11], v[156:159], 0
    v_exp_f32 v112, v112
    v_exp_f32 v113, v113
    v_cvt_pk_bf16_f32 v108, v108, v109
    v_exp_f32 v114, v114
    v_exp_f32 v115, v115
    v_cvt_pk_bf16_f32 v109, v110, v111
    v_mfma_f32_32x32x8bf16_1k v[124:139], v[36:37], v[166:167], v[124:139]
    v_exp_f32 v116, v116
    v_cvt_pk_bf16_f32 v110, v112, v113
    v_cvt_pk_bf16_f32 v111, v114, v115
    v_exp_f32 v117, v117
    v_exp_f32 v118, v118
    v_exp_f32 v119, v119
    v_mfma_f32_32x32x16_bf16 v[140:155], v[44:47], v[108:111], 0
    v_exp_f32 v120, v120
    v_exp_f32 v121, v121
    v_cvt_pk_bf16_f32 v116, v116, v117
    v_exp_f32 v122, v122
    v_exp_f32 v123, v123
    v_cvt_pk_bf16_f32 v117, v118, v119
    v_cvt_pk_bf16_f32 v118, v120, v121
    v_cvt_pk_bf16_f32 v119, v122, v123
    v_exp_f32 v124, v124
    v_exp_f32 v125, v125
    v_mfma_f32_32x32x16_bf16 v[140:155], v[48:51], v[116:119], v[140:155]
    v_exp_f32 v126, v126
    v_exp_f32 v127, v127
    v_mfma_f32_32x32x16_bf16 v[108:123], v[12:15], v[156:159], 0
    v_exp_f32 v128, v128
    v_exp_f32 v129, v129
    v_cvt_pk_bf16_f32 v124, v124, v125
    v_exp_f32 v130, v130
    v_exp_f32 v131, v131
    v_cvt_pk_bf16_f32 v125, v126, v127
    v_mfma_f32_32x32x8bf16_1k v[108:123], v[38:39], v[164:165], v[108:123]
    v_exp_f32 v132, v132
    v_cvt_pk_bf16_f32 v126, v128, v129
    v_cvt_pk_bf16_f32 v127, v130, v131
    v_exp_f32 v133, v133
    v_exp_f32 v134, v134
    v_exp_f32 v135, v135
    v_mfma_f32_32x32x16_bf16 v[140:155], v[52:55], v[124:127], v[140:155]
    v_exp_f32 v136, v136
    v_exp_f32 v137, v137
    v_cvt_pk_bf16_f32 v132, v132, v133
    v_exp_f32 v138, v138
    v_exp_f32 v139, v139
    v_cvt_pk_bf16_f32 v133, v134, v135
    v_cvt_pk_bf16_f32 v134, v136, v137
    v_cvt_pk_bf16_f32 v135, v138, v139
    s_cmp_lt_u32 s18, 4
    s_cbranch_scc1 AT_bal4_2
    s_setprio 1
AT_bal4_2:
    v_exp_f32 v108, v108
    v_exp_f32 v109, v109
    v_mfma_f32_32x32x16_bf16 v[140:155], v[56:59], v[132:135], v[140:155]
    v_exp_f32 v110, v110
    v_exp_f32 v111, v111
    v_mfma_f32_32x32x16_bf16 v[124:139], v[16:19], v[156:159], 0
    v_exp_f32 v112, v112
    v_exp_f32 v113, v113
    v_cvt_pk_bf16_f32 v108, v108, v109
    v_exp_f32 v114, v114
    v_exp_f32 v115, v115
    v_cvt_pk_bf16_f32 v109, v110, v111
    v_mfma_f32_32x32x8bf16_1k v[124:139], v[38:39], v[166:167], v[124:139]
    v_exp_f32 v116, v116
    v_cvt_pk_bf16_f32 v110, v112, v113
    v_cvt_pk_bf16_f32 v111, v114, v115
    v_exp_f32 v117, v117
    v_exp_f32 v118, v118
    v_exp_f32 v119, v119
    v_mfma_f32_32x32x16_bf16 v[140:155], v[60:63], v[108:111], v[140:155]
    v_exp_f32 v120, v120
    v_exp_f32 v121, v121
    v_cvt_pk_bf16_f32 v116, v116, v117
    v_exp_f32 v122, v122
    v_exp_f32 v123, v123
    v_cvt_pk_bf16_f32 v117, v118, v119
    v_cvt_pk_bf16_f32 v118, v120, v121
    v_cvt_pk_bf16_f32 v119, v122, v123
    v_exp_f32 v124, v124
    v_exp_f32 v125, v125
    v_mfma_f32_32x32x16_bf16 v[140:155], v[64:67], v[116:119], v[140:155]
    v_exp_f32 v126, v126
    v_exp_f32 v127, v127
    v_mfma_f32_32x32x16_bf16 v[108:123], v[20:23], v[156:159], 0
    v_exp_f32 v128, v128
    v_exp_f32 v129, v129
    v_cvt_pk_bf16_f32 v124, v124, v125
    v_exp_f32 v130, v130
    v_exp_f32 v131, v131
    v_cvt_pk_bf16_f32 v125, v126, v127
    v_mfma_f32_32x32x8bf16_1k v[108:123], v[40:41], v[164:165], v[108:123]
    v_exp_f32 v132, v132
    v_cvt_pk_bf16_f32 v126, v128, v129
    v_cvt_pk_bf16_f32 v127, v130, v131
    v_exp_f32 v133, v133
    v_exp_f32 v134, v134
    v_exp_f32 v135, v135
    v_mfma_f32_32x32x16_bf16 v[140:155], v[68:71], v[124:127], v[140:155]
    v_exp_f32 v136, v136
    v_exp_f32 v137, v137
    v_cvt_pk_bf16_f32 v132, v132, v133
    v_exp_f32 v138, v138
    v_exp_f32 v139, v139
    v_cvt_pk_bf16_f32 v133, v134, v135
    v_cvt_pk_bf16_f32 v134, v136, v137
    v_cvt_pk_bf16_f32 v135, v138, v139
    v_exp_f32 v108, v108
    v_exp_f32 v109, v109
    v_mfma_f32_32x32x16_bf16 v[140:155], v[72:75], v[132:135], v[140:155]
    v_exp_f32 v110, v110
    v_exp_f32 v111, v111
    v_mfma_f32_32x32x16_bf16 v[124:139], v[24:27], v[156:159], 0
    v_exp_f32 v112, v112
    v_exp_f32 v113, v113
    v_cvt_pk_bf16_f32 v108, v108, v109
    v_exp_f32 v114, v114
    v_exp_f32 v115, v115
    v_cvt_pk_bf16_f32 v109, v110, v111
    v_mfma_f32_32x32x8bf16_1k v[124:139], v[40:41], v[166:167], v[124:139]
    v_exp_f32 v116, v116
    v_cvt_pk_bf16_f32 v110, v112, v113
    v_cvt_pk_bf16_f32 v111, v114, v115
    v_exp_f32 v117, v117
    v_exp_f32 v118, v118
    v_exp_f32 v119, v119
    v_mfma_f32_32x32x16_bf16 v[140:155], v[76:79], v[108:111], v[140:155]
    v_exp_f32 v120, v120
    v_exp_f32 v121, v121
    v_cvt_pk_bf16_f32 v116, v116, v117
    v_exp_f32 v122, v122
    v_exp_f32 v123, v123
    v_cvt_pk_bf16_f32 v117, v118, v119
    v_cvt_pk_bf16_f32 v118, v120, v121
    v_cvt_pk_bf16_f32 v119, v122, v123
    v_exp_f32 v124, v124
    v_exp_f32 v125, v125
    v_mfma_f32_32x32x16_bf16 v[140:155], v[80:83], v[116:119], v[140:155]
    v_exp_f32 v126, v126
    v_exp_f32 v127, v127
    v_mfma_f32_32x32x16_bf16 v[108:123], v[28:31], v[156:159], 0
    v_exp_f32 v128, v128
    v_exp_f32 v129, v129
    v_cvt_pk_bf16_f32 v124, v124, v125
    v_exp_f32 v130, v130
    v_exp_f32 v131, v131
    v_cvt_pk_bf16_f32 v125, v126, v127
    v_mfma_f32_32x32x8bf16_1k v[108:123], v[42:43], v[164:165], v[108:123]
    v_exp_f32 v132, v132
    v_cvt_pk_bf16_f32 v126, v128, v129
    s_add_u32 s24, s18, 1
    s_and_b32 s24, s24, 3
    s_mul_i32 s24, s24, 2560
    s_add_u32 s24, s24, 153088
    v_add_u32 v160, s24, v1
    ds_read_b128 v[160:163], v160
    s_mov_b32 exec_hi, 0
    v_add_u32 v164, s24, v2
    ds_read_b64 v[164:165], v164 offset:1024
    s_mov_b32 exec_hi, -1
    v_cvt_pk_bf16_f32 v127, v130, v131
    v_exp_f32 v133, v133
    v_exp_f32 v134, v134
    v_exp_f32 v135, v135
    v_mfma_f32_32x32x16_bf16 v[140:155], v[84:87], v[124:127], v[140:155]
    v_exp_f32 v136, v136
    v_exp_f32 v137, v137
    v_cvt_pk_bf16_f32 v132, v132, v133
    v_exp_f32 v138, v138
    v_exp_f32 v139, v139
    v_cvt_pk_bf16_f32 v133, v134, v135
    v_cvt_pk_bf16_f32 v134, v136, v137
    v_cvt_pk_bf16_f32 v135, v138, v139
    v_exp_f32 v108, v108
    v_exp_f32 v109, v109
    v_mfma_f32_32x32x16_bf16 v[140:155], v[88:91], v[132:135], v[140:155]
    v_exp_f32 v110, v110
    v_exp_f32 v111, v111
    v_mfma_f32_32x32x16_bf16 v[124:139], v[32:35], v[156:159], 0
    v_exp_f32 v112, v112
    v_exp_f32 v113, v113
    v_cvt_pk_bf16_f32 v108, v108, v109
    v_exp_f32 v114, v114
    v_exp_f32 v115, v115
    v_cvt_pk_bf16_f32 v109, v110, v111
    v_mfma_f32_32x32x8bf16_1k v[124:139], v[42:43], v[166:167], v[124:139]
    v_exp_f32 v116, v116
    v_cvt_pk_bf16_f32 v110, v112, v113
    s_mov_b32 exec_lo, 0
    v_add_u32 v166, s24, v2
    ds_read_b64 v[166:167], v166 offset:768
    s_mov_b32 exec_lo, -1
    v_cvt_pk_bf16_f32 v111, v114, v115
    v_exp_f32 v117, v117
    v_exp_f32 v118, v118
    v_exp_f32 v119, v119
    v_mfma_f32_32x32x16_bf16 v[140:155], v[92:95], v[108:111], v[140:155]
    v_exp_f32 v120, v120
    v_exp_f32 v121, v121
    v_cvt_pk_bf16_f32 v116, v116, v117
    v_exp_f32 v122, v122
    v_exp_f32 v123, v123
    v_cvt_pk_bf16_f32 v117, v118, v119
    v_cvt_pk_bf16_f32 v118, v120, v121
    v_cvt_pk_bf16_f32 v119, v122, v123
    v_exp_f32 v124, v124
    v_exp_f32 v125, v125
    v_mfma_f32_32x32x16_bf16 v[140:155], v[96:99], v[116:119], v[140:155]
    v_exp_f32 v126, v126
    v_exp_f32 v127, v127
    s_waitcnt lgkmcnt(0)
    v_mfma_f32_32x32x16_bf16 v[108:123], v[4:7], v[160:163], 0
    v_exp_f32 v128, v128
    v_exp_f32 v129, v129
    v_cvt_pk_bf16_f32 v124, v124, v125
    v_exp_f32 v130, v130
    v_exp_f32 v131, v131
    v_cvt_pk_bf16_f32 v125, v126, v127
    v_mfma_f32_32x32x8bf16_1k v[108:123], v[36:37], v[164:165], v[108:123]
    v_exp_f32 v132, v132
    v_cvt_pk_bf16_f32 v126, v128, v129
    s_add_u32 s47, s18, 0
    s_and_b32 s47, s47, 3
    s_and_b32 s48, s18, 4
    s_or_b32 s47, s47, s48
    s_mul_i32 s48, s47, 3072
    s_add_u32 s48, s48, 0
    s_lshl_b32 s47, s47, 2
    s_add_u32 s47, s47, 151552
    v_add_u32 v3, s48, v2
    v_mov_b32 v0, s47
    ds_read_b32 v0, v0
    v_cvt_pk_bf16_f32 v127, v130, v131
    v_exp_f32 v133, v133
    v_exp_f32 v134, v134
    v_exp_f32 v135, v135
    v_mfma_f32_32x32x16_bf16 v[140:155], v[100:103], v[124:127], v[140:155]
    v_exp_f32 v136, v136
    v_exp_f32 v137, v137
    v_cvt_pk_bf16_f32 v132, v132, v133
    v_exp_f32 v138, v138
    v_exp_f32 v139, v139
    v_cvt_pk_bf16_f32 v133, v134, v135
    v_cvt_pk_bf16_f32 v134, v136, v137
    v_cvt_pk_bf16_f32 v135, v138, v139
    s_cmp_lt_u32 s18, 4
    s_cbranch_scc1 AT_bal5_0
    s_setprio 0
AT_bal5_0:
    v_exp_f32 v108, v108
    v_exp_f32 v109, v109
    v_mfma_f32_32x32x16_bf16 v[140:155], v[104:107], v[132:135], v[140:155]
    v_exp_f32 v110, v110
    v_exp_f32 v111, v111
    v_mfma_f32_32x32x16_bf16 v[124:139], v[8:11], v[160:163], 0
    v_exp_f32 v112, v112
    v_exp_f32 v113, v113
    v_cvt_pk_bf16_f32 v108, v108, v109
    v_exp_f32 v114, v114
    v_exp_f32 v115, v115
    v_cvt_pk_bf16_f32 v109, v110, v111
    v_mfma_f32_32x32x8bf16_1k v[124:139], v[36:37], v[166:167], v[124:139]
    v_exp_f32 v116, v116
    v_cvt_pk_bf16_f32 v110, v112, v113
    s_waitcnt lgkmcnt(0)
    v_readfirstlane_b32 s49, v0
    s_cmp_ge_u32 s49, 5
    s_cbranch_scc0 AT_slow9
AT_back9:
    ds_write2st64_b64 v3, v[140:141], v[142:143] offset0:0 offset1:1
    ds_write2st64_b64 v3, v[144:145], v[146:147] offset0:2 offset1:3
    ds_write2st64_b64 v3, v[148:149], v[150:151] offset0:4 offset1:5
    v_mov_b32 v0, s47
    v_mov_b32 v3, 9
    ds_write_b32 v0, v3
    v_cvt_pk_bf16_f32 v111, v114, v115
    v_exp_f32 v117, v117
    v_exp_f32 v118, v118
    v_exp_f32 v119, v119
    v_mfma_f32_32x32x16_bf16 v[140:155], v[44:47], v[108:111], 0
    v_exp_f32 v120, v120
    v_exp_f32 v121, v121
    v_cvt_pk_bf16_f32 v116, v116, v117
    v_exp_f32 v122, v122
    v_exp_f32 v123, v123
    v_cvt_pk_bf16_f32 v117, v118, v119
    v_cvt_pk_bf16_f32 v118, v120, v121
    v_cvt_pk_bf16_f32 v119, v122, v123
    v_exp_f32 v124, v124
    v_exp_f32 v125, v125
    v_mfma_f32_32x32x16_bf16 v[140:155], v[48:51], v[116:119], v[140:155]
    v_exp_f32 v126, v126
    v_exp_f32 v127, v127
    v_mfma_f32_32x32x16_bf16 v[108:123], v[12:15], v[160:163], 0
    v_exp_f32 v128, v128
    v_exp_f32 v129, v129
    v_cvt_pk_bf16_f32 v124, v124, v125
    v_exp_f32 v130, v130
    v_exp_f32 v131, v131
    v_cvt_pk_bf16_f32 v125, v126, v127
    v_mfma_f32_32x32x8bf16_1k v[108:123], v[38:39], v[164:165], v[108:123]
    v_exp_f32 v132, v132
    v_cvt_pk_bf16_f32 v126, v128, v129
    v_cvt_pk_bf16_f32 v127, v130, v131
    v_exp_f32 v133, v133
    v_exp_f32 v134, v134
    v_exp_f32 v135, v135
    v_mfma_f32_32x32x16_bf16 v[140:155], v[52:55], v[124:127], v[140:155]
    v_exp_f32 v136, v136
    v_exp_f32 v137, v137
    v_cvt_pk_bf16_f32 v132, v132, v133
    v_exp_f32 v138, v138
    v_exp_f32 v139, v139
    v_cvt_pk_bf16_f32 v133, v134, v135
    v_cvt_pk_bf16_f32 v134, v136, v137
    v_cvt_pk_bf16_f32 v135, v138, v139
    s_cmp_lt_u32 s18, 4
    s_cbranch_scc1 AT_bal5_2
    s_setprio 1
AT_bal5_2:
    v_exp_f32 v108, v108
    v_exp_f32 v109, v109
    v_mfma_f32_32x32x16_bf16 v[140:155], v[56:59], v[132:135], v[140:155]
    v_exp_f32 v110, v110
    v_exp_f32 v111, v111
    v_mfma_f32_32x32x16_bf16 v[124:139], v[16:19], v[160:163], 0
    v_exp_f32 v112, v112
    v_exp_f32 v113, v113
    v_cvt_pk_bf16_f32 v108, v108, v109
    v_exp_f32 v114, v114
    v_exp_f32 v115, v115
    v_cvt_pk_bf16_f32 v109, v110, v111
    v_mfma_f32_32x32x8bf16_1k v[124:139], v[38:39], v[166:167], v[124:139]
    v_exp_f32 v116, v116
    v_cvt_pk_bf16_f32 v110, v112, v113
    v_cvt_pk_bf16_f32 v111, v114, v115
    v_exp_f32 v117, v117
    v_exp_f32 v118, v118
    v_exp_f32 v119, v119
    v_mfma_f32_32x32x16_bf16 v[140:155], v[60:63], v[108:111], v[140:155]
    v_exp_f32 v120, v120
    v_exp_f32 v121, v121
    v_cvt_pk_bf16_f32 v116, v116, v117
    v_exp_f32 v122, v122
    v_exp_f32 v123, v123
    v_cvt_pk_bf16_f32 v117, v118, v119
    v_cvt_pk_bf16_f32 v118, v120, v121
    v_cvt_pk_bf16_f32 v119, v122, v123
    v_exp_f32 v124, v124
    v_exp_f32 v125, v125
    v_mfma_f32_32x32x16_bf16 v[140:155], v[64:67], v[116:119], v[140:155]
    v_exp_f32 v126, v126
    v_exp_f32 v127, v127
    v_mfma_f32_32x32x16_bf16 v[108:123], v[20:23], v[160:163], 0
    v_exp_f32 v128, v128
    v_exp_f32 v129, v129
    v_cvt_pk_bf16_f32 v124, v124, v125
    v_exp_f32 v130, v130
    v_exp_f32 v131, v131
    v_cvt_pk_bf16_f32 v125, v126, v127
    v_mfma_f32_32x32x8bf16_1k v[108:123], v[40:41], v[164:165], v[108:123]
    v_exp_f32 v132, v132
    v_cvt_pk_bf16_f32 v126, v128, v129
    v_cvt_pk_bf16_f32 v127, v130, v131
    v_exp_f32 v133, v133
    v_exp_f32 v134, v134
    v_exp_f32 v135, v135
    v_mfma_f32_32x32x16_bf16 v[140:155], v[68:71], v[124:127], v[140:155]
    v_exp_f32 v136, v136
    v_exp_f32 v137, v137
    v_cvt_pk_bf16_f32 v132, v132, v133
    v_exp_f32 v138, v138
    v_exp_f32 v139, v139
    v_cvt_pk_bf16_f32 v133, v134, v135
    v_cvt_pk_bf16_f32 v134, v136, v137
    v_cvt_pk_bf16_f32 v135, v138, v139
    v_exp_f32 v108, v108
    v_exp_f32 v109, v109
    v_mfma_f32_32x32x16_bf16 v[140:155], v[72:75], v[132:135], v[140:155]
    v_exp_f32 v110, v110
    v_exp_f32 v111, v111
    v_mfma_f32_32x32x16_bf16 v[124:139], v[24:27], v[160:163], 0
    v_exp_f32 v112, v112
    v_exp_f32 v113, v113
    v_cvt_pk_bf16_f32 v108, v108, v109
    v_exp_f32 v114, v114
    v_exp_f32 v115, v115
    v_cvt_pk_bf16_f32 v109, v110, v111
    v_mfma_f32_32x32x8bf16_1k v[124:139], v[40:41], v[166:167], v[124:139]
    v_exp_f32 v116, v116
    v_cvt_pk_bf16_f32 v110, v112, v113
    v_cvt_pk_bf16_f32 v111, v114, v115
    v_exp_f32 v117, v117
    v_exp_f32 v118, v118
    v_exp_f32 v119, v119
    v_mfma_f32_32x32x16_bf16 v[140:155], v[76:79], v[108:111], v[140:155]
    v_exp_f32 v120, v120
    v_exp_f32 v121, v121
    v_cvt_pk_bf16_f32 v116, v116, v117
    v_exp_f32 v122, v122
    v_exp_f32 v123, v123
    v_cvt_pk_bf16_f32 v117, v118, v119
    v_cvt_pk_bf16_f32 v118, v120, v121
    v_cvt_pk_bf16_f32 v119, v122, v123
    v_exp_f32 v124, v124
    v_exp_f32 v125, v125
    v_mfma_f32_32x32x16_bf16 v[140:155], v[80:83], v[116:119], v[140:155]
    v_exp_f32 v126, v126
    v_exp_f32 v127, v127
    v_mfma_f32_32x32x16_bf16 v[108:123], v[28:31], v[160:163], 0
    v_exp_f32 v128, v128
    v_exp_f32 v129, v129
    v_cvt_pk_bf16_f32 v124, v124, v125
    v_exp_f32 v130, v130
    v_exp_f32 v131, v131
    v_cvt_pk_bf16_f32 v125, v126, v127
    v_mfma_f32_32x32x8bf16_1k v[108:123], v[42:43], v[164:165], v[108:123]
    v_exp_f32 v132, v132
    v_cvt_pk_bf16_f32 v126, v128, v129
    s_add_u32 s24, s18, 2
    s_and_b32 s24, s24, 3
    s_mul_i32 s24, s24, 2560
    s_add_u32 s24, s24, 153088
    v_add_u32 v156, s24, v1
    ds_read_b128 v[156:159], v156
    s_mov_b32 exec_hi, 0
    v_add_u32 v164, s24, v2
    ds_read_b64 v[164:165], v164 offset:1024
    s_mov_b32 exec_hi, -1
    v_cvt_pk_bf16_f32 v127, v130, v131
    v_exp_f32 v133, v133
    v_exp_f32 v134, v134
    v_exp_f32 v135, v135
    v_mfma_f32_32x32x16_bf16 v[140:155], v[84:87], v[124:127], v[140:155]
    v_exp_f32 v136, v136
    v_exp_f32 v137, v137
    v_cvt_pk_bf16_f32 v132, v132, v133
    v_exp_f32 v138, v138
    v_exp_f32 v139, v139
    v_cvt_pk_bf16_f32 v133, v134, v135
    v_cvt_pk_bf16_f32 v134, v136, v137
    v_cvt_pk_bf16_f32 v135, v138, v139
    v_exp_f32 v108, v108
    v_exp_f32 v109, v109
    v_mfma_f32_32x32x16_bf16 v[140:155], v[88:91], v[132:135], v[140:155]
    v_exp_f32 v110, v110
    v_exp_f32 v111, v111
    v_mfma_f32_32x32x16_bf16 v[124:139], v[32:35], v[160:163], 0
    v_exp_f32 v112, v112
    v_exp_f32 v113, v113
    v_cvt_pk_bf16_f32 v108, v108, v109
    v_exp_f32 v114, v114
    v_exp_f32 v115, v115
    v_cvt_pk_bf16_f32 v109, v110, v111
    v_mfma_f32_32x32x8bf16_1k v[124:139], v[42:43], v[166:167], v[124:139]
    v_exp_f32 v116, v116
    v_cvt_pk_bf16_f32 v110, v112, v113
    s_mov_b32 exec_lo, 0
    v_add_u32 v166, s24, v2
    ds_read_b64 v[166:167], v166 offset:768
    s_mov_b32 exec_lo, -1
    v_cvt_pk_bf16_f32 v111, v114, v115
    v_exp_f32 v117, v117
    v_exp_f32 v118, v118
    v_exp_f32 v119, v119
    v_mfma_f32_32x32x16_bf16 v[140:155], v[92:95], v[108:111], v[140:155]
    v_exp_f32 v120, v120
    v_exp_f32 v121, v121
    v_cvt_pk_bf16_f32 v116, v116, v117
    v_exp_f32 v122, v122
    v_exp_f32 v123, v123
    v_cvt_pk_bf16_f32 v117, v118, v119
    v_cvt_pk_bf16_f32 v118, v120, v121
    v_cvt_pk_bf16_f32 v119, v122, v123
    v_exp_f32 v124, v124
    v_exp_f32 v125, v125
    v_mfma_f32_32x32x16_bf16 v[140:155], v[96:99], v[116:119], v[140:155]
    v_exp_f32 v126, v126
    v_exp_f32 v127, v127
    s_waitcnt lgkmcnt(0)
    v_mfma_f32_32x32x16_bf16 v[108:123], v[4:7], v[156:159], 0
    v_exp_f32 v128, v128
    v_exp_f32 v129, v129
    v_cvt_pk_bf16_f32 v124, v124, v125
    v_exp_f32 v130, v130
    v_exp_f32 v131, v131
    v_cvt_pk_bf16_f32 v125, v126, v127
    v_mfma_f32_32x32x8bf16_1k v[108:123], v[36:37], v[164:165], v[108:123]
    v_exp_f32 v132, v132
    v_cvt_pk_bf16_f32 v126, v128, v129
    s_add_u32 s47, s18, 2
    s_and_b32 s47, s47, 3
    s_and_b32 s48, s18, 4
    s_or_b32 s47, s47, s48
    s_mul_i32 s48, s47, 3072
    s_add_u32 s48, s48, 0
    s_lshl_b32 s47, s47, 2
    s_add_u32 s47, s47, 151552
    v_add_u32 v3, s48, v2
    v_mov_b32 v0, s47
    ds_read_b32 v0, v0
    v_cvt_pk_bf16_f32 v127, v130, v131
    v_exp_f32 v133, v133
    v_exp_f32 v134, v134
    v_exp_f32 v135, v135
    v_mfma_f32_32x32x16_bf16 v[140:155], v[100:103], v[124:127], v[140:155]
    v_exp_f32 v136, v136
    v_exp_f32 v137, v137
    v_cvt_pk_bf16_f32 v132, v132, v133
    v_exp_f32 v138, v138
    v_exp_f32 v139, v139
    v_cvt_pk_bf16_f32 v133, v134, v135
    v_cvt_pk_bf16_f32 v134, v136, v137
    v_cvt_pk_bf16_f32 v135, v138, v139
    s_cmp_lt_u32 s18, 4
    s_cbranch_scc1 AT_bal6_0
    s_setprio 0
AT_bal6_0:
    v_exp_f32 v108, v108
    v_exp_f32 v109, v109
    v_mfma_f32_32x32x16_bf16 v[140:155], v[104:107], v[132:135], v[140:155]
    v_exp_f32 v110, v110
    v_exp_f32 v111, v111
    v_mfma_f32_32x32x16_bf16 v[124:139], v[8:11], v[156:159], 0
    v_exp_f32 v112, v112
    v_exp_f32 v113, v113
    v_cvt_pk_bf16_f32 v108, v108, v109
    v_exp_f32 v114, v114
    v_exp_f32 v115, v115
    v_cvt_pk_bf16_f32 v109, v110, v111
    v_mfma_f32_32x32x8bf16_1k v[124:139], v[36:37], v[166:167], v[124:139]
    v_exp_f32 v116, v116
    v_cvt_pk_bf16_f32 v110, v112, v113
    s_waitcnt lgkmcnt(0)
    v_readfirstlane_b32 s49, v0
    s_cmp_ge_u32 s49, 9
    s_cbranch_scc0 AT_slow10
AT_back10:
    ds_wrxchg2st64_rtn_b64 v[140:143], v3, v[140:141], v[142:143] offset0:0 offset1:1
    ds_wrxchg2st64_rtn_b64 v[144:147], v3, v[144:145], v[146:147] offset0:2 offset1:3
    ds_wrxchg2st64_rtn_b64 v[148:151], v3, v[148:149], v[150:151] offset0:4 offset1:5
    v_mov_b32 v0, s47
    v_mov_b32 v3, 10
    ds_write_b32 v0, v3
    v_cvt_pk_bf16_f32 v111, v114, v115
    v_exp_f32 v117, v117
    v_exp_f32 v118, v118
    v_exp_f32 v119, v119
    v_exp_f32 v120, v120
    v_exp_f32 v121, v121
    v_cvt_pk_bf16_f32 v116, v116, v117
    v_exp_f32 v122, v122
    v_exp_f32 v123, v123
    v_cvt_pk_bf16_f32 v117, v118, v119
    v_cvt_pk_bf16_f32 v118, v120, v121
    v_cvt_pk_bf16_f32 v119, v122, v123
    s_waitcnt lgkmcnt(1)
    v_mfma_f32_32x32x16_bf16 v[140:155], v[44:47], v[108:111], v[140:155]
    v_exp_f32 v124, v124
    v_exp_f32 v125, v125
    v_mfma_f32_32x32x16_bf16 v[140:155], v[48:51], v[116:119], v[140:155]
    v_exp_f32 v126, v126
    v_exp_f32 v127, v127
    v_mfma_f32_32x32x16_bf16 v[108:123], v[12:15], v[156:159], 0
    v_exp_f32 v128, v128
    v_exp_f32 v129, v129
    v_cvt_pk_bf16_f32 v124, v124, v125
    v_exp_f32 v130, v130
    v_exp_f32 v131, v131
    v_cvt_pk_bf16_f32 v125, v126, v127
    v_mfma_f32_32x32x8bf16_1k v[108:123], v[38:39], v[164:165], v[108:123]
    v_exp_f32 v132, v132
    v_cvt_pk_bf16_f32 v126, v128, v129
    v_cvt_pk_bf16_f32 v127, v130, v131
    v_exp_f32 v133, v133
    v_exp_f32 v134, v134
    v_exp_f32 v135, v135
    v_mfma_f32_32x32x16_bf16 v[140:155], v[52:55], v[124:127], v[140:155]
    v_exp_f32 v136, v136
    v_exp_f32 v137, v137
    v_cvt_pk_bf16_f32 v132, v132, v133
    v_exp_f32 v138, v138
    v_exp_f32 v139, v139
    v_cvt_pk_bf16_f32 v133, v134, v135
    v_cvt_pk_bf16_f32 v134, v136, v137
    v_cvt_pk_bf16_f32 v135, v138, v139
    s_cmp_lt_u32 s18, 4
    s_cbranch_scc1 AT_bal6_2
    s_setprio 1
AT_bal6_2:
    v_exp_f32 v108, v108
    v_exp_f32 v109, v109
    v_mfma_f32_32x32x16_bf16 v[140:155], v[56:59], v[132:135], v[140:155]
    v_exp_f32 v110, v110
    v_exp_f32 v111, v111
    v_mfma_f32_32x32x16_bf16 v[124:139], v[16:19], v[156:159], 0
    v_exp_f32 v112, v112
    v_exp_f32 v113, v113
    v_cvt_pk_bf16_f32 v108, v108, v109
    v_exp_f32 v114, v114
    v_exp_f32 v115, v115
    v_cvt_pk_bf16_f32 v109, v110, v111
    v_mfma_f32_32x32x8bf16_1k v[124:139], v[38:39], v[166:167], v[124:139]
    v_exp_f32 v116, v116
    v_cvt_pk_bf16_f32 v110, v112, v113
    v_cvt_pk_bf16_f32 v111, v114, v115
    v_exp_f32 v117, v117
    v_exp_f32 v118, v118
    v_exp_f32 v119, v119
    v_mfma_f32_32x32x16_bf16 v[140:155], v[60:63], v[108:111], v[140:155]
    v_exp_f32 v120, v120
    v_exp_f32 v121, v121
    v_cvt_pk_bf16_f32 v116, v116, v117
    v_exp_f32 v122, v122
    v_exp_f32 v123, v123
    v_cvt_pk_bf16_f32 v117, v118, v119
    v_cvt_pk_bf16_f32 v118, v120, v121
    v_cvt_pk_bf16_f32 v119, v122, v123
    v_exp_f32 v124, v124
    v_exp_f32 v125, v125
    v_mfma_f32_32x32x16_bf16 v[140:155], v[64:67], v[116:119], v[140:155]
    v_exp_f32 v126, v126
    v_exp_f32 v127, v127
    v_mfma_f32_32x32x16_bf16 v[108:123], v[20:23], v[156:159], 0
    v_exp_f32 v128, v128
    v_exp_f32 v129, v129
    v_cvt_pk_bf16_f32 v124, v124, v125
    v_exp_f32 v130, v130
    v_exp_f32 v131, v131
    v_cvt_pk_bf16_f32 v125, v126, v127
    v_mfma_f32_32x32x8bf16_1k v[108:123], v[40:41], v[164:165], v[108:123]
    v_exp_f32 v132, v132
    v_cvt_pk_bf16_f32 v126, v128, v129
    v_cvt_pk_bf16_f32 v127, v130, v131
    v_exp_f32 v133, v133
    v_exp_f32 v134, v134
    v_exp_f32 v135, v135
    v_mfma_f32_32x32x16_bf16 v[140:155], v[68:71], v[124:127], v[140:155]
    v_exp_f32 v136, v136
    v_exp_f32 v137, v137
    v_cvt_pk_bf16_f32 v132, v132, v133
    v_exp_f32 v138, v138
    v_exp_f32 v139, v139
    v_cvt_pk_bf16_f32 v133, v134, v135
    v_cvt_pk_bf16_f32 v134, v136, v137
    v_cvt_pk_bf16_f32 v135, v138, v139
    v_exp_f32 v108, v108
    v_exp_f32 v109, v109
    v_mfma_f32_32x32x16_bf16 v[140:155], v[72:75], v[132:135], v[140:155]
    v_exp_f32 v110, v110
    v_exp_f32 v111, v111
    v_mfma_f32_32x32x16_bf16 v[124:139], v[24:27], v[156:159], 0
    v_exp_f32 v112, v112
    v_exp_f32 v113, v113
    v_cvt_pk_bf16_f32 v108, v108, v109
    v_exp_f32 v114, v114
    v_exp_f32 v115, v115
    v_cvt_pk_bf16_f32 v109, v110, v111
    v_mfma_f32_32x32x8bf16_1k v[124:139], v[40:41], v[166:167], v[124:139]
    v_exp_f32 v116, v116
    v_cvt_pk_bf16_f32 v110, v112, v113
    v_cvt_pk_bf16_f32 v111, v114, v115
    v_exp_f32 v117, v117
    v_exp_f32 v118, v118
    v_exp_f32 v119, v119
    v_mfma_f32_32x32x16_bf16 v[140:155], v[76:79], v[108:111], v[140:155]
    v_exp_f32 v120, v120
    v_exp_f32 v121, v121
    v_cvt_pk_bf16_f32 v116, v116, v117
    v_exp_f32 v122, v122
    v_exp_f32 v123, v123
    v_cvt_pk_bf16_f32 v117, v118, v119
    v_cvt_pk_bf16_f32 v118, v120, v121
    v_cvt_pk_bf16_f32 v119, v122, v123
    v_exp_f32 v124, v124
    v_exp_f32 v125, v125
    v_mfma_f32_32x32x16_bf16 v[140:155], v[80:83], v[116:119], v[140:155]
    v_exp_f32 v126, v126
    v_exp_f32 v127, v127
    v_mfma_f32_32x32x16_bf16 v[108:123], v[28:31], v[156:159], 0
    v_exp_f32 v128, v128
    v_exp_f32 v129, v129
    v_cvt_pk_bf16_f32 v124, v124, v125
    v_exp_f32 v130, v130
    v_exp_f32 v131, v131
    v_cvt_pk_bf16_f32 v125, v126, v127
    v_mfma_f32_32x32x8bf16_1k v[108:123], v[42:43], v[164:165], v[108:123]
    v_exp_f32 v132, v132
    v_cvt_pk_bf16_f32 v126, v128, v129
    s_add_u32 s24, s18, 3
    s_and_b32 s24, s24, 3
    s_mul_i32 s24, s24, 2560
    s_add_u32 s24, s24, 153088
    v_add_u32 v160, s24, v1
    ds_read_b128 v[160:163], v160
    s_mov_b32 exec_hi, 0
    v_add_u32 v164, s24, v2
    ds_read_b64 v[164:165], v164 offset:1024
    s_mov_b32 exec_hi, -1
    v_cvt_pk_bf16_f32 v127, v130, v131
    v_exp_f32 v133, v133
    v_exp_f32 v134, v134
    v_exp_f32 v135, v135
    v_mfma_f32_32x32x16_bf16 v[140:155], v[84:87], v[124:127], v[140:155]
    v_exp_f32 v136, v136
    v_exp_f32 v137, v137
    v_cvt_pk_bf16_f32 v132, v132, v133
    v_exp_f32 v138, v138
    v_exp_f32 v139, v139
    v_cvt_pk_bf16_f32 v133, v134, v135
    v_cvt_pk_bf16_f32 v134, v136, v137
    v_cvt_pk_bf16_f32 v135, v138, v139
    v_exp_f32 v108, v108
    v_exp_f32 v109, v109
    v_mfma_f32_32x32x16_bf16 v[140:155], v[88:91], v[132:135], v[140:155]
    v_exp_f32 v110, v110
    v_exp_f32 v111, v111
    v_mfma_f32_32x32x16_bf16 v[124:139], v[32:35], v[156:159], 0
    v_exp_f32 v112, v112
    v_exp_f32 v113, v113
    v_cvt_pk_bf16_f32 v108, v108, v109
    v_exp_f32 v114, v114
    v_exp_f32 v115, v115
    v_cvt_pk_bf16_f32 v109, v110, v111
    v_mfma_f32_32x32x8bf16_1k v[124:139], v[42:43], v[166:167], v[124:139]
    v_exp_f32 v116, v116
    v_cvt_pk_bf16_f32 v110, v112, v113
    s_mov_b32 exec_lo, 0
    v_add_u32 v166, s24, v2
    ds_read_b64 v[166:167], v166 offset:768
    s_mov_b32 exec_lo, -1
    v_cvt_pk_bf16_f32 v111, v114, v115
    v_exp_f32 v117, v117
    v_exp_f32 v118, v118
    v_exp_f32 v119, v119
    v_mfma_f32_32x32x16_bf16 v[140:155], v[92:95], v[108:111], v[140:155]
    v_exp_f32 v120, v120
    v_exp_f32 v121, v121
    v_cvt_pk_bf16_f32 v116, v116, v117
    v_exp_f32 v122, v122
    v_exp_f32 v123, v123
    v_cvt_pk_bf16_f32 v117, v118, v119
    v_cvt_pk_bf16_f32 v118, v120, v121
    v_cvt_pk_bf16_f32 v119, v122, v123
    v_exp_f32 v124, v124
    v_exp_f32 v125, v125
    v_mfma_f32_32x32x16_bf16 v[140:155], v[96:99], v[116:119], v[140:155]
    v_exp_f32 v126, v126
    v_exp_f32 v127, v127
    s_waitcnt lgkmcnt(0)
    v_mfma_f32_32x32x16_bf16 v[108:123], v[4:7], v[160:163], 0
    v_exp_f32 v128, v128
    v_exp_f32 v129, v129
    v_cvt_pk_bf16_f32 v124, v124, v125
    v_exp_f32 v130, v130
    v_exp_f32 v131, v131
    v_cvt_pk_bf16_f32 v125, v126, v127
    v_mfma_f32_32x32x8bf16_1k v[108:123], v[36:37], v[164:165], v[108:123]
    v_exp_f32 v132, v132
    v_cvt_pk_bf16_f32 v126, v128, v129
    s_add_u32 s47, s18, 4
    s_and_b32 s47, s47, 3
    s_and_b32 s48, s18, 4
    s_or_b32 s47, s47, s48
    s_mul_i32 s48, s47, 3072
    s_add_u32 s48, s48, 0
    s_lshl_b32 s47, s47, 2
    s_add_u32 s47, s47, 151552
    v_add_u32 v3, s48, v2
    v_mov_b32 v0, s47
    ds_read_b32 v0, v0
    v_cvt_pk_bf16_f32 v127, v130, v131
    v_exp_f32 v133, v133
    v_exp_f32 v134, v134
    v_exp_f32 v135, v135
    v_mfma_f32_32x32x16_bf16 v[140:155], v[100:103], v[124:127], v[140:155]
    v_exp_f32 v136, v136
    v_exp_f32 v137, v137
    v_cvt_pk_bf16_f32 v132, v132, v133
    v_exp_f32 v138, v138
    v_exp_f32 v139, v139
    v_cvt_pk_bf16_f32 v133, v134, v135
    v_cvt_pk_bf16_f32 v134, v136, v137
    v_cvt_pk_bf16_f32 v135, v138, v139
    s_cmp_lt_u32 s18, 4
    s_cbranch_scc1 AT_bal7_0
    s_setprio 0
AT_bal7_0:
    v_exp_f32 v108, v108
    v_exp_f32 v109, v109
    v_mfma_f32_32x32x16_bf16 v[140:155], v[104:107], v[132:135], v[140:155]
    v_exp_f32 v110, v110
    v_exp_f32 v111, v111
    v_mfma_f32_32x32x16_bf16 v[124:139], v[8:11], v[160:163], 0
    v_exp_f32 v112, v112
    v_exp_f32 v113, v113
    v_cvt_pk_bf16_f32 v108, v108, v109
    v_exp_f32 v114, v114
    v_exp_f32 v115, v115
    v_cvt_pk_bf16_f32 v109, v110, v111
    v_mfma_f32_32x32x8bf16_1k v[124:139], v[36:37], v[166:167], v[124:139]
    v_exp_f32 v116, v116
    v_cvt_pk_bf16_f32 v110, v112, v113
    s_waitcnt lgkmcnt(0)
    v_readfirstlane_b32 s49, v0
    s_cmp_ge_u32 s49, 10
    s_cbranch_scc0 AT_slow11
AT_back11:
    ds_wrxchg2st64_rtn_b64 v[140:143], v3, v[140:141], v[142:143] offset0:0 offset1:1
    ds_wrxchg2st64_rtn_b64 v[144:147], v3, v[144:145], v[146:147] offset0:2 offset1:3
    ds_wrxchg2st64_rtn_b64 v[148:151], v3, v[148:149], v[150:151] offset0:4 offset1:5
    v_mov_b32 v0, s47
    v_mov_b32 v3, 11
    ds_write_b32 v0, v3
    v_cvt_pk_bf16_f32 v111, v114, v115
    v_exp_f32 v117, v117
    v_exp_f32 v118, v118
    v_exp_f32 v119, v119
    v_exp_f32 v120, v120
    v_exp_f32 v121, v121
    v_cvt_pk_bf16_f32 v116, v116, v117
    v_exp_f32 v122, v122
    v_exp_f32 v123, v123
    v_cvt_pk_bf16_f32 v117, v118, v119
    v_cvt_pk_bf16_f32 v118, v120, v121
    v_cvt_pk_bf16_f32 v119, v122, v123
    s_waitcnt lgkmcnt(1)
    v_mfma_f32_32x32x16_bf16 v[140:155], v[44:47], v[108:111], v[140:155]
    v_exp_f32 v124, v124
    v_exp_f32 v125, v125
    v_mfma_f32_32x32x16_bf16 v[140:155], v[48:51], v[116:119], v[140:155]
    v_exp_f32 v126, v126
    v_exp_f32 v127, v127
    v_mfma_f32_32x32x16_bf16 v[108:123], v[12:15], v[160:163], 0
    v_exp_f32 v128, v128
    v_exp_f32 v129, v129
    v_cvt_pk_bf16_f32 v124, v124, v125
    v_exp_f32 v130, v130
    v_exp_f32 v131, v131
    v_cvt_pk_bf16_f32 v125, v126, v127
    v_mfma_f32_32x32x8bf16_1k v[108:123], v[38:39], v[164:165], v[108:123]
    v_exp_f32 v132, v132
    v_cvt_pk_bf16_f32 v126, v128, v129
    s_add_u32 s44, s18, 3
    s_bfe_u32 s45, s44, 0x10001
    s_lshl_b32 s50, s45, 7
    s_add_u32 s50, s50, 162048
    v_lshrrev_b32 v156, 1, v2
    v_and_b32 v156, 127, v156
    v_add_u32 v156, s50, v156
    ds_read_b32 v156, v156
    v_mov_b32 v158, 151584
    v_mov_b32 v159, 1
    v_cvt_pk_bf16_f32 v127, v130, v131
    v_exp_f32 v133, v133
    v_exp_f32 v134, v134
    v_exp_f32 v135, v135
    v_mfma_f32_32x32x16_bf16 v[140:155], v[52:55], v[124:127], v[140:155]
    v_exp_f32 v136, v136
    v_exp_f32 v137, v137
    v_cvt_pk_bf16_f32 v132, v132, v133
    v_exp_f32 v138, v138
    v_exp_f32 v139, v139
    v_cvt_pk_bf16_f32 v133, v134, v135
    v_cvt_pk_bf16_f32 v134, v136, v137
    v_cvt_pk_bf16_f32 v135, v138, v139
    s_cmp_lt_u32 s18, 4
    s_cbranch_scc1 AT_bal7_2
    s_setprio 1
AT_bal7_2:
    v_exp_f32 v108, v108
    v_exp_f32 v109, v109
    v_mfma_f32_32x32x16_bf16 v[140:155], v[56:59], v[132:135], v[140:155]
    v_exp_f32 v110, v110
    v_exp_f32 v111, v111
    v_mfma_f32_32x32x16_bf16 v[124:139], v[16:19], v[160:163], 0
    v_exp_f32 v112, v112
    v_exp_f32 v113, v113
    v_cvt_pk_bf16_f32 v108, v108, v109
    v_exp_f32 v114, v114
    v_exp_f32 v115, v115
    v_cvt_pk_bf16_f32 v109, v110, v111
    v_mfma_f32_32x32x8bf16_1k v[124:139], v[38:39], v[166:167], v[124:139]
    v_exp_f32 v116, v116
    v_cvt_pk_bf16_f32 v110, v112, v113
    v_cvt_pk_bf16_f32 v111, v114, v115
    v_exp_f32 v117, v117
    v_exp_f32 v118, v118
    v_exp_f32 v119, v119
    v_mfma_f32_32x32x16_bf16 v[140:155], v[60:63], v[108:111], v[140:155]
    v_exp_f32 v120, v120
    v_exp_f32 v121, v121
    v_cvt_pk_bf16_f32 v116, v116, v117
    v_exp_f32 v122, v122
    v_exp_f32 v123, v123
    v_cvt_pk_bf16_f32 v117, v118, v119
    v_cvt_pk_bf16_f32 v118, v120, v121
    v_cvt_pk_bf16_f32 v119, v122, v123
    v_exp_f32 v124, v124
    v_exp_f32 v125, v125
    v_mfma_f32_32x32x16_bf16 v[140:155], v[64:67], v[116:119], v[140:155]
    v_exp_f32 v126, v126
    v_exp_f32 v127, v127
    v_mfma_f32_32x32x16_bf16 v[108:123], v[20:23], v[160:163], 0
    v_exp_f32 v128, v128
    v_exp_f32 v129, v129
    v_cvt_pk_bf16_f32 v124, v124, v125
    v_exp_f32 v130, v130
    v_exp_f32 v131, v131
    v_cvt_pk_bf16_f32 v125, v126, v127
    v_mfma_f32_32x32x8bf16_1k v[108:123], v[40:41], v[164:165], v[108:123]
    v_exp_f32 v132, v132
    v_cvt_pk_bf16_f32 v126, v128, v129
    v_cvt_pk_bf16_f32 v127, v130, v131
    v_exp_f32 v133, v133
    v_exp_f32 v134, v134
    v_exp_f32 v135, v135
    v_mfma_f32_32x32x16_bf16 v[140:155], v[68:71], v[124:127], v[140:155]
    v_exp_f32 v136, v136
    v_exp_f32 v137, v137
    v_cvt_pk_bf16_f32 v132, v132, v133
    v_exp_f32 v138, v138
    v_exp_f32 v139, v139
    v_cvt_pk_bf16_f32 v133, v134, v135
    v_cvt_pk_bf16_f32 v134, v136, v137
    v_cvt_pk_bf16_f32 v135, v138, v139
    v_exp_f32 v108, v108
    v_exp_f32 v109, v109
    v_mfma_f32_32x32x16_bf16 v[140:155], v[72:75], v[132:135], v[140:155]
    v_exp_f32 v110, v110
    v_exp_f32 v111, v111
    v_mfma_f32_32x32x16_bf16 v[124:139], v[24:27], v[160:163], 0
    v_exp_f32 v112, v112
    v_exp_f32 v113, v113
    v_cvt_pk_bf16_f32 v108, v108, v109
    v_exp_f32 v114, v114
    v_exp_f32 v115, v115
    v_cvt_pk_bf16_f32 v109, v110, v111
    v_mfma_f32_32x32x8bf16_1k v[124:139], v[40:41], v[166:167], v[124:139]
    v_exp_f32 v116, v116
    v_cvt_pk_bf16_f32 v110, v112, v113
    v_cvt_pk_bf16_f32 v111, v114, v115
    v_exp_f32 v117, v117
    v_exp_f32 v118, v118
    v_exp_f32 v119, v119
    v_mfma_f32_32x32x16_bf16 v[140:155], v[76:79], v[108:111], v[140:155]
    v_exp_f32 v120, v120
    v_exp_f32 v121, v121
    v_cvt_pk_bf16_f32 v116, v116, v117
    v_exp_f32 v122, v122
    v_exp_f32 v123, v123
    v_cvt_pk_bf16_f32 v117, v118, v119
    v_cvt_pk_bf16_f32 v118, v120, v121
    v_cvt_pk_bf16_f32 v119, v122, v123
    v_exp_f32 v124, v124
    v_exp_f32 v125, v125
    v_mfma_f32_32x32x16_bf16 v[140:155], v[80:83], v[116:119], v[140:155]
    v_exp_f32 v126, v126
    v_exp_f32 v127, v127
    v_mfma_f32_32x32x16_bf16 v[108:123], v[28:31], v[160:163], 0
    v_exp_f32 v128, v128
    v_exp_f32 v129, v129
    v_cvt_pk_bf16_f32 v124, v124, v125
    v_exp_f32 v130, v130
    v_exp_f32 v131, v131
    v_cvt_pk_bf16_f32 v125, v126, v127
    v_mfma_f32_32x32x8bf16_1k v[108:123], v[42:43], v[164:165], v[108:123]
    v_exp_f32 v132, v132
    v_cvt_pk_bf16_f32 v126, v128, v129
    v_cvt_pk_bf16_f32 v127, v130, v131
    v_exp_f32 v133, v133
    v_exp_f32 v134, v134
    v_exp_f32 v135, v135
    v_mfma_f32_32x32x16_bf16 v[140:155], v[84:87], v[124:127], v[140:155]
    v_exp_f32 v136, v136
    v_exp_f32 v137, v137
    v_cvt_pk_bf16_f32 v132, v132, v133
    v_exp_f32 v138, v138
    v_exp_f32 v139, v139
    v_cvt_pk_bf16_f32 v133, v134, v135
    v_cvt_pk_bf16_f32 v134, v136, v137
    v_cvt_pk_bf16_f32 v135, v138, v139
    v_exp_f32 v108, v108
    v_exp_f32 v109, v109
    v_mfma_f32_32x32x16_bf16 v[140:155], v[88:91], v[132:135], v[140:155]
    v_exp_f32 v110, v110
    v_exp_f32 v111, v111
    v_mfma_f32_32x32x16_bf16 v[124:139], v[32:35], v[160:163], 0
    v_exp_f32 v112, v112
    v_exp_f32 v113, v113
    v_cvt_pk_bf16_f32 v108, v108, v109
    v_exp_f32 v114, v114
    v_exp_f32 v115, v115
    v_cvt_pk_bf16_f32 v109, v110, v111
    v_mfma_f32_32x32x8bf16_1k v[124:139], v[42:43], v[166:167], v[124:139]
    v_exp_f32 v116, v116
    v_cvt_pk_bf16_f32 v110, v112, v113
    v_cvt_pk_bf16_f32 v111, v114, v115
    v_exp_f32 v117, v117
    v_exp_f32 v118, v118
    v_exp_f32 v119, v119
    v_mfma_f32_32x32x16_bf16 v[140:155], v[92:95], v[108:111], v[140:155]
    v_exp_f32 v120, v120
    v_exp_f32 v121, v121
    v_cvt_pk_bf16_f32 v116, v116, v117
    v_exp_f32 v122, v122
    v_exp_f32 v123, v123
    v_cvt_pk_bf16_f32 v117, v118, v119
    v_cvt_pk_bf16_f32 v118, v120, v121
    v_cvt_pk_bf16_f32 v119, v122, v123
    v_exp_f32 v124, v124
    v_exp_f32 v125, v125
    v_mfma_f32_32x32x16_bf16 v[140:155], v[96:99], v[116:119], v[140:155]
    v_exp_f32 v126, v126
    v_exp_f32 v127, v127
    v_exp_f32 v128, v128
    v_exp_f32 v129, v129
    v_cvt_pk_bf16_f32 v124, v124, v125
    v_exp_f32 v130, v130
    v_exp_f32 v131, v131
    v_cvt_pk_bf16_f32 v125, v126, v127
    v_exp_f32 v132, v132
    v_cvt_pk_bf16_f32 v126, v128, v129
    s_add_u32 s47, s18, 1
    s_and_b32 s47, s47, 3
    s_mul_i32 s48, s47, 3072
    s_add_u32 s48, s48, 0
    s_lshl_b32 s47, s47, 2
    s_add_u32 s47, s47, 151552
    v_add_u32 v3, s48, v2
    v_mov_b32 v0, s47
    s_mov_b64 exec, 1
    ds_add_rtn_u32 v157, v0, v159 offset:112
    s_mov_b64 exec, -1
    ds_read2_b32 v[120:121], v0 offset0:0 offset1:4
    v_cvt_pk_bf16_f32 v127, v130, v131
    v_exp_f32 v133, v133
    v_exp_f32 v134, v134
    v_exp_f32 v135, v135
    v_mfma_f32_32x32x16_bf16 v[140:155], v[100:103], v[124:127], v[140:155]
    v_exp_f32 v136, v136
    v_exp_f32 v137, v137
    v_cvt_pk_bf16_f32 v132, v132, v133
    v_exp_f32 v138, v138
    v_exp_f32 v139, v139
    v_cvt_pk_bf16_f32 v133, v134, v135
    v_cvt_pk_bf16_f32 v134, v136, v137
    v_cvt_pk_bf16_f32 v135, v138, v139
    s_nop 1
    v_mfma_f32_32x32x16_bf16 v[140:155], v[104:107], v[132:135], v[140:155]
AT_epi:
    s_waitcnt lgkmcnt(0)
    v_readfirstlane_b32 s49, v157
    s_add_u32 s50, s28, 3
    s_add_u32 s51, s28, 4
    s_cmp_eq_u32 s49, 0
    s_cbranch_scc1 AT_first
AT_sec:
    v_readfirstlane_b32 s49, v120
    s_cmp_ge_u32 s49, s51
    s_cbranch_scc0 AT_secw
    ds_read2st64_b64 v[108:111], v3 offset0:0 offset1:1
    ds_read2st64_b64 v[112:115], v3 offset0:2 offset1:3
    ds_read2st64_b64 v[116:119], v3 offset0:4 offset1:5
    v_add_u32 v120, s51, 1
    ds_write_b32 v0, v120
    s_mov_b32 s56, 0
    s_mov_b32 s52, 0x1f800000
    s_mov_b32 s53, 0x5f800000
    s_mov_b32 s54, 0x7b800000
    s_mov_b32 s55, 0xfffe0000
    s_waitcnt vmcnt(0) lgkmcnt(1)
    v_add_f32 v140, v140, v108
    v_add_f32 v141, v141, v109
    v_add_f32 v142, v142, v110
    v_add_f32 v143, v143, v111
    v_add_f32 v144, v144, v112
    v_add_f32 v145, v145, v113
    v_add_f32 v146, v146, v114
    v_add_f32 v147, v147, v115
    v_add_f32 v148, v148, v116
    v_add_f32 v149, v149, v117
    v_add_f32 v150, v150, v118
    v_add_f32 v151, v151, v119
AT_norm:
    v_mov_b32 v108, v148
    v_mov_b32 v109, v148
    v_max3_f32 v110, |v140|, |v141|, |v142|
    v_max3_f32 v111, |v143|, |v144|, |v145|
    v_permlane32_swap_b32 v108, v109
    v_max3_f32 v110, |v146|, |v147|, v110
    v_max3_f32 v111, |v148|, |v149|, v111
    v_rcp_f32 v108, v109
    v_max3_f32 v110, |v150|, |v151|, v110
    v_max_f32 v110, v110, v111
    v_cmp_nle_f32 s[58:59], s52, v109
    v_cmp_nge_f32 s[60:61], s53, v109
    v_cmp_nge_f32 s[62:63], s54, v110
    v_mul_f32 v108, v108, v156
    s_or_b64 s[58:59], s[58:59], s[60:61]
    s_or_b64 s[58:59], s[58:59], s[62:63]
    s_cmp_lg_u32 s56, 0
    s_cselect_b64 s[58:59], 0, s[58:59]
    s_cmp_lg_u64 s[58:59], 0
    s_cbranch_scc1 AT_fb
    v_mul_f32 v140, v140, v108
    v_mul_f32 v148, v148, v108
    v_mul_f32 v141, v141, v108
    v_add_u32 v140, 0x10000, v140
    v_mul_f32 v142, v142, v108
    v_add_u32 v148, 0x10000, v148
    v_mul_f32 v143, v143, v108
    v_and_b32 v140, s55, v140
    v_mul_f32 v144, v144, v108
    v_and_b32 v148, s55, v148
    v_mul_f32 v145, v145, v108
    v_mul_f32 v146, v146, v108
    v_mul_f32 v147, v147, v108
    v_mul_f32 v149, v149, v108
    v_mul_f32 v150, v150, v108
    v_mul_f32 v151, v151, v108
    v_cvt_pk_bf16_f32 v140, v140, v141
    v_cvt_pk_bf16_f32 v141, v142, v143
    v_cvt_pk_bf16_f32 v142, v144, v145
    v_cvt_pk_bf16_f32 v143, v146, v147
    v_cvt_pk_bf16_f32 v144, v148, v149
    v_cvt_pk_bf16_f32 v145, v150, v151
    buffer_store_dwordx4 v[140:143], v1, s[32:35], s26 offen sc1
    s_mov_b32 exec_hi, 0
    buffer_store_dwordx2 v[144:145], v2, s[32:35], s27 offen sc1
    s_mov_b32 exec_lo, 1
    ds_add_u32 v158, v159
    s_mov_b64 exec, -1
AT_next:
    s_cmp_eq_u32 s28, 0
    s_cbranch_scc1 AT_h1
    s_endpgm
AT_qs:
    s_sleep 1
    s_branch AT_q
AT_slow2:
    s_sleep 1
    v_mov_b32 v0, s47
    ds_read_b32 v0, v0
    s_waitcnt lgkmcnt(0)
    v_readfirstlane_b32 s49, v0
    s_cmp_ge_u32 s49, 1
    s_cbranch_scc0 AT_slow2
    s_branch AT_back2
AT_slow3:
    s_sleep 1
    v_mov_b32 v0, s47
    ds_read_b32 v0, v0
    s_waitcnt lgkmcnt(0)
    v_readfirstlane_b32 s49, v0
    s_cmp_ge_u32 s49, 2
    s_cbranch_scc0 AT_slow3
    s_branch AT_back3
AT_slow9:
    s_sleep 1
    v_mov_b32 v0, s47
    ds_read_b32 v0, v0
    s_waitcnt lgkmcnt(0)
    v_readfirstlane_b32 s49, v0
    s_cmp_ge_u32 s49, 5
    s_cbranch_scc0 AT_slow9
    s_branch AT_back9
AT_slow10:
    s_sleep 1
    v_mov_b32 v0, s47
    ds_read_b32 v0, v0
    s_waitcnt lgkmcnt(0)
    v_readfirstlane_b32 s49, v0
    s_cmp_ge_u32 s49, 9
    s_cbranch_scc0 AT_slow10
    s_branch AT_back10
AT_slow11:
    s_sleep 1
    v_mov_b32 v0, s47
    ds_read_b32 v0, v0
    s_waitcnt lgkmcnt(0)
    v_readfirstlane_b32 s49, v0
    s_cmp_ge_u32 s49, 10
    s_cbranch_scc0 AT_slow11
    s_branch AT_back11
AT_secw:
    s_sleep 1
    ds_read_b32 v120, v0
    s_waitcnt lgkmcnt(0)
    s_branch AT_sec
AT_firstw:
    s_sleep 1
    ds_read2_b32 v[120:121], v0 offset0:0 offset1:4
    s_waitcnt lgkmcnt(0)
AT_first:
    v_min_u32 v120, v120, v121
    s_nop 0
    v_readfirstlane_b32 s49, v120
    s_cmp_ge_u32 s49, s50
    s_cbranch_scc0 AT_firstw
    ds_read2st64_b64 v[108:111], v3 offset0:0 offset1:1
    ds_read2st64_b64 v[112:115], v3 offset0:2 offset1:3
    ds_read2st64_b64 v[116:119], v3 offset0:4 offset1:5
    ds_read2st64_b64 v[124:127], v3 offset0:24 offset1:25
    ds_read2st64_b64 v[128:131], v3 offset0:26 offset1:27
    ds_read2st64_b64 v[132:135], v3 offset0:28 offset1:29
    v_mov_b32 v120, s51
    v_add_u32 v121, 1, v120
    s_nop 7
    s_waitcnt lgkmcnt(3)
    v_add_f32 v140, v140, v108
    v_add_f32 v141, v141, v109
    v_add_f32 v142, v142, v110
    v_add_f32 v143, v143, v111
    v_add_f32 v144, v144, v112
    v_add_f32 v145, v145, v113
    v_add_f32 v146, v146, v114
    v_add_f32 v147, v147, v115
    v_add_f32 v148, v148, v116
    v_add_f32 v149, v149, v117
    v_add_f32 v150, v150, v118
    v_add_f32 v151, v151, v119
    s_waitcnt lgkmcnt(0)
    v_add_f32 v140, v140, v124
    v_add_f32 v141, v141, v125
    v_add_f32 v142, v142, v126
    v_add_f32 v143, v143, v127
    v_add_f32 v144, v144, v128
    v_add_f32 v145, v145, v129
    v_add_f32 v146, v146, v130
    v_add_f32 v147, v147, v131
    v_add_f32 v148, v148, v132
    v_add_f32 v149, v149, v133
    v_add_f32 v150, v150, v134
    v_add_f32 v151, v151, v135
    ds_write2st64_b64 v3, v[140:141], v[142:143] offset0:0 offset1:1
    ds_write2st64_b64 v3, v[144:145], v[146:147] offset0:2 offset1:3
    ds_write2st64_b64 v3, v[148:149], v[150:151] offset0:4 offset1:5
    ds_write2_b32 v0, v120, v121 offset0:0 offset1:4
    s_branch AT_next
AT_fb:
    s_mov_b32 s56, 1
    s_mov_b32 s57, 0
    v_mov_b32 v157, 0xff800000
    v_lshrrev_b32 v3, 2, v1
    v_and_b32 v3, 128, v3
    v_and_b32 v0, 256, v1
    v_max_u32 v0, v0, v3
    v_add_u32 v3, v0, v3
    v_and_b32 v0, 0x1f0, v1
    v_cmp_lt_u32 vcc, 320, v0
    v_add_u32 v3, v0, v3
    s_nop 0
    v_cndmask_b32 v3, v3, 2.0, vcc
    v_mov_b32 v140, 0
    v_mov_b32 v141, 0
    v_mov_b32 v142, 0
    v_mov_b32 v143, 0
    v_mov_b32 v144, 0
    v_mov_b32 v145, 0
    v_mov_b32 v146, 0
    v_mov_b32 v147, 0
    v_mov_b32 v148, 0
    v_mov_b32 v149, 0
    v_mov_b32 v150, 0
    v_mov_b32 v151, 0
    v_mov_b32 v152, 0
    v_mov_b32 v153, 0
    v_mov_b32 v154, 0
    v_mov_b32 v155, 0
AT_fb_pass:
    s_mov_b32 s29, 0
AT_fb_g:
    s_add_u32 s29, s29, 1
    s_add_u32 s40, s29, s18
    s_and_b32 s40, s40, 7
    s_lshl_b32 s21, s40, 13
    s_add_u32 s21, s21, 3145728
    s_lshl_b32 s22, s40, 11
    s_add_u32 s22, s22, 3211264
    s_mul_i32 s23, s40, 12288
    s_add_u32 s23, s23, 3276800
    buffer_load_dwordx4 v[4:7], v1, s[32:35], s21 offen offset:0 sc1
    buffer_load_dwordx2 v[36:37], v2, s[32:35], s22 offen offset:0 sc1
    buffer_load_dwordx4 v[44:47], v3, s[32:35], s23 offen offset:0 sc1
    buffer_load_dwordx4 v[48:51], v3, s[32:35], s23 offen offset:768 sc1
    buffer_load_dwordx4 v[8:11], v1, s[32:35], s21 offen offset:1024 sc1
    buffer_load_dwordx4 v[52:55], v3, s[32:35], s23 offen offset:1536 sc1
    buffer_load_dwordx4 v[56:59], v3, s[32:35], s23 offen offset:2304 sc1
    buffer_load_dwordx4 v[12:15], v1, s[32:35], s21 offen offset:2048 sc1
    buffer_load_dwordx2 v[38:39], v2, s[32:35], s22 offen offset:512 sc1
    s_add_u32 s23, s23, 3072
    buffer_load_dwordx4 v[60:63], v3, s[32:35], s23 offen offset:0 sc1
    buffer_load_dwordx4 v[64:67], v3, s[32:35], s23 offen offset:768 sc1
    buffer_load_dwordx4 v[16:19], v1, s[32:35], s21 offen offset:3072 sc1
    buffer_load_dwordx4 v[68:71], v3, s[32:35], s23 offen offset:1536 sc1
    buffer_load_dwordx4 v[72:75], v3, s[32:35], s23 offen offset:2304 sc1
    s_add_u32 s21, s21, 4096
    buffer_load_dwordx4 v[20:23], v1, s[32:35], s21 offen offset:0 sc1
    buffer_load_dwordx2 v[40:41], v2, s[32:35], s22 offen offset:1024 sc1
    s_add_u32 s23, s23, 3072
    buffer_load_dwordx4 v[76:79], v3, s[32:35], s23 offen offset:0 sc1
    buffer_load_dwordx4 v[80:83], v3, s[32:35], s23 offen offset:768 sc1
    buffer_load_dwordx4 v[24:27], v1, s[32:35], s21 offen offset:1024 sc1
    buffer_load_dwordx4 v[84:87], v3, s[32:35], s23 offen offset:1536 sc1
    buffer_load_dwordx4 v[88:91], v3, s[32:35], s23 offen offset:2304 sc1
    buffer_load_dwordx4 v[28:31], v1, s[32:35], s21 offen offset:2048 sc1
    buffer_load_dwordx2 v[42:43], v2, s[32:35], s22 offen offset:1536 sc1
    s_add_u32 s23, s23, 3072
    buffer_load_dwordx4 v[92:95], v3, s[32:35], s23 offen offset:0 sc1
    buffer_load_dwordx4 v[96:99], v3, s[32:35], s23 offen offset:768 sc1
    buffer_load_dwordx4 v[32:35], v1, s[32:35], s21 offen offset:3072 sc1
    buffer_load_dwordx4 v[100:103], v3, s[32:35], s23 offen offset:1536 sc1
    buffer_load_dwordx4 v[104:107], v3, s[32:35], s23 offen offset:2304 sc1
    s_waitcnt vmcnt(0)
    s_cmp_eq_u32 s57, 0
    s_cbranch_scc0 AT_fb_p2
    v_mfma_f32_32x32x16_bf16 v[108:123], v[4:7], v[160:163], 0
    v_mfma_f32_32x32x8bf16_1k v[108:123], v[36:37], v[164:165], v[108:123]
    s_nop 11
    v_max3_f32 v157, v108, v109, v157
    v_max3_f32 v157, v110, v111, v157
    v_max3_f32 v157, v112, v113, v157
    v_max3_f32 v157, v114, v115, v157
    v_max3_f32 v157, v116, v117, v157
    v_max3_f32 v157, v118, v119, v157
    v_max3_f32 v157, v120, v121, v157
    v_max3_f32 v157, v122, v123, v157
    v_mfma_f32_32x32x16_bf16 v[108:123], v[8:11], v[160:163], 0
    v_mfma_f32_32x32x8bf16_1k v[108:123], v[36:37], v[166:167], v[108:123]
    s_nop 11
    v_max3_f32 v157, v108, v109, v157
    v_max3_f32 v157, v110, v111, v157
    v_max3_f32 v157, v112, v113, v157
    v_max3_f32 v157, v114, v115, v157
    v_max3_f32 v157, v116, v117, v157
    v_max3_f32 v157, v118, v119, v157
    v_max3_f32 v157, v120, v121, v157
    v_max3_f32 v157, v122, v123, v157
    v_mfma_f32_32x32x16_bf16 v[108:123], v[12:15], v[160:163], 0
    v_mfma_f32_32x32x8bf16_1k v[108:123], v[38:39], v[164:165], v[108:123]
    s_nop 11
    v_max3_f32 v157, v108, v109, v157
    v_max3_f32 v157, v110, v111, v157
    v_max3_f32 v157, v112, v113, v157
    v_max3_f32 v157, v114, v115, v157
    v_max3_f32 v157, v116, v117, v157
    v_max3_f32 v157, v118, v119, v157
    v_max3_f32 v157, v120, v121, v157
    v_max3_f32 v157, v122, v123, v157
    v_mfma_f32_32x32x16_bf16 v[108:123], v[16:19], v[160:163], 0
    v_mfma_f32_32x32x8bf16_1k v[108:123], v[38:39], v[166:167], v[108:123]
    s_nop 11
    v_max3_f32 v157, v108, v109, v157
    v_max3_f32 v157, v110, v111, v157
    v_max3_f32 v157, v112, v113, v157
    v_max3_f32 v157, v114, v115, v157
    v_max3_f32 v157, v116, v117, v157
    v_max3_f32 v157, v118, v119, v157
    v_max3_f32 v157, v120, v121, v157
    v_max3_f32 v157, v122, v123, v157
    v_mfma_f32_32x32x16_bf16 v[108:123], v[20:23], v[160:163], 0
    v_mfma_f32_32x32x8bf16_1k v[108:123], v[40:41], v[164:165], v[108:123]
    s_nop 11
    v_max3_f32 v157, v108, v109, v157
    v_max3_f32 v157, v110, v111, v157
    v_max3_f32 v157, v112, v113, v157
    v_max3_f32 v157, v114, v115, v157
    v_max3_f32 v157, v116, v117, v157
    v_max3_f32 v157, v118, v119, v157
    v_max3_f32 v157, v120, v121, v157
    v_max3_f32 v157, v122, v123, v157
    v_mfma_f32_32x32x16_bf16 v[108:123], v[24:27], v[160:163], 0
    v_mfma_f32_32x32x8bf16_1k v[108:123], v[40:41], v[166:167], v[108:123]
    s_nop 11
    v_max3_f32 v157, v108, v109, v157
    v_max3_f32 v157, v110, v111, v157
    v_max3_f32 v157, v112, v113, v157
    v_max3_f32 v157, v114, v115, v157
    v_max3_f32 v157, v116, v117, v157
    v_max3_f32 v157, v118, v119, v157
    v_max3_f32 v157, v120, v121, v157
    v_max3_f32 v157, v122, v123, v157
    v_mfma_f32_32x32x16_bf16 v[108:123], v[28:31], v[160:163], 0
    v_mfma_f32_32x32x8bf16_1k v[108:123], v[42:43], v[164:165], v[108:123]
    s_nop 11
    v_max3_f32 v157, v108, v109, v157
    v_max3_f32 v157, v110, v111, v157
    v_max3_f32 v157, v112, v113, v157
    v_max3_f32 v157, v114, v115, v157
    v_max3_f32 v157, v116, v117, v157
    v_max3_f32 v157, v118, v119, v157
    v_max3_f32 v157, v120, v121, v157
    v_max3_f32 v157, v122, v123, v157
    v_mfma_f32_32x32x16_bf16 v[108:123], v[32:35], v[160:163], 0
    v_mfma_f32_32x32x8bf16_1k v[108:123], v[42:43], v[166:167], v[108:123]
    s_nop 11
    v_max3_f32 v157, v108, v109, v157
    v_max3_f32 v157, v110, v111, v157
    v_max3_f32 v157, v112, v113, v157
    v_max3_f32 v157, v114, v115, v157
    v_max3_f32 v157, v116, v117, v157
    v_max3_f32 v157, v118, v119, v157
    v_max3_f32 v157, v120, v121, v157
    v_max3_f32 v157, v122, v123, v157
    s_branch AT_fb_next
AT_fb_p2:
    v_mfma_f32_32x32x16_bf16 v[108:123], v[4:7], v[160:163], 0
    v_mfma_f32_32x32x8bf16_1k v[108:123], v[36:37], v[164:165], v[108:123]
    s_nop 11
    v_sub_f32 v108, v108, v157
    v_sub_f32 v109, v109, v157
    v_sub_f32 v110, v110, v157
    v_sub_f32 v111, v111, v157
    v_sub_f32 v112, v112, v157
    v_sub_f32 v113, v113, v157
    v_sub_f32 v114, v114, v157
    v_sub_f32 v115, v115, v157
    v_sub_f32 v116, v116, v157
    v_sub_f32 v117, v117, v157
    v_sub_f32 v118, v118, v157
    v_sub_f32 v119, v119, v157
    v_sub_f32 v120, v120, v157
    v_sub_f32 v121, v121, v157
    v_sub_f32 v122, v122, v157
    v_sub_f32 v123, v123, v157
    v_exp_f32 v108, v108
    v_exp_f32 v109, v109
    v_exp_f32 v110, v110
    v_exp_f32 v111, v111
    v_exp_f32 v112, v112
    v_exp_f32 v113, v113
    v_exp_f32 v114, v114
    v_exp_f32 v115, v115
    v_exp_f32 v116, v116
    v_exp_f32 v117, v117
    v_exp_f32 v118, v118
    v_exp_f32 v119, v119
    v_exp_f32 v120, v120
    v_exp_f32 v121, v121
    v_exp_f32 v122, v122
    v_exp_f32 v123, v123
    v_cvt_pk_bf16_f32 v108, v108, v109
    v_cvt_pk_bf16_f32 v109, v110, v111
    v_cvt_pk_bf16_f32 v110, v112, v113
    v_cvt_pk_bf16_f32 v111, v114, v115
    v_cvt_pk_bf16_f32 v116, v116, v117
    v_cvt_pk_bf16_f32 v117, v118, v119
    v_cvt_pk_bf16_f32 v118, v120, v121
    v_cvt_pk_bf16_f32 v119, v122, v123
    v_mfma_f32_32x32x16_bf16 v[140:155], v[44:47], v[108:111], v[140:155]
    s_nop 0
    v_mfma_f32_32x32x16_bf16 v[140:155], v[48:51], v[116:119], v[140:155]
    v_mfma_f32_32x32x16_bf16 v[108:123], v[8:11], v[160:163], 0
    v_mfma_f32_32x32x8bf16_1k v[108:123], v[36:37], v[166:167], v[108:123]
    s_nop 11
    v_sub_f32 v108, v108, v157
    v_sub_f32 v109, v109, v157
    v_sub_f32 v110, v110, v157
    v_sub_f32 v111, v111, v157
    v_sub_f32 v112, v112, v157
    v_sub_f32 v113, v113, v157
    v_sub_f32 v114, v114, v157
    v_sub_f32 v115, v115, v157
    v_sub_f32 v116, v116, v157
    v_sub_f32 v117, v117, v157
    v_sub_f32 v118, v118, v157
    v_sub_f32 v119, v119, v157
    v_sub_f32 v120, v120, v157
    v_sub_f32 v121, v121, v157
    v_sub_f32 v122, v122, v157
    v_sub_f32 v123, v123, v157
    v_exp_f32 v108, v108
    v_exp_f32 v109, v109
    v_exp_f32 v110, v110
    v_exp_f32 v111, v111
    v_exp_f32 v112, v112
    v_exp_f32 v113, v113
    v_exp_f32 v114, v114
    v_exp_f32 v115, v115
    v_exp_f32 v116, v116
    v_exp_f32 v117, v117
    v_exp_f32 v118, v118
    v_exp_f32 v119, v119
    v_exp_f32 v120, v120
    v_exp_f32 v121, v121
    v_exp_f32 v122, v122
    v_exp_f32 v123, v123
    v_cvt_pk_bf16_f32 v108, v108, v109
    v_cvt_pk_bf16_f32 v109, v110, v111
    v_cvt_pk_bf16_f32 v110, v112, v113
    v_cvt_pk_bf16_f32 v111, v114, v115
    v_cvt_pk_bf16_f32 v116, v116, v117
    v_cvt_pk_bf16_f32 v117, v118, v119
    v_cvt_pk_bf16_f32 v118, v120, v121
    v_cvt_pk_bf16_f32 v119, v122, v123
    v_mfma_f32_32x32x16_bf16 v[140:155], v[52:55], v[108:111], v[140:155]
    s_nop 0
    v_mfma_f32_32x32x16_bf16 v[140:155], v[56:59], v[116:119], v[140:155]
    v_mfma_f32_32x32x16_bf16 v[108:123], v[12:15], v[160:163], 0
    v_mfma_f32_32x32x8bf16_1k v[108:123], v[38:39], v[164:165], v[108:123]
    s_nop 11
    v_sub_f32 v108, v108, v157
    v_sub_f32 v109, v109, v157
    v_sub_f32 v110, v110, v157
    v_sub_f32 v111, v111, v157
    v_sub_f32 v112, v112, v157
    v_sub_f32 v113, v113, v157
    v_sub_f32 v114, v114, v157
    v_sub_f32 v115, v115, v157
    v_sub_f32 v116, v116, v157
    v_sub_f32 v117, v117, v157
    v_sub_f32 v118, v118, v157
    v_sub_f32 v119, v119, v157
    v_sub_f32 v120, v120, v157
    v_sub_f32 v121, v121, v157
    v_sub_f32 v122, v122, v157
    v_sub_f32 v123, v123, v157
    v_exp_f32 v108, v108
    v_exp_f32 v109, v109
    v_exp_f32 v110, v110
    v_exp_f32 v111, v111
    v_exp_f32 v112, v112
    v_exp_f32 v113, v113
    v_exp_f32 v114, v114
    v_exp_f32 v115, v115
    v_exp_f32 v116, v116
    v_exp_f32 v117, v117
    v_exp_f32 v118, v118
    v_exp_f32 v119, v119
    v_exp_f32 v120, v120
    v_exp_f32 v121, v121
    v_exp_f32 v122, v122
    v_exp_f32 v123, v123
    v_cvt_pk_bf16_f32 v108, v108, v109
    v_cvt_pk_bf16_f32 v109, v110, v111
    v_cvt_pk_bf16_f32 v110, v112, v113
    v_cvt_pk_bf16_f32 v111, v114, v115
    v_cvt_pk_bf16_f32 v116, v116, v117
    v_cvt_pk_bf16_f32 v117, v118, v119
    v_cvt_pk_bf16_f32 v118, v120, v121
    v_cvt_pk_bf16_f32 v119, v122, v123
    v_mfma_f32_32x32x16_bf16 v[140:155], v[60:63], v[108:111], v[140:155]
    s_nop 0
    v_mfma_f32_32x32x16_bf16 v[140:155], v[64:67], v[116:119], v[140:155]
    v_mfma_f32_32x32x16_bf16 v[108:123], v[16:19], v[160:163], 0
    v_mfma_f32_32x32x8bf16_1k v[108:123], v[38:39], v[166:167], v[108:123]
    s_nop 11
    v_sub_f32 v108, v108, v157
    v_sub_f32 v109, v109, v157
    v_sub_f32 v110, v110, v157
    v_sub_f32 v111, v111, v157
    v_sub_f32 v112, v112, v157
    v_sub_f32 v113, v113, v157
    v_sub_f32 v114, v114, v157
    v_sub_f32 v115, v115, v157
    v_sub_f32 v116, v116, v157
    v_sub_f32 v117, v117, v157
    v_sub_f32 v118, v118, v157
    v_sub_f32 v119, v119, v157
    v_sub_f32 v120, v120, v157
    v_sub_f32 v121, v121, v157
    v_sub_f32 v122, v122, v157
    v_sub_f32 v123, v123, v157
    v_exp_f32 v108, v108
    v_exp_f32 v109, v109
    v_exp_f32 v110, v110
    v_exp_f32 v111, v111
    v_exp_f32 v112, v112
    v_exp_f32 v113, v113
    v_exp_f32 v114, v114
    v_exp_f32 v115, v115
    v_exp_f32 v116, v116
    v_exp_f32 v117, v117
    v_exp_f32 v118, v118
    v_exp_f32 v119, v119
    v_exp_f32 v120, v120
    v_exp_f32 v121, v121
    v_exp_f32 v122, v122
    v_exp_f32 v123, v123
    v_cvt_pk_bf16_f32 v108, v108, v109
    v_cvt_pk_bf16_f32 v109, v110, v111
    v_cvt_pk_bf16_f32 v110, v112, v113
    v_cvt_pk_bf16_f32 v111, v114, v115
    v_cvt_pk_bf16_f32 v116, v116, v117
    v_cvt_pk_bf16_f32 v117, v118, v119
    v_cvt_pk_bf16_f32 v118, v120, v121
    v_cvt_pk_bf16_f32 v119, v122, v123
    v_mfma_f32_32x32x16_bf16 v[140:155], v[68:71], v[108:111], v[140:155]
    s_nop 0
    v_mfma_f32_32x32x16_bf16 v[140:155], v[72:75], v[116:119], v[140:155]
    v_mfma_f32_32x32x16_bf16 v[108:123], v[20:23], v[160:163], 0
    v_mfma_f32_32x32x8bf16_1k v[108:123], v[40:41], v[164:165], v[108:123]
    s_nop 11
    v_sub_f32 v108, v108, v157
    v_sub_f32 v109, v109, v157
    v_sub_f32 v110, v110, v157
    v_sub_f32 v111, v111, v157
    v_sub_f32 v112, v112, v157
    v_sub_f32 v113, v113, v157
    v_sub_f32 v114, v114, v157
    v_sub_f32 v115, v115, v157
    v_sub_f32 v116, v116, v157
    v_sub_f32 v117, v117, v157
    v_sub_f32 v118, v118, v157
    v_sub_f32 v119, v119, v157
    v_sub_f32 v120, v120, v157
    v_sub_f32 v121, v121, v157
    v_sub_f32 v122, v122, v157
    v_sub_f32 v123, v123, v157
    v_exp_f32 v108, v108
    v_exp_f32 v109, v109
    v_exp_f32 v110, v110
    v_exp_f32 v111, v111
    v_exp_f32 v112, v112
    v_exp_f32 v113, v113
    v_exp_f32 v114, v114
    v_exp_f32 v115, v115
    v_exp_f32 v116, v116
    v_exp_f32 v117, v117
    v_exp_f32 v118, v118
    v_exp_f32 v119, v119
    v_exp_f32 v120, v120
    v_exp_f32 v121, v121
    v_exp_f32 v122, v122
    v_exp_f32 v123, v123
    v_cvt_pk_bf16_f32 v108, v108, v109
    v_cvt_pk_bf16_f32 v109, v110, v111
    v_cvt_pk_bf16_f32 v110, v112, v113
    v_cvt_pk_bf16_f32 v111, v114, v115
    v_cvt_pk_bf16_f32 v116, v116, v117
    v_cvt_pk_bf16_f32 v117, v118, v119
    v_cvt_pk_bf16_f32 v118, v120, v121
    v_cvt_pk_bf16_f32 v119, v122, v123
    v_mfma_f32_32x32x16_bf16 v[140:155], v[76:79], v[108:111], v[140:155]
    s_nop 0
    v_mfma_f32_32x32x16_bf16 v[140:155], v[80:83], v[116:119], v[140:155]
    v_mfma_f32_32x32x16_bf16 v[108:123], v[24:27], v[160:163], 0
    v_mfma_f32_32x32x8bf16_1k v[108:123], v[40:41], v[166:167], v[108:123]
    s_nop 11
    v_sub_f32 v108, v108, v157
    v_sub_f32 v109, v109, v157
    v_sub_f32 v110, v110, v157
    v_sub_f32 v111, v111, v157
    v_sub_f32 v112, v112, v157
    v_sub_f32 v113, v113, v157
    v_sub_f32 v114, v114, v157
    v_sub_f32 v115, v115, v157
    v_sub_f32 v116, v116, v157
    v_sub_f32 v117, v117, v157
    v_sub_f32 v118, v118, v157
    v_sub_f32 v119, v119, v157
    v_sub_f32 v120, v120, v157
    v_sub_f32 v121, v121, v157
    v_sub_f32 v122, v122, v157
    v_sub_f32 v123, v123, v157
    v_exp_f32 v108, v108
    v_exp_f32 v109, v109
    v_exp_f32 v110, v110
    v_exp_f32 v111, v111
    v_exp_f32 v112, v112
    v_exp_f32 v113, v113
    v_exp_f32 v114, v114
    v_exp_f32 v115, v115
    v_exp_f32 v116, v116
    v_exp_f32 v117, v117
    v_exp_f32 v118, v118
    v_exp_f32 v119, v119
    v_exp_f32 v120, v120
    v_exp_f32 v121, v121
    v_exp_f32 v122, v122
    v_exp_f32 v123, v123
    v_cvt_pk_bf16_f32 v108, v108, v109
    v_cvt_pk_bf16_f32 v109, v110, v111
    v_cvt_pk_bf16_f32 v110, v112, v113
    v_cvt_pk_bf16_f32 v111, v114, v115
    v_cvt_pk_bf16_f32 v116, v116, v117
    v_cvt_pk_bf16_f32 v117, v118, v119
    v_cvt_pk_bf16_f32 v118, v120, v121
    v_cvt_pk_bf16_f32 v119, v122, v123
    v_mfma_f32_32x32x16_bf16 v[140:155], v[84:87], v[108:111], v[140:155]
    s_nop 0
    v_mfma_f32_32x32x16_bf16 v[140:155], v[88:91], v[116:119], v[140:155]
    v_mfma_f32_32x32x16_bf16 v[108:123], v[28:31], v[160:163], 0
    v_mfma_f32_32x32x8bf16_1k v[108:123], v[42:43], v[164:165], v[108:123]
    s_nop 11
    v_sub_f32 v108, v108, v157
    v_sub_f32 v109, v109, v157
    v_sub_f32 v110, v110, v157
    v_sub_f32 v111, v111, v157
    v_sub_f32 v112, v112, v157
    v_sub_f32 v113, v113, v157
    v_sub_f32 v114, v114, v157
    v_sub_f32 v115, v115, v157
    v_sub_f32 v116, v116, v157
    v_sub_f32 v117, v117, v157
    v_sub_f32 v118, v118, v157
    v_sub_f32 v119, v119, v157
    v_sub_f32 v120, v120, v157
    v_sub_f32 v121, v121, v157
    v_sub_f32 v122, v122, v157
    v_sub_f32 v123, v123, v157
    v_exp_f32 v108, v108
    v_exp_f32 v109, v109
    v_exp_f32 v110, v110
    v_exp_f32 v111, v111
    v_exp_f32 v112, v112
    v_exp_f32 v113, v113
    v_exp_f32 v114, v114
    v_exp_f32 v115, v115
    v_exp_f32 v116, v116
    v_exp_f32 v117, v117
    v_exp_f32 v118, v118
    v_exp_f32 v119, v119
    v_exp_f32 v120, v120
    v_exp_f32 v121, v121
    v_exp_f32 v122, v122
    v_exp_f32 v123, v123
    v_cvt_pk_bf16_f32 v108, v108, v109
    v_cvt_pk_bf16_f32 v109, v110, v111
    v_cvt_pk_bf16_f32 v110, v112, v113
    v_cvt_pk_bf16_f32 v111, v114, v115
    v_cvt_pk_bf16_f32 v116, v116, v117
    v_cvt_pk_bf16_f32 v117, v118, v119
    v_cvt_pk_bf16_f32 v118, v120, v121
    v_cvt_pk_bf16_f32 v119, v122, v123
    v_mfma_f32_32x32x16_bf16 v[140:155], v[92:95], v[108:111], v[140:155]
    s_nop 0
    v_mfma_f32_32x32x16_bf16 v[140:155], v[96:99], v[116:119], v[140:155]
    v_mfma_f32_32x32x16_bf16 v[108:123], v[32:35], v[160:163], 0
    v_mfma_f32_32x32x8bf16_1k v[108:123], v[42:43], v[166:167], v[108:123]
    s_nop 11
    v_sub_f32 v108, v108, v157
    v_sub_f32 v109, v109, v157
    v_sub_f32 v110, v110, v157
    v_sub_f32 v111, v111, v157
    v_sub_f32 v112, v112, v157
    v_sub_f32 v113, v113, v157
    v_sub_f32 v114, v114, v157
    v_sub_f32 v115, v115, v157
    v_sub_f32 v116, v116, v157
    v_sub_f32 v117, v117, v157
    v_sub_f32 v118, v118, v157
    v_sub_f32 v119, v119, v157
    v_sub_f32 v120, v120, v157
    v_sub_f32 v121, v121, v157
    v_sub_f32 v122, v122, v157
    v_sub_f32 v123, v123, v157
    v_exp_f32 v108, v108
    v_exp_f32 v109, v109
    v_exp_f32 v110, v110
    v_exp_f32 v111, v111
    v_exp_f32 v112, v112
    v_exp_f32 v113, v113
    v_exp_f32 v114, v114
    v_exp_f32 v115, v115
    v_exp_f32 v116, v116
    v_exp_f32 v117, v117
    v_exp_f32 v118, v118
    v_exp_f32 v119, v119
    v_exp_f32 v120, v120
    v_exp_f32 v121, v121
    v_exp_f32 v122, v122
    v_exp_f32 v123, v123
    v_cvt_pk_bf16_f32 v108, v108, v109
    v_cvt_pk_bf16_f32 v109, v110, v111
    v_cvt_pk_bf16_f32 v110, v112, v113
    v_cvt_pk_bf16_f32 v111, v114, v115
    v_cvt_pk_bf16_f32 v116, v116, v117
    v_cvt_pk_bf16_f32 v117, v118, v119
    v_cvt_pk_bf16_f32 v118, v120, v121
    v_cvt_pk_bf16_f32 v119, v122, v123
    v_mfma_f32_32x32x16_bf16 v[140:155], v[100:103], v[108:111], v[140:155]
    s_nop 0
    v_mfma_f32_32x32x16_bf16 v[140:155], v[104:107], v[116:119], v[140:155]
AT_fb_next:
    s_nop 15
    s_cmp_lt_u32 s29, 8
    s_cbranch_scc1 AT_fb_g
    s_cmp_eq_u32 s57, 0
    s_cbranch_scc0 AT_norm
    v_mov_b32 v0, v157
    s_nop 1
    v_permlane32_swap_b32 v157, v0
    v_max_f32 v157, v157, v0
    s_mov_b32 s57, 1
    s_branch AT_fb_pass
E_w:
    s_waitcnt lgkmcnt(0)
    v_mov_b32 v0, 151608
    ds_read_b32 v0, v0
    s_waitcnt lgkmcnt(0)
    v_readfirstlane_b32 s49, v0
    s_andn2_b32 s49, s25, s49
    s_cbranch_scc0 E_c4
    s_sleep 1
    s_branch E_w
E_c1:
    buffer_load_dwordx4 v[4:7], v1, s[32:35], s21 offen offset:0 sc1
    buffer_load_dwordx2 v[36:37], v2, s[32:35], s22 offen offset:0 sc1
    buffer_load_dwordx4 v[44:47], v3, s[32:35], s23 offen offset:0 sc1
    buffer_load_dwordx4 v[48:51], v3, s[32:35], s23 offen offset:768 sc1
    s_branch E_g1
E_c2:
    buffer_load_dwordx4 v[4:7], v1, s[32:35], s21 offen offset:0 sc1
    buffer_load_dwordx2 v[36:37], v2, s[32:35], s22 offen offset:0 sc1
    buffer_load_dwordx4 v[44:47], v3, s[32:35], s23 offen offset:0 sc1
    buffer_load_dwordx4 v[48:51], v3, s[32:35], s23 offen offset:768 sc1
    buffer_load_dwordx4 v[8:11], v1, s[32:35], s21 offen offset:1024 sc1
    buffer_load_dwordx4 v[52:55], v3, s[32:35], s23 offen offset:1536 sc1
    buffer_load_dwordx4 v[56:59], v3, s[32:35], s23 offen offset:2304 sc1
    s_branch E_g2
E_c3:
    buffer_load_dwordx4 v[4:7], v1, s[32:35], s21 offen offset:0 sc1
    buffer_load_dwordx2 v[36:37], v2, s[32:35], s22 offen offset:0 sc1
    buffer_load_dwordx4 v[44:47], v3, s[32:35], s23 offen offset:0 sc1
    buffer_load_dwordx4 v[48:51], v3, s[32:35], s23 offen offset:768 sc1
    buffer_load_dwordx4 v[8:11], v1, s[32:35], s21 offen offset:1024 sc1
    buffer_load_dwordx4 v[52:55], v3, s[32:35], s23 offen offset:1536 sc1
    buffer_load_dwordx4 v[56:59], v3, s[32:35], s23 offen offset:2304 sc1
    buffer_load_dwordx4 v[12:15], v1, s[32:35], s21 offen offset:2048 sc1
    buffer_load_dwordx2 v[38:39], v2, s[32:35], s22 offen offset:512 sc1
    s_add_u32 s23, s23, 3072
    buffer_load_dwordx4 v[60:63], v3, s[32:35], s23 offen offset:0 sc1
    buffer_load_dwordx4 v[64:67], v3, s[32:35], s23 offen offset:768 sc1
    s_branch E_g3
E_c4:
    buffer_load_dwordx4 v[4:7], v1, s[32:35], s21 offen offset:0 sc1
    buffer_load_dwordx2 v[36:37], v2, s[32:35], s22 offen offset:0 sc1
    buffer_load_dwordx4 v[44:47], v3, s[32:35], s23 offen offset:0 sc1
    buffer_load_dwordx4 v[48:51], v3, s[32:35], s23 offen offset:768 sc1
    buffer_load_dwordx4 v[8:11], v1, s[32:35], s21 offen offset:1024 sc1
    buffer_load_dwordx4 v[52:55], v3, s[32:35], s23 offen offset:1536 sc1
    buffer_load_dwordx4 v[56:59], v3, s[32:35], s23 offen offset:2304 sc1
    buffer_load_dwordx4 v[12:15], v1, s[32:35], s21 offen offset:2048 sc1
    buffer_load_dwordx2 v[38:39], v2, s[32:35], s22 offen offset:512 sc1
    s_add_u32 s23, s23, 3072
    buffer_load_dwordx4 v[60:63], v3, s[32:35], s23 offen offset:0 sc1
    buffer_load_dwordx4 v[64:67], v3, s[32:35], s23 offen offset:768 sc1
    buffer_load_dwordx4 v[16:19], v1, s[32:35], s21 offen offset:3072 sc1
    buffer_load_dwordx4 v[68:71], v3, s[32:35], s23 offen offset:1536 sc1
    buffer_load_dwordx4 v[72:75], v3, s[32:35], s23 offen offset:2304 sc1
    s_branch E_g4
K_cq:
    s_load_dwordx2 s[50:51], s[0:1], 88
    v_lshlrev_b32 v1, 4, v4
    v_lshlrev_b32 v2, 3, v4
    s_lshl_b32 s21, s18, 13
    s_add_u32 s21, s21, 3145728
    s_lshl_b32 s22, s18, 11
    s_add_u32 s22, s22, 3211264
    s_mul_i32 s23, s18, 12288
    s_add_u32 s23, s23, 3276800
    s_lshl_b32 s40, s18, 1
    s_lshl_b32 s25, 3, s40
    s_add_u32 s40, s18, 3
    s_lshl_b32 s40, s40, 1
    s_bfe_u32 s41, s40, 0x10002
    s_and_b32 s40, s40, 3
    s_lshl_b32 s26, s54, 1
    s_add_u32 s41, s41, s26
    s_mul_i32 s41, s41, 40
    s_mul_i32 s26, s55, 5
    s_add_u32 s41, s41, s26
    s_lshl_b32 s41, s41, 10
    s_add_u32 s41, s41, 0
    s_lshl_b32 s26, s40, 10
    s_add_u32 s26, s26, s41
    s_lshl_b32 s27, s40, 8
    s_add_u32 s27, s27, s41
    s_add_u32 s27, s27, 4096
    v_lshrrev_b32 v3, 2, v1
    v_and_b32 v3, 128, v3
    v_and_b32 v0, 256, v1
    v_max_u32 v0, v0, v3
    v_add_u32 v3, v0, v3
    v_and_b32 v0, 0x1f0, v1
    v_cmp_lt_u32 vcc, 320, v0
    v_add_u32 v3, v0, v3
    s_nop 0
    v_cndmask_b32 v3, v3, 2.0, vcc
    v_mov_b32 v164, 0
    v_mov_b32 v165, 0
    v_mov_b32 v166, 0
    v_mov_b32 v167, 0
    s_lshl_b32 s53, s16, 10
    s_add_u32 s53, s53, 3473408
    s_lshl_b32 s52, s17, 8
    s_add_u32 s52, s52, s53
    v_mov_b32 v86, 1
    v_mov_b32 v88, 0x10000
    s_mov_b32 s28, 0xfffe0000
    s_mov_b32 s29, -1
    v_lshlrev_b32 v85, 2, v4
    v_lshlrev_b32 v87, 8, v4
    v_and_b32 v19, 1, v6
    v_lshrrev_b32 v17, 1, v14
    v_lshl_or_b32 v17, v19, 1, v17
    v_xor_b32 v17, s62, v17
    v_lshlrev_b32 v17, 5, v17
    v_lshl_add_u32 v17, v16, 3, v17
    v_add_u32 v17, 65536, v17
    s_mul_i32 s40, s46, 40
    s_add_u32 s40, s40, s62
    s_lshl_b32 s40, s40, 10
    s_waitcnt lgkmcnt(0)
    s_mov_b32 s32, s14
    s_mov_b32 s33, s15
    s_mov_b32 s34, 16777216
    s_mov_b32 s35, 0x00020000
    s_mov_b32 s36, s50
    s_mov_b32 s37, s51
    s_mov_b32 s38, 256
    s_mov_b32 s39, 0x00020000
    s_cmp_eq_u32 s17, 0
    s_cbranch_scc1 K_ca
    s_lshl_b32 s47, s17, 1
    s_add_u32 s47, s47, s62
    s_bitcmp1_b32 135300, s47
    s_cselect_b32 s29, s28, -1
    s_bitcmp1_b32 8456, s47
    s_cselect_b32 s30, s28, -1
    s_bitcmp1_b32 528, s47
    s_cselect_b32 s31, s28, -1
    v_mul_u32_u24 v10, 384, v15
    v_add_u32 v10, v10, v17
    s_mul_i32 s41, s17, 12288
    s_add_u32 s40, s40, s41
    s_sub_u32 s40, s40, 8192
    s_add_u32 s41, s40, 40960
    s_add_u32 s42, s40, 4096
    s_add_u32 s43, s41, 4096
    s_add_u32 s44, s40, 8192
    s_add_u32 s45, s41, 8192
    s_lshl_b32 s47, s17, 2
    s_add_u32 s53, s53, s47
    s_add_u32 s53, s53, 64
    s_mov_b64 s[56:57], 15
    s_barrier
    ds_read_b64_tr_b16 v[36:37], v10 offset:0
    ds_read_b64_tr_b16 v[38:39], v10 offset:1536
    ds_read_b128 v[20:23], v8 offset:0
    ds_read_b128 v[24:27], v8 offset:2048
    ds_read_b128 v[28:31], v8 offset:4096
    ds_read_b128 v[32:35], v8 offset:6144
    ds_read_b64_tr_b16 v[40:41], v10 offset:128
    ds_read_b64_tr_b16 v[42:43], v10 offset:1664
    ds_read_b64_tr_b16 v[44:45], v10 offset:256
    ds_read_b64_tr_b16 v[46:47], v10 offset:1792
    s_cmp_lg_u32 s18, 0
    s_cbranch_scc1 K_cq_n1
    buffer_store_dword v164, v85, s[32:35], s52 offen sc1
K_cq_n1:
    s_waitcnt lgkmcnt(0)
    s_barrier
    v_mfma_f32_16x16x32_bf16 v[92:95], v[36:39], v[20:23], 0
    ds_read_b64_tr_b16 v[68:69], v10 offset:12288
    ds_read_b64_tr_b16 v[70:71], v10 offset:13824
    v_mfma_f32_16x16x32_bf16 v[96:99], v[36:39], v[24:27], 0
    ds_read_b128 v[52:55], v9 offset:0
    ds_read_b128 v[56:59], v9 offset:2048
    v_mfma_f32_16x16x32_bf16 v[100:103], v[36:39], v[28:31], 0
    ds_read_b128 v[60:63], v9 offset:4096
    ds_read_b128 v[64:67], v9 offset:6144
    v_mfma_f32_16x16x32_bf16 v[104:107], v[36:39], v[32:35], 0
    ds_read_b64_tr_b16 v[72:73], v10 offset:12416
    ds_read_b64_tr_b16 v[74:75], v10 offset:13952
    v_mfma_f32_16x16x32_bf16 v[108:111], v[40:43], v[20:23], 0
    ds_read_b64_tr_b16 v[76:77], v10 offset:12544
    ds_read_b64_tr_b16 v[78:79], v10 offset:14080
    v_mfma_f32_16x16x32_bf16 v[112:115], v[40:43], v[24:27], 0
    v_mfma_f32_16x16x32_bf16 v[116:119], v[40:43], v[28:31], 0
    v_mfma_f32_16x16x32_bf16 v[120:123], v[40:43], v[32:35], 0
    v_mfma_f32_16x16x32_bf16 v[124:127], v[44:47], v[20:23], 0
    v_mfma_f32_16x16x32_bf16 v[128:131], v[44:47], v[24:27], 0
    v_mfma_f32_16x16x32_bf16 v[132:135], v[44:47], v[28:31], 0
    v_mfma_f32_16x16x32_bf16 v[136:139], v[44:47], v[32:35], 0
    s_waitcnt lgkmcnt(0)
    s_barrier
    v_mfma_f32_16x16x32_bf16 v[92:95], v[68:71], v[52:55], v[92:95]
    ds_read_b64_tr_b16 v[36:37], v10 offset:24576
    ds_read_b64_tr_b16 v[38:39], v10 offset:26112
    v_mfma_f32_16x16x32_bf16 v[96:99], v[68:71], v[56:59], v[96:99]
    ds_read_b128 v[20:23], v8 offset:16384
    ds_read_b128 v[24:27], v8 offset:18432
    v_mfma_f32_16x16x32_bf16 v[100:103], v[68:71], v[60:63], v[100:103]
    ds_read_b128 v[28:31], v8 offset:20480
    ds_read_b128 v[32:35], v8 offset:22528
    v_mfma_f32_16x16x32_bf16 v[104:107], v[68:71], v[64:67], v[104:107]
    ds_read_b64_tr_b16 v[40:41], v10 offset:24704
    ds_read_b64_tr_b16 v[42:43], v10 offset:26240
    v_mfma_f32_16x16x32_bf16 v[108:111], v[72:75], v[52:55], v[108:111]
    ds_read_b64_tr_b16 v[44:45], v10 offset:24832
    ds_read_b64_tr_b16 v[46:47], v10 offset:26368
    v_mfma_f32_16x16x32_bf16 v[112:115], v[72:75], v[56:59], v[112:115]
    v_mfma_f32_16x16x32_bf16 v[116:119], v[72:75], v[60:63], v[116:119]
    v_mfma_f32_16x16x32_bf16 v[120:123], v[72:75], v[64:67], v[120:123]
    v_mfma_f32_16x16x32_bf16 v[124:127], v[76:79], v[52:55], v[124:127]
    v_mfma_f32_16x16x32_bf16 v[128:131], v[76:79], v[56:59], v[128:131]
    v_mfma_f32_16x16x32_bf16 v[132:135], v[76:79], v[60:63], v[132:135]
    v_mfma_f32_16x16x32_bf16 v[136:139], v[76:79], v[64:67], v[136:139]
    s_waitcnt lgkmcnt(0)
    s_barrier
    v_mfma_f32_16x16x32_bf16 v[92:95], v[36:39], v[20:23], v[92:95]
    ds_read_b64_tr_b16 v[68:69], v10 offset:36864
    ds_read_b64_tr_b16 v[70:71], v10 offset:38400
    v_mfma_f32_16x16x32_bf16 v[96:99], v[36:39], v[24:27], v[96:99]
    ds_read_b128 v[52:55], v9 offset:16384
    ds_read_b128 v[56:59], v9 offset:18432
    v_mfma_f32_16x16x32_bf16 v[100:103], v[36:39], v[28:31], v[100:103]
    ds_read_b128 v[60:63], v9 offset:20480
    ds_read_b128 v[64:67], v9 offset:22528
    v_mfma_f32_16x16x32_bf16 v[104:107], v[36:39], v[32:35], v[104:107]
    ds_read_b64_tr_b16 v[72:73], v10 offset:36992
    ds_read_b64_tr_b16 v[74:75], v10 offset:38528
    v_mfma_f32_16x16x32_bf16 v[108:111], v[40:43], v[20:23], v[108:111]
    ds_read_b64_tr_b16 v[76:77], v10 offset:37120
    ds_read_b64_tr_b16 v[78:79], v10 offset:38656
    s_cmp_lg_u32 s18, 0
    s_cbranch_scc1 K_cq_n2
    s_mov_b64 exec, 1
    s_waitcnt vmcnt(0)
    buffer_atomic_add v86, off, s[36:39], 0 sc1
    s_mov_b64 exec, -1
K_cq_n2:
    v_mfma_f32_16x16x32_bf16 v[112:115], v[40:43], v[24:27], v[112:115]
    v_mfma_f32_16x16x32_bf16 v[116:119], v[40:43], v[28:31], v[116:119]
    v_mfma_f32_16x16x32_bf16 v[120:123], v[40:43], v[32:35], v[120:123]
    v_mfma_f32_16x16x32_bf16 v[124:127], v[44:47], v[20:23], v[124:127]
    v_mfma_f32_16x16x32_bf16 v[128:131], v[44:47], v[24:27], v[128:131]
    v_mfma_f32_16x16x32_bf16 v[132:135], v[44:47], v[28:31], v[132:135]
    v_mfma_f32_16x16x32_bf16 v[136:139], v[44:47], v[32:35], v[136:139]
    s_waitcnt lgkmcnt(0)
    s_barrier
    v_mfma_f32_16x16x32_bf16 v[92:95], v[68:71], v[52:55], v[92:95]
    ds_read_b64_tr_b16 v[36:37], v10 offset:49152
    ds_read_b64_tr_b16 v[38:39], v10 offset:50688
    v_mfma_f32_16x16x32_bf16 v[96:99], v[68:71], v[56:59], v[96:99]
    ds_read_b128 v[20:23], v8 offset:32768
    ds_read_b128 v[24:27], v8 offset:34816
    v_mfma_f32_16x16x32_bf16 v[100:103], v[68:71], v[60:63], v[100:103]
    ds_read_b128 v[28:31], v8 offset:36864
    ds_read_b128 v[32:35], v8 offset:38912
    v_mfma_f32_16x16x32_bf16 v[104:107], v[68:71], v[64:67], v[104:107]
    ds_read_b64_tr_b16 v[40:41], v10 offset:49280
    ds_read_b64_tr_b16 v[42:43], v10 offset:50816
    v_mfma_f32_16x16x32_bf16 v[108:111], v[72:75], v[52:55], v[108:111]
    ds_read_b64_tr_b16 v[44:45], v10 offset:49408
    ds_read_b64_tr_b16 v[46:47], v10 offset:50944
    v_mfma_f32_16x16x32_bf16 v[112:115], v[72:75], v[56:59], v[112:115]
    v_mfma_f32_16x16x32_bf16 v[116:119], v[72:75], v[60:63], v[116:119]
    v_mfma_f32_16x16x32_bf16 v[120:123], v[72:75], v[64:67], v[120:123]
    v_mfma_f32_16x16x32_bf16 v[124:127], v[76:79], v[52:55], v[124:127]
    v_mfma_f32_16x16x32_bf16 v[128:131], v[76:79], v[56:59], v[128:131]
    v_mfma_f32_16x16x32_bf16 v[132:135], v[76:79], v[60:63], v[132:135]
    v_mfma_f32_16x16x32_bf16 v[136:139], v[76:79], v[64:67], v[136:139]
    s_waitcnt lgkmcnt(0)
    s_barrier
    v_mfma_f32_16x16x32_bf16 v[92:95], v[36:39], v[20:23], v[92:95]
    ds_read_b64_tr_b16 v[68:69], v10 offset:0
    ds_read_b64_tr_b16 v[70:71], v10 offset:1536
    v_mfma_f32_16x16x32_bf16 v[96:99], v[36:39], v[24:27], v[96:99]
    ds_read_b128 v[52:55], v9 offset:32768
    ds_read_b128 v[56:59], v9 offset:34816
    v_mfma_f32_16x16x32_bf16 v[100:103], v[36:39], v[28:31], v[100:103]
    ds_read_b128 v[60:63], v9 offset:36864
    ds_read_b128 v[64:67], v9 offset:38912
    v_mfma_f32_16x16x32_bf16 v[104:107], v[36:39], v[32:35], v[104:107]
    ds_read_b64_tr_b16 v[72:73], v10 offset:128
    ds_read_b64_tr_b16 v[74:75], v10 offset:1664
    v_mfma_f32_16x16x32_bf16 v[108:111], v[40:43], v[20:23], v[108:111]
    ds_read_b64_tr_b16 v[76:77], v10 offset:256
    ds_read_b64_tr_b16 v[78:79], v10 offset:1792
    v_mfma_f32_16x16x32_bf16 v[112:115], v[40:43], v[24:27], v[112:115]
    v_mfma_f32_16x16x32_bf16 v[116:119], v[40:43], v[28:31], v[116:119]
    v_mfma_f32_16x16x32_bf16 v[120:123], v[40:43], v[32:35], v[120:123]
    v_mfma_f32_16x16x32_bf16 v[124:127], v[44:47], v[20:23], v[124:127]
    v_mfma_f32_16x16x32_bf16 v[128:131], v[44:47], v[24:27], v[128:131]
    v_mfma_f32_16x16x32_bf16 v[132:135], v[44:47], v[28:31], v[132:135]
    v_mfma_f32_16x16x32_bf16 v[136:139], v[44:47], v[32:35], v[136:139]
    s_waitcnt lgkmcnt(0)
    s_barrier
    v_mfma_f32_16x16x32_bf16 v[92:95], v[68:71], v[52:55], v[92:95]
    ds_read_b64_tr_b16 v[36:37], v10 offset:12288
    ds_read_b64_tr_b16 v[38:39], v10 offset:13824
    v_mfma_f32_16x16x32_bf16 v[96:99], v[68:71], v[56:59], v[96:99]
    ds_read_b128 v[20:23], v8 offset:49152
    ds_read_b128 v[24:27], v8 offset:51200
    v_mfma_f32_16x16x32_bf16 v[100:103], v[68:71], v[60:63], v[100:103]
    ds_read_b128 v[28:31], v8 offset:53248
    ds_read_b128 v[32:35], v8 offset:55296
    v_mfma_f32_16x16x32_bf16 v[104:107], v[68:71], v[64:67], v[104:107]
    ds_read_b64_tr_b16 v[40:41], v10 offset:12416
    ds_read_b64_tr_b16 v[42:43], v10 offset:13952
    v_mfma_f32_16x16x32_bf16 v[108:111], v[72:75], v[52:55], v[108:111]
    ds_read_b64_tr_b16 v[44:45], v10 offset:12544
    ds_read_b64_tr_b16 v[46:47], v10 offset:14080
    v_mfma_f32_16x16x32_bf16 v[112:115], v[72:75], v[56:59], v[112:115]
    v_mfma_f32_16x16x32_bf16 v[116:119], v[72:75], v[60:63], v[116:119]
    v_mfma_f32_16x16x32_bf16 v[120:123], v[72:75], v[64:67], v[120:123]
    v_mfma_f32_16x16x32_bf16 v[124:127], v[76:79], v[52:55], v[124:127]
    v_mfma_f32_16x16x32_bf16 v[128:131], v[76:79], v[56:59], v[128:131]
    v_mfma_f32_16x16x32_bf16 v[132:135], v[76:79], v[60:63], v[132:135]
    v_mfma_f32_16x16x32_bf16 v[136:139], v[76:79], v[64:67], v[136:139]
    s_waitcnt lgkmcnt(0)
    s_barrier
    v_mfma_f32_16x16x32_bf16 v[92:95], v[36:39], v[20:23], v[92:95]
    ds_read_b64_tr_b16 v[68:69], v10 offset:24576
    ds_read_b64_tr_b16 v[70:71], v10 offset:26112
    v_mfma_f32_16x16x32_bf16 v[96:99], v[36:39], v[24:27], v[96:99]
    ds_read_b128 v[52:55], v9 offset:49152
    ds_read_b128 v[56:59], v9 offset:51200
    v_mfma_f32_16x16x32_bf16 v[100:103], v[36:39], v[28:31], v[100:103]
    ds_read_b128 v[60:63], v9 offset:53248
    ds_read_b128 v[64:67], v9 offset:55296
    v_mfma_f32_16x16x32_bf16 v[104:107], v[36:39], v[32:35], v[104:107]
    ds_read_b64_tr_b16 v[72:73], v10 offset:24704
    ds_read_b64_tr_b16 v[74:75], v10 offset:26240
    v_mfma_f32_16x16x32_bf16 v[108:111], v[40:43], v[20:23], v[108:111]
    ds_read_b64_tr_b16 v[76:77], v10 offset:24832
    ds_read_b64_tr_b16 v[78:79], v10 offset:26368
    v_mfma_f32_16x16x32_bf16 v[112:115], v[40:43], v[24:27], v[112:115]
    v_mfma_f32_16x16x32_bf16 v[116:119], v[40:43], v[28:31], v[116:119]
    v_mfma_f32_16x16x32_bf16 v[120:123], v[40:43], v[32:35], v[120:123]
    v_mfma_f32_16x16x32_bf16 v[124:127], v[44:47], v[20:23], v[124:127]
    v_mfma_f32_16x16x32_bf16 v[128:131], v[44:47], v[24:27], v[128:131]
    v_mfma_f32_16x16x32_bf16 v[132:135], v[44:47], v[28:31], v[132:135]
    v_mfma_f32_16x16x32_bf16 v[136:139], v[44:47], v[32:35], v[136:139]
    s_waitcnt lgkmcnt(0)
    s_barrier
    v_mfma_f32_16x16x32_bf16 v[92:95], v[68:71], v[52:55], v[92:95]
    ds_read_b64_tr_b16 v[36:37], v10 offset:36864
    ds_read_b64_tr_b16 v[38:39], v10 offset:38400
    v_mfma_f32_16x16x32_bf16 v[96:99], v[68:71], v[56:59], v[96:99]
    ds_read_b128 v[20:23], v8 offset:0
    ds_read_b128 v[24:27], v8 offset:2048
    v_mfma_f32_16x16x32_bf16 v[100:103], v[68:71], v[60:63], v[100:103]
    ds_read_b128 v[28:31], v8 offset:4096
    ds_read_b128 v[32:35], v8 offset:6144
    v_mfma_f32_16x16x32_bf16 v[104:107], v[68:71], v[64:67], v[104:107]
    ds_read_b64_tr_b16 v[40:41], v10 offset:36992
    ds_read_b64_tr_b16 v[42:43], v10 offset:38528
    v_mfma_f32_16x16x32_bf16 v[108:111], v[72:75], v[52:55], v[108:111]
    ds_read_b64_tr_b16 v[44:45], v10 offset:37120
    ds_read_b64_tr_b16 v[46:47], v10 offset:38656
    v_mfma_f32_16x16x32_bf16 v[112:115], v[72:75], v[56:59], v[112:115]
    v_mfma_f32_16x16x32_bf16 v[116:119], v[72:75], v[60:63], v[116:119]
    v_mfma_f32_16x16x32_bf16 v[120:123], v[72:75], v[64:67], v[120:123]
    v_mfma_f32_16x16x32_bf16 v[124:127], v[76:79], v[52:55], v[124:127]
    v_mfma_f32_16x16x32_bf16 v[128:131], v[76:79], v[56:59], v[128:131]
    v_mfma_f32_16x16x32_bf16 v[132:135], v[76:79], v[60:63], v[132:135]
    v_mfma_f32_16x16x32_bf16 v[136:139], v[76:79], v[64:67], v[136:139]
    s_waitcnt lgkmcnt(0)
    s_barrier
    v_mfma_f32_16x16x32_bf16 v[92:95], v[36:39], v[20:23], v[92:95]
    ds_read_b64_tr_b16 v[68:69], v10 offset:49152
    ds_read_b64_tr_b16 v[70:71], v10 offset:50688
    v_mfma_f32_16x16x32_bf16 v[96:99], v[36:39], v[24:27], v[96:99]
    ds_read_b128 v[52:55], v9 offset:0
    ds_read_b128 v[56:59], v9 offset:2048
    v_mfma_f32_16x16x32_bf16 v[100:103], v[36:39], v[28:31], v[100:103]
    ds_read_b128 v[60:63], v9 offset:4096
    ds_read_b128 v[64:67], v9 offset:6144
    v_mfma_f32_16x16x32_bf16 v[104:107], v[36:39], v[32:35], v[104:107]
    ds_read_b64_tr_b16 v[72:73], v10 offset:49280
    ds_read_b64_tr_b16 v[74:75], v10 offset:50816
    v_mfma_f32_16x16x32_bf16 v[108:111], v[40:43], v[20:23], v[108:111]
    ds_read_b64_tr_b16 v[76:77], v10 offset:49408
    ds_read_b64_tr_b16 v[78:79], v10 offset:50944
    v_mfma_f32_16x16x32_bf16 v[112:115], v[40:43], v[24:27], v[112:115]
    v_mfma_f32_16x16x32_bf16 v[116:119], v[40:43], v[28:31], v[116:119]
    v_mfma_f32_16x16x32_bf16 v[120:123], v[40:43], v[32:35], v[120:123]
    v_mfma_f32_16x16x32_bf16 v[124:127], v[44:47], v[20:23], v[124:127]
    v_mfma_f32_16x16x32_bf16 v[128:131], v[44:47], v[24:27], v[128:131]
    v_mfma_f32_16x16x32_bf16 v[132:135], v[44:47], v[28:31], v[132:135]
    v_mfma_f32_16x16x32_bf16 v[136:139], v[44:47], v[32:35], v[136:139]
    s_waitcnt lgkmcnt(0)
    s_barrier
    v_mfma_f32_16x16x32_bf16 v[92:95], v[68:71], v[52:55], v[92:95]
    ds_read_b64_tr_b16 v[36:37], v10 offset:0
    ds_read_b64_tr_b16 v[38:39], v10 offset:1536
    v_mfma_f32_16x16x32_bf16 v[96:99], v[68:71], v[56:59], v[96:99]
    ds_read_b128 v[20:23], v8 offset:16384
    ds_read_b128 v[24:27], v8 offset:18432
    v_mfma_f32_16x16x32_bf16 v[100:103], v[68:71], v[60:63], v[100:103]
    ds_read_b128 v[28:31], v8 offset:20480
    ds_read_b128 v[32:35], v8 offset:22528
    v_mfma_f32_16x16x32_bf16 v[104:107], v[68:71], v[64:67], v[104:107]
    ds_read_b64_tr_b16 v[40:41], v10 offset:128
    ds_read_b64_tr_b16 v[42:43], v10 offset:1664
    v_mfma_f32_16x16x32_bf16 v[108:111], v[72:75], v[52:55], v[108:111]
    ds_read_b64_tr_b16 v[44:45], v10 offset:256
    ds_read_b64_tr_b16 v[46:47], v10 offset:1792
    v_mfma_f32_16x16x32_bf16 v[112:115], v[72:75], v[56:59], v[112:115]
    v_mfma_f32_16x16x32_bf16 v[116:119], v[72:75], v[60:63], v[116:119]
    v_mfma_f32_16x16x32_bf16 v[120:123], v[72:75], v[64:67], v[120:123]
    v_mfma_f32_16x16x32_bf16 v[124:127], v[76:79], v[52:55], v[124:127]
    v_mfma_f32_16x16x32_bf16 v[128:131], v[76:79], v[56:59], v[128:131]
    v_mfma_f32_16x16x32_bf16 v[132:135], v[76:79], v[60:63], v[132:135]
    v_mfma_f32_16x16x32_bf16 v[136:139], v[76:79], v[64:67], v[136:139]
    s_waitcnt lgkmcnt(0)
    s_barrier
    v_mfma_f32_16x16x32_bf16 v[92:95], v[36:39], v[20:23], v[92:95]
    ds_read_b64_tr_b16 v[68:69], v10 offset:12288
    ds_read_b64_tr_b16 v[70:71], v10 offset:13824
    v_mfma_f32_16x16x32_bf16 v[96:99], v[36:39], v[24:27], v[96:99]
    ds_read_b128 v[52:55], v9 offset:16384
    ds_read_b128 v[56:59], v9 offset:18432
    v_mfma_f32_16x16x32_bf16 v[100:103], v[36:39], v[28:31], v[100:103]
    ds_read_b128 v[60:63], v9 offset:20480
    ds_read_b128 v[64:67], v9 offset:22528
    v_mfma_f32_16x16x32_bf16 v[104:107], v[36:39], v[32:35], v[104:107]
    ds_read_b64_tr_b16 v[72:73], v10 offset:12416
    ds_read_b64_tr_b16 v[74:75], v10 offset:13952
    v_mfma_f32_16x16x32_bf16 v[108:111], v[40:43], v[20:23], v[108:111]
    ds_read_b64_tr_b16 v[76:77], v10 offset:12544
    ds_read_b64_tr_b16 v[78:79], v10 offset:14080
    v_mfma_f32_16x16x32_bf16 v[112:115], v[40:43], v[24:27], v[112:115]
    v_mfma_f32_16x16x32_bf16 v[116:119], v[40:43], v[28:31], v[116:119]
    v_mfma_f32_16x16x32_bf16 v[120:123], v[40:43], v[32:35], v[120:123]
    v_mfma_f32_16x16x32_bf16 v[124:127], v[44:47], v[20:23], v[124:127]
    v_mfma_f32_16x16x32_bf16 v[128:131], v[44:47], v[24:27], v[128:131]
    v_mfma_f32_16x16x32_bf16 v[132:135], v[44:47], v[28:31], v[132:135]
    v_mfma_f32_16x16x32_bf16 v[136:139], v[44:47], v[32:35], v[136:139]
    s_waitcnt lgkmcnt(0)
    s_barrier
    v_mfma_f32_16x16x32_bf16 v[92:95], v[68:71], v[52:55], v[92:95]
    ds_read_b64_tr_b16 v[36:37], v10 offset:24576
    ds_read_b64_tr_b16 v[38:39], v10 offset:26112
    v_mfma_f32_16x16x32_bf16 v[96:99], v[68:71], v[56:59], v[96:99]
    ds_read_b128 v[20:23], v8 offset:32768
    ds_read_b128 v[24:27], v8 offset:34816
    v_mfma_f32_16x16x32_bf16 v[100:103], v[68:71], v[60:63], v[100:103]
    ds_read_b128 v[28:31], v8 offset:36864
    ds_read_b128 v[32:35], v8 offset:38912
    v_mfma_f32_16x16x32_bf16 v[104:107], v[68:71], v[64:67], v[104:107]
    ds_read_b64_tr_b16 v[40:41], v10 offset:24704
    ds_read_b64_tr_b16 v[42:43], v10 offset:26240
    v_mfma_f32_16x16x32_bf16 v[108:111], v[72:75], v[52:55], v[108:111]
    ds_read_b64_tr_b16 v[44:45], v10 offset:24832
    ds_read_b64_tr_b16 v[46:47], v10 offset:26368
    v_mfma_f32_16x16x32_bf16 v[112:115], v[72:75], v[56:59], v[112:115]
    v_mfma_f32_16x16x32_bf16 v[116:119], v[72:75], v[60:63], v[116:119]
    v_mfma_f32_16x16x32_bf16 v[120:123], v[72:75], v[64:67], v[120:123]
    v_mfma_f32_16x16x32_bf16 v[124:127], v[76:79], v[52:55], v[124:127]
    v_mfma_f32_16x16x32_bf16 v[128:131], v[76:79], v[56:59], v[128:131]
    v_mfma_f32_16x16x32_bf16 v[132:135], v[76:79], v[60:63], v[132:135]
    v_mfma_f32_16x16x32_bf16 v[136:139], v[76:79], v[64:67], v[136:139]
    s_waitcnt lgkmcnt(0)
    s_barrier
    v_mfma_f32_16x16x32_bf16 v[92:95], v[36:39], v[20:23], v[92:95]
    ds_read_b64_tr_b16 v[68:69], v10 offset:36864
    ds_read_b64_tr_b16 v[70:71], v10 offset:38400
    v_mfma_f32_16x16x32_bf16 v[96:99], v[36:39], v[24:27], v[96:99]
    ds_read_b128 v[52:55], v9 offset:32768
    ds_read_b128 v[56:59], v9 offset:34816
    v_mfma_f32_16x16x32_bf16 v[100:103], v[36:39], v[28:31], v[100:103]
    ds_read_b128 v[60:63], v9 offset:36864
    ds_read_b128 v[64:67], v9 offset:38912
    v_mfma_f32_16x16x32_bf16 v[104:107], v[36:39], v[32:35], v[104:107]
    ds_read_b64_tr_b16 v[72:73], v10 offset:36992
    ds_read_b64_tr_b16 v[74:75], v10 offset:38528
    v_mfma_f32_16x16x32_bf16 v[108:111], v[40:43], v[20:23], v[108:111]
    ds_read_b64_tr_b16 v[76:77], v10 offset:37120
    ds_read_b64_tr_b16 v[78:79], v10 offset:38656
    v_mfma_f32_16x16x32_bf16 v[112:115], v[40:43], v[24:27], v[112:115]
    v_mfma_f32_16x16x32_bf16 v[116:119], v[40:43], v[28:31], v[116:119]
    v_mfma_f32_16x16x32_bf16 v[120:123], v[40:43], v[32:35], v[120:123]
    v_mfma_f32_16x16x32_bf16 v[124:127], v[44:47], v[20:23], v[124:127]
    v_mfma_f32_16x16x32_bf16 v[128:131], v[44:47], v[24:27], v[128:131]
    v_mfma_f32_16x16x32_bf16 v[132:135], v[44:47], v[28:31], v[132:135]
    v_mfma_f32_16x16x32_bf16 v[136:139], v[44:47], v[32:35], v[136:139]
    s_waitcnt lgkmcnt(0)
    s_barrier
    v_mfma_f32_16x16x32_bf16 v[92:95], v[68:71], v[52:55], v[92:95]
    ds_read_b64_tr_b16 v[36:37], v10 offset:49152
    ds_read_b64_tr_b16 v[38:39], v10 offset:50688
    v_mfma_f32_16x16x32_bf16 v[96:99], v[68:71], v[56:59], v[96:99]
    ds_read_b128 v[20:23], v8 offset:49152
    ds_read_b128 v[24:27], v8 offset:51200
    v_mfma_f32_16x16x32_bf16 v[100:103], v[68:71], v[60:63], v[100:103]
    ds_read_b128 v[28:31], v8 offset:53248
    ds_read_b128 v[32:35], v8 offset:55296
    v_mfma_f32_16x16x32_bf16 v[104:107], v[68:71], v[64:67], v[104:107]
    ds_read_b64_tr_b16 v[40:41], v10 offset:49280
    ds_read_b64_tr_b16 v[42:43], v10 offset:50816
    v_mfma_f32_16x16x32_bf16 v[108:111], v[72:75], v[52:55], v[108:111]
    ds_read_b64_tr_b16 v[44:45], v10 offset:49408
    ds_read_b64_tr_b16 v[46:47], v10 offset:50944
    v_mfma_f32_16x16x32_bf16 v[112:115], v[72:75], v[56:59], v[112:115]
    v_mfma_f32_16x16x32_bf16 v[116:119], v[72:75], v[60:63], v[116:119]
    v_mfma_f32_16x16x32_bf16 v[120:123], v[72:75], v[64:67], v[120:123]
    v_mfma_f32_16x16x32_bf16 v[124:127], v[76:79], v[52:55], v[124:127]
    v_mfma_f32_16x16x32_bf16 v[128:131], v[76:79], v[56:59], v[128:131]
    v_mfma_f32_16x16x32_bf16 v[132:135], v[76:79], v[60:63], v[132:135]
    v_mfma_f32_16x16x32_bf16 v[136:139], v[76:79], v[64:67], v[136:139]
    s_waitcnt lgkmcnt(0)
    s_barrier
    v_mfma_f32_16x16x32_bf16 v[92:95], v[36:39], v[20:23], v[92:95]
    ds_read_b64_tr_b16 v[68:69], v10 offset:0
    ds_read_b64_tr_b16 v[70:71], v10 offset:1536
    v_mfma_f32_16x16x32_bf16 v[96:99], v[36:39], v[24:27], v[96:99]
    ds_read_b128 v[52:55], v9 offset:49152
    ds_read_b128 v[56:59], v9 offset:51200
    v_mfma_f32_16x16x32_bf16 v[100:103], v[36:39], v[28:31], v[100:103]
    ds_read_b128 v[60:63], v9 offset:53248
    ds_read_b128 v[64:67], v9 offset:55296
    v_mfma_f32_16x16x32_bf16 v[104:107], v[36:39], v[32:35], v[104:107]
    ds_read_b64_tr_b16 v[72:73], v10 offset:128
    ds_read_b64_tr_b16 v[74:75], v10 offset:1664
    v_mfma_f32_16x16x32_bf16 v[108:111], v[40:43], v[20:23], v[108:111]
    ds_read_b64_tr_b16 v[76:77], v10 offset:256
    ds_read_b64_tr_b16 v[78:79], v10 offset:1792
    v_mfma_f32_16x16x32_bf16 v[112:115], v[40:43], v[24:27], v[112:115]
    v_mfma_f32_16x16x32_bf16 v[116:119], v[40:43], v[28:31], v[116:119]
    v_mfma_f32_16x16x32_bf16 v[120:123], v[40:43], v[32:35], v[120:123]
    v_mfma_f32_16x16x32_bf16 v[124:127], v[44:47], v[20:23], v[124:127]
    v_mfma_f32_16x16x32_bf16 v[128:131], v[44:47], v[24:27], v[128:131]
    v_mfma_f32_16x16x32_bf16 v[132:135], v[44:47], v[28:31], v[132:135]
    v_mfma_f32_16x16x32_bf16 v[136:139], v[44:47], v[32:35], v[136:139]
    s_waitcnt lgkmcnt(0)
    s_barrier
    v_mfma_f32_16x16x32_bf16 v[92:95], v[68:71], v[52:55], v[92:95]
    ds_read_b64_tr_b16 v[36:37], v10 offset:12288
    ds_read_b64_tr_b16 v[38:39], v10 offset:13824
    v_mfma_f32_16x16x32_bf16 v[96:99], v[68:71], v[56:59], v[96:99]
    ds_read_b128 v[20:23], v8 offset:0
    ds_read_b128 v[24:27], v8 offset:2048
    v_mfma_f32_16x16x32_bf16 v[100:103], v[68:71], v[60:63], v[100:103]
    ds_read_b128 v[28:31], v8 offset:4096
    ds_read_b128 v[32:35], v8 offset:6144
    v_mfma_f32_16x16x32_bf16 v[104:107], v[68:71], v[64:67], v[104:107]
    ds_read_b64_tr_b16 v[40:41], v10 offset:12416
    ds_read_b64_tr_b16 v[42:43], v10 offset:13952
    v_mfma_f32_16x16x32_bf16 v[108:111], v[72:75], v[52:55], v[108:111]
    ds_read_b64_tr_b16 v[44:45], v10 offset:12544
    ds_read_b64_tr_b16 v[46:47], v10 offset:14080
    v_mfma_f32_16x16x32_bf16 v[112:115], v[72:75], v[56:59], v[112:115]
    v_mfma_f32_16x16x32_bf16 v[116:119], v[72:75], v[60:63], v[116:119]
    v_mfma_f32_16x16x32_bf16 v[120:123], v[72:75], v[64:67], v[120:123]
    v_mfma_f32_16x16x32_bf16 v[124:127], v[76:79], v[52:55], v[124:127]
    v_mfma_f32_16x16x32_bf16 v[128:131], v[76:79], v[56:59], v[128:131]
    v_mfma_f32_16x16x32_bf16 v[132:135], v[76:79], v[60:63], v[132:135]
    v_mfma_f32_16x16x32_bf16 v[136:139], v[76:79], v[64:67], v[136:139]
    s_waitcnt lgkmcnt(0)
    s_barrier
    v_mfma_f32_16x16x32_bf16 v[92:95], v[36:39], v[20:23], v[92:95]
    ds_read_b64_tr_b16 v[68:69], v10 offset:24576
    ds_read_b64_tr_b16 v[70:71], v10 offset:26112
    v_mfma_f32_16x16x32_bf16 v[96:99], v[36:39], v[24:27], v[96:99]
    ds_read_b128 v[52:55], v9 offset:0
    ds_read_b128 v[56:59], v9 offset:2048
    v_mfma_f32_16x16x32_bf16 v[100:103], v[36:39], v[28:31], v[100:103]
    ds_read_b128 v[60:63], v9 offset:4096
    ds_read_b128 v[64:67], v9 offset:6144
    v_mfma_f32_16x16x32_bf16 v[104:107], v[36:39], v[32:35], v[104:107]
    ds_read_b64_tr_b16 v[72:73], v10 offset:24704
    ds_read_b64_tr_b16 v[74:75], v10 offset:26240
    v_mfma_f32_16x16x32_bf16 v[108:111], v[40:43], v[20:23], v[108:111]
    ds_read_b64_tr_b16 v[76:77], v10 offset:24832
    ds_read_b64_tr_b16 v[78:79], v10 offset:26368
    v_mfma_f32_16x16x32_bf16 v[112:115], v[40:43], v[24:27], v[112:115]
    v_mfma_f32_16x16x32_bf16 v[116:119], v[40:43], v[28:31], v[116:119]
    v_mfma_f32_16x16x32_bf16 v[120:123], v[40:43], v[32:35], v[120:123]
    v_mfma_f32_16x16x32_bf16 v[124:127], v[44:47], v[20:23], v[124:127]
    v_mfma_f32_16x16x32_bf16 v[128:131], v[44:47], v[24:27], v[128:131]
    v_mfma_f32_16x16x32_bf16 v[132:135], v[44:47], v[28:31], v[132:135]
    v_mfma_f32_16x16x32_bf16 v[136:139], v[44:47], v[32:35], v[136:139]
    s_waitcnt lgkmcnt(0)
    s_barrier
    v_mfma_f32_16x16x32_bf16 v[92:95], v[68:71], v[52:55], v[92:95]
    ds_read_b64_tr_b16 v[36:37], v10 offset:36864
    ds_read_b64_tr_b16 v[38:39], v10 offset:38400
    v_mfma_f32_16x16x32_bf16 v[96:99], v[68:71], v[56:59], v[96:99]
    ds_read_b128 v[20:23], v8 offset:16384
    ds_read_b128 v[24:27], v8 offset:18432
    v_mfma_f32_16x16x32_bf16 v[100:103], v[68:71], v[60:63], v[100:103]
    ds_read_b128 v[28:31], v8 offset:20480
    ds_read_b128 v[32:35], v8 offset:22528
    v_mfma_f32_16x16x32_bf16 v[104:107], v[68:71], v[64:67], v[104:107]
    ds_read_b64_tr_b16 v[40:41], v10 offset:36992
    ds_read_b64_tr_b16 v[42:43], v10 offset:38528
    v_mfma_f32_16x16x32_bf16 v[108:111], v[72:75], v[52:55], v[108:111]
    ds_read_b64_tr_b16 v[44:45], v10 offset:37120
    ds_read_b64_tr_b16 v[46:47], v10 offset:38656
    v_mfma_f32_16x16x32_bf16 v[112:115], v[72:75], v[56:59], v[112:115]
    v_mfma_f32_16x16x32_bf16 v[116:119], v[72:75], v[60:63], v[116:119]
    v_mfma_f32_16x16x32_bf16 v[120:123], v[72:75], v[64:67], v[120:123]
    v_mfma_f32_16x16x32_bf16 v[124:127], v[76:79], v[52:55], v[124:127]
    v_mfma_f32_16x16x32_bf16 v[128:131], v[76:79], v[56:59], v[128:131]
    v_mfma_f32_16x16x32_bf16 v[132:135], v[76:79], v[60:63], v[132:135]
    v_mfma_f32_16x16x32_bf16 v[136:139], v[76:79], v[64:67], v[136:139]
    s_waitcnt lgkmcnt(0)
    s_barrier
    v_mfma_f32_16x16x32_bf16 v[92:95], v[36:39], v[20:23], v[92:95]
    ds_read_b64_tr_b16 v[68:69], v10 offset:49152
    ds_read_b64_tr_b16 v[70:71], v10 offset:50688
    v_mfma_f32_16x16x32_bf16 v[96:99], v[36:39], v[24:27], v[96:99]
    ds_read_b128 v[52:55], v9 offset:16384
    ds_read_b128 v[56:59], v9 offset:18432
    v_mfma_f32_16x16x32_bf16 v[100:103], v[36:39], v[28:31], v[100:103]
    ds_read_b128 v[60:63], v9 offset:20480
    ds_read_b128 v[64:67], v9 offset:22528
    v_mfma_f32_16x16x32_bf16 v[104:107], v[36:39], v[32:35], v[104:107]
    ds_read_b64_tr_b16 v[72:73], v10 offset:49280
    ds_read_b64_tr_b16 v[74:75], v10 offset:50816
    v_mfma_f32_16x16x32_bf16 v[108:111], v[40:43], v[20:23], v[108:111]
    ds_read_b64_tr_b16 v[76:77], v10 offset:49408
    ds_read_b64_tr_b16 v[78:79], v10 offset:50944
    v_mfma_f32_16x16x32_bf16 v[112:115], v[40:43], v[24:27], v[112:115]
    v_mfma_f32_16x16x32_bf16 v[116:119], v[40:43], v[28:31], v[116:119]
    v_mfma_f32_16x16x32_bf16 v[120:123], v[40:43], v[32:35], v[120:123]
    v_mfma_f32_16x16x32_bf16 v[124:127], v[44:47], v[20:23], v[124:127]
    v_mfma_f32_16x16x32_bf16 v[128:131], v[44:47], v[24:27], v[128:131]
    v_mfma_f32_16x16x32_bf16 v[132:135], v[44:47], v[28:31], v[132:135]
    v_mfma_f32_16x16x32_bf16 v[136:139], v[44:47], v[32:35], v[136:139]
    s_waitcnt lgkmcnt(0)
    v_mfma_f32_16x16x32_bf16 v[92:95], v[68:71], v[52:55], v[92:95]
    v_mfma_f32_16x16x32_bf16 v[96:99], v[68:71], v[56:59], v[96:99]
    v_mfma_f32_16x16x32_bf16 v[100:103], v[68:71], v[60:63], v[100:103]
    v_mfma_f32_16x16x32_bf16 v[104:107], v[68:71], v[64:67], v[104:107]
    v_mfma_f32_16x16x32_bf16 v[108:111], v[72:75], v[52:55], v[108:111]
    v_mfma_f32_16x16x32_bf16 v[112:115], v[72:75], v[56:59], v[112:115]
    v_mfma_f32_16x16x32_bf16 v[116:119], v[72:75], v[60:63], v[116:119]
    v_mfma_f32_16x16x32_bf16 v[120:123], v[72:75], v[64:67], v[120:123]
    s_nop 0
    v_bfi_b32 v92, s28, v92, v88
    v_bfi_b32 v96, s29, v96, v88
    v_cvt_pk_bf16_f32 v21, v94, v95
    v_cvt_pk_bf16_f32 v23, v98, v99
    v_cvt_pk_bf16_f32 v20, v92, v93
    v_cvt_pk_bf16_f32 v22, v96, v97
    buffer_store_dwordx4 v[20:23], v1, s[32:35], s40 offen sc1
    v_bfi_b32 v100, s28, v100, v88
    v_bfi_b32 v104, s29, v104, v88
    v_cvt_pk_bf16_f32 v25, v102, v103
    v_cvt_pk_bf16_f32 v27, v106, v107
    v_cvt_pk_bf16_f32 v24, v100, v101
    v_cvt_pk_bf16_f32 v26, v104, v105
    buffer_store_dwordx4 v[24:27], v1, s[32:35], s41 offen sc1
    v_mfma_f32_16x16x32_bf16 v[124:127], v[76:79], v[52:55], v[124:127]
    v_mfma_f32_16x16x32_bf16 v[128:131], v[76:79], v[56:59], v[128:131]
    v_mfma_f32_16x16x32_bf16 v[132:135], v[76:79], v[60:63], v[132:135]
    v_mfma_f32_16x16x32_bf16 v[136:139], v[76:79], v[64:67], v[136:139]
    v_bfi_b32 v108, s28, v108, v88
    v_bfi_b32 v112, s30, v112, v88
    v_cvt_pk_bf16_f32 v29, v110, v111
    v_cvt_pk_bf16_f32 v31, v114, v115
    v_cvt_pk_bf16_f32 v28, v108, v109
    v_cvt_pk_bf16_f32 v30, v112, v113
    buffer_store_dwordx4 v[28:31], v1, s[32:35], s42 offen sc1
    v_bfi_b32 v116, s28, v116, v88
    v_bfi_b32 v120, s30, v120, v88
    v_cvt_pk_bf16_f32 v33, v118, v119
    v_cvt_pk_bf16_f32 v35, v122, v123
    v_cvt_pk_bf16_f32 v32, v116, v117
    v_cvt_pk_bf16_f32 v34, v120, v121
    buffer_store_dwordx4 v[32:35], v1, s[32:35], s43 offen sc1
    v_bfi_b32 v124, s28, v124, v88
    v_bfi_b32 v128, s31, v128, v88
    v_cvt_pk_bf16_f32 v37, v126, v127
    v_cvt_pk_bf16_f32 v39, v130, v131
    v_cvt_pk_bf16_f32 v36, v124, v125
    v_cvt_pk_bf16_f32 v38, v128, v129
    buffer_store_dwordx4 v[36:39], v1, s[32:35], s44 offen sc1
    v_bfi_b32 v132, s28, v132, v88
    v_bfi_b32 v136, s31, v136, v88
    v_cvt_pk_bf16_f32 v41, v134, v135
    v_cvt_pk_bf16_f32 v43, v138, v139
    v_cvt_pk_bf16_f32 v40, v132, v133
    v_cvt_pk_bf16_f32 v42, v136, v137
    buffer_store_dwordx4 v[40:43], v1, s[32:35], s45 offen sc1
K_cq_e:
    v_mov_b32 v17, 151616
    s_mov_b64 exec, 1
    s_waitcnt vmcnt(0)
    ds_add_rtn_u32 v18, v17, v86
    s_mov_b64 exec, s[56:57]
    s_waitcnt lgkmcnt(0)
    v_readfirstlane_b32 s48, v18
    s_cmp_eq_u32 s48, 7
    s_cbranch_scc0 K_cq_end
    buffer_store_dword v86, v87, s[32:35], s53 offen sc1
K_cq_end:
    s_mov_b64 exec, -1
    s_branch E_w
K_ca:
    v_lshl_add_u32 v10, v15, 7, v17
    s_add_u32 s41, s40, 40960
    s_lshr_b32 s42, s62, 1
    s_mul_i32 s42, s42, 1280
    s_add_u32 s42, s42, 69632
    s_bitcmp1_b32 s62, 0
    s_cselect_b64 vcc, -1, 0
    v_cndmask_b32 v17, v16, 4, vcc
    v_lshl_add_u32 v17, v17, 3, s42
    v_mad_u32_u24 v11, v15, 40, v17
    v_lshlrev_b32 v12, 4, v6
    v_add_u32 v12, 98816, v12
    s_lshl_b32 s53, s16, 2
    s_add_u32 s53, s53, 3473408
    s_mov_b64 s[56:57], -1
    s_cmp_ge_u32 s62, 2
    s_cbranch_scc1 K_cv
    v_and_b32 v84, 0x27, v4
    v_lshl_or_b32 v84, v19, 3, v84
    v_and_b32 v17, 8, v4
    v_lshl_or_b32 v84, v17, 1, v84
    s_sub_u32 s44, 4, s62
    v_lshlrev_b32 v84, s44, v84
    s_lshl_b32 s44, s46, 10
    s_add_u32 s44, s44, 3145728
    s_lshl_b32 s43, s46, 8
    s_add_u32 s43, s43, 3211264
    s_lshl_b32 s45, s46, 7
    s_add_u32 s45, s45, 3407872
    s_mov_b32 s47, 0x3ea52b5c
    s_barrier
    ds_read_b64_tr_b16 v[36:37], v10 offset:0
    ds_read_b64_tr_b16 v[38:39], v10 offset:512
    ds_read_b128 v[20:23], v8 offset:0
    ds_read_b128 v[24:27], v8 offset:2048
    ds_read_b128 v[28:31], v8 offset:4096
    ds_read_b128 v[32:35], v8 offset:6144
    ds_read_b64_tr_b16 v[40:41], v11 offset:0
    ds_read_b64_tr_b16 v[42:43], v11 offset:160
    ds_read_b128 v[44:47], v12 offset:0
    s_cmp_lg_u32 s18, 0
    s_cbranch_scc1 K_cq_n3
    buffer_store_dword v164, v85, s[32:35], s52 offen sc1
K_cq_n3:
    s_waitcnt lgkmcnt(0)
    s_barrier
    v_mfma_f32_16x16x32_bf16 v[92:95], v[36:39], v[20:23], 0
    ds_read_b64_tr_b16 v[68:69], v10 offset:6656
    ds_read_b64_tr_b16 v[70:71], v10 offset:7168
    v_mfma_f32_16x16x32_bf16 v[96:99], v[36:39], v[24:27], 0
    ds_read_b128 v[52:55], v9 offset:0
    ds_read_b128 v[56:59], v9 offset:2048
    v_mfma_f32_16x16x32_bf16 v[100:103], v[36:39], v[28:31], 0
    ds_read_b128 v[60:63], v9 offset:4096
    ds_read_b128 v[64:67], v9 offset:6144
    v_mfma_f32_16x16x32_bf16 v[104:107], v[36:39], v[32:35], 0
    ds_read_b64_tr_b16 v[72:73], v11 offset:6656
    ds_read_b64_tr_b16 v[74:75], v11 offset:6816
    v_mfma_f32_16x16x32_bf16 v[108:111], v[40:43], v[20:23], 0
    ds_read_b128 v[76:79], v12 offset:64
    v_mfma_f32_16x16x32_bf16 v[112:115], v[40:43], v[24:27], 0
    v_mfma_f32_16x16x32_bf16 v[116:119], v[40:43], v[28:31], 0
    v_mfma_f32_16x16x32_bf16 v[120:123], v[40:43], v[32:35], 0
    v_mfma_f32_16x16x32_bf16 v[124:127], v[44:47], v[20:23], 0
    v_mfma_f32_16x16x32_bf16 v[128:131], v[44:47], v[24:27], 0
    v_mfma_f32_16x16x32_bf16 v[132:135], v[44:47], v[28:31], 0
    v_mfma_f32_16x16x32_bf16 v[136:139], v[44:47], v[32:35], 0
    s_waitcnt lgkmcnt(0)
    s_barrier
    v_mfma_f32_16x16x32_bf16 v[92:95], v[68:71], v[52:55], v[92:95]
    ds_read_b64_tr_b16 v[36:37], v10 offset:13312
    ds_read_b64_tr_b16 v[38:39], v10 offset:13824
    v_mfma_f32_16x16x32_bf16 v[96:99], v[68:71], v[56:59], v[96:99]
    ds_read_b128 v[20:23], v8 offset:16384
    ds_read_b128 v[24:27], v8 offset:18432
    v_mfma_f32_16x16x32_bf16 v[100:103], v[68:71], v[60:63], v[100:103]
    ds_read_b128 v[28:31], v8 offset:20480
    ds_read_b128 v[32:35], v8 offset:22528
    v_mfma_f32_16x16x32_bf16 v[104:107], v[68:71], v[64:67], v[104:107]
    ds_read_b64_tr_b16 v[40:41], v11 offset:13312
    ds_read_b64_tr_b16 v[42:43], v11 offset:13472
    v_mfma_f32_16x16x32_bf16 v[108:111], v[72:75], v[52:55], v[108:111]
    ds_read_b128 v[44:47], v12 offset:128
    v_mfma_f32_16x16x32_bf16 v[112:115], v[72:75], v[56:59], v[112:115]
    v_mfma_f32_16x16x32_bf16 v[116:119], v[72:75], v[60:63], v[116:119]
    v_mfma_f32_16x16x32_bf16 v[120:123], v[72:75], v[64:67], v[120:123]
    v_mfma_f32_16x16x32_bf16 v[124:127], v[76:79], v[52:55], v[124:127]
    v_mfma_f32_16x16x32_bf16 v[128:131], v[76:79], v[56:59], v[128:131]
    v_mfma_f32_16x16x32_bf16 v[132:135], v[76:79], v[60:63], v[132:135]
    v_mfma_f32_16x16x32_bf16 v[136:139], v[76:79], v[64:67], v[136:139]
    s_waitcnt lgkmcnt(0)
    s_barrier
    v_mfma_f32_16x16x32_bf16 v[92:95], v[36:39], v[20:23], v[92:95]
    ds_read_b64_tr_b16 v[68:69], v10 offset:19968
    ds_read_b64_tr_b16 v[70:71], v10 offset:20480
    v_mfma_f32_16x16x32_bf16 v[96:99], v[36:39], v[24:27], v[96:99]
    ds_read_b128 v[52:55], v9 offset:16384
    ds_read_b128 v[56:59], v9 offset:18432
    v_mfma_f32_16x16x32_bf16 v[100:103], v[36:39], v[28:31], v[100:103]
    ds_read_b128 v[60:63], v9 offset:20480
    ds_read_b128 v[64:67], v9 offset:22528
    v_mfma_f32_16x16x32_bf16 v[104:107], v[36:39], v[32:35], v[104:107]
    ds_read_b64_tr_b16 v[72:73], v11 offset:19968
    ds_read_b64_tr_b16 v[74:75], v11 offset:20128
    v_mfma_f32_16x16x32_bf16 v[108:111], v[40:43], v[20:23], v[108:111]
    ds_read_b128 v[76:79], v12 offset:192
    s_cmp_lg_u32 s18, 0
    s_cbranch_scc1 K_cq_n4
    s_mov_b64 exec, 1
    s_waitcnt vmcnt(0)
    buffer_atomic_add v86, off, s[36:39], 0 sc1
    s_mov_b64 exec, -1
K_cq_n4:
    v_mfma_f32_16x16x32_bf16 v[112:115], v[40:43], v[24:27], v[112:115]
    v_mfma_f32_16x16x32_bf16 v[116:119], v[40:43], v[28:31], v[116:119]
    v_mfma_f32_16x16x32_bf16 v[120:123], v[40:43], v[32:35], v[120:123]
    v_mfma_f32_16x16x32_bf16 v[124:127], v[44:47], v[20:23], v[124:127]
    v_mfma_f32_16x16x32_bf16 v[128:131], v[44:47], v[24:27], v[128:131]
    v_mfma_f32_16x16x32_bf16 v[132:135], v[44:47], v[28:31], v[132:135]
    v_mfma_f32_16x16x32_bf16 v[136:139], v[44:47], v[32:35], v[136:139]
    s_waitcnt lgkmcnt(0)
    s_barrier
    v_mfma_f32_16x16x32_bf16 v[92:95], v[68:71], v[52:55], v[92:95]
    ds_read_b64_tr_b16 v[36:37], v10 offset:26624
    ds_read_b64_tr_b16 v[38:39], v10 offset:27136
    v_mfma_f32_16x16x32_bf16 v[96:99], v[68:71], v[56:59], v[96:99]
    ds_read_b128 v[20:23], v8 offset:32768
    ds_read_b128 v[24:27], v8 offset:34816
    v_mfma_f32_16x16x32_bf16 v[100:103], v[68:71], v[60:63], v[100:103]
    ds_read_b128 v[28:31], v8 offset:36864
    ds_read_b128 v[32:35], v8 offset:38912
    v_mfma_f32_16x16x32_bf16 v[104:107], v[68:71], v[64:67], v[104:107]
    ds_read_b64_tr_b16 v[40:41], v11 offset:26624
    ds_read_b64_tr_b16 v[42:43], v11 offset:26784
    v_mfma_f32_16x16x32_bf16 v[108:111], v[72:75], v[52:55], v[108:111]
    ds_read_b128 v[44:47], v12 offset:256
    v_mfma_f32_16x16x32_bf16 v[112:115], v[72:75], v[56:59], v[112:115]
    v_mfma_f32_16x16x32_bf16 v[116:119], v[72:75], v[60:63], v[116:119]
    v_mfma_f32_16x16x32_bf16 v[120:123], v[72:75], v[64:67], v[120:123]
    v_mfma_f32_16x16x32_bf16 v[124:127], v[76:79], v[52:55], v[124:127]
    v_mfma_f32_16x16x32_bf16 v[128:131], v[76:79], v[56:59], v[128:131]
    v_mfma_f32_16x16x32_bf16 v[132:135], v[76:79], v[60:63], v[132:135]
    v_mfma_f32_16x16x32_bf16 v[136:139], v[76:79], v[64:67], v[136:139]
    s_waitcnt lgkmcnt(0)
    s_barrier
    v_mfma_f32_16x16x32_bf16 v[92:95], v[36:39], v[20:23], v[92:95]
    ds_read_b64_tr_b16 v[68:69], v10 offset:0
    ds_read_b64_tr_b16 v[70:71], v10 offset:512
    v_mfma_f32_16x16x32_bf16 v[96:99], v[36:39], v[24:27], v[96:99]
    ds_read_b128 v[52:55], v9 offset:32768
    ds_read_b128 v[56:59], v9 offset:34816
    v_mfma_f32_16x16x32_bf16 v[100:103], v[36:39], v[28:31], v[100:103]
    ds_read_b128 v[60:63], v9 offset:36864
    ds_read_b128 v[64:67], v9 offset:38912
    v_mfma_f32_16x16x32_bf16 v[104:107], v[36:39], v[32:35], v[104:107]
    ds_read_b64_tr_b16 v[72:73], v11 offset:0
    ds_read_b64_tr_b16 v[74:75], v11 offset:160
    v_mfma_f32_16x16x32_bf16 v[108:111], v[40:43], v[20:23], v[108:111]
    ds_read_b128 v[76:79], v12 offset:320
    v_mfma_f32_16x16x32_bf16 v[112:115], v[40:43], v[24:27], v[112:115]
    v_mfma_f32_16x16x32_bf16 v[116:119], v[40:43], v[28:31], v[116:119]
    v_mfma_f32_16x16x32_bf16 v[120:123], v[40:43], v[32:35], v[120:123]
    v_mfma_f32_16x16x32_bf16 v[124:127], v[44:47], v[20:23], v[124:127]
    v_mfma_f32_16x16x32_bf16 v[128:131], v[44:47], v[24:27], v[128:131]
    v_mfma_f32_16x16x32_bf16 v[132:135], v[44:47], v[28:31], v[132:135]
    v_mfma_f32_16x16x32_bf16 v[136:139], v[44:47], v[32:35], v[136:139]
    s_waitcnt lgkmcnt(0)
    s_barrier
    v_mfma_f32_16x16x32_bf16 v[92:95], v[68:71], v[52:55], v[92:95]
    ds_read_b64_tr_b16 v[36:37], v10 offset:6656
    ds_read_b64_tr_b16 v[38:39], v10 offset:7168
    v_mfma_f32_16x16x32_bf16 v[96:99], v[68:71], v[56:59], v[96:99]
    ds_read_b128 v[20:23], v8 offset:49152
    ds_read_b128 v[24:27], v8 offset:51200
    v_mfma_f32_16x16x32_bf16 v[100:103], v[68:71], v[60:63], v[100:103]
    ds_read_b128 v[28:31], v8 offset:53248
    ds_read_b128 v[32:35], v8 offset:55296
    v_mfma_f32_16x16x32_bf16 v[104:107], v[68:71], v[64:67], v[104:107]
    ds_read_b64_tr_b16 v[40:41], v11 offset:6656
    ds_read_b64_tr_b16 v[42:43], v11 offset:6816
    v_mfma_f32_16x16x32_bf16 v[108:111], v[72:75], v[52:55], v[108:111]
    ds_read_b128 v[44:47], v12 offset:384
    v_mfma_f32_16x16x32_bf16 v[112:115], v[72:75], v[56:59], v[112:115]
    v_mfma_f32_16x16x32_bf16 v[116:119], v[72:75], v[60:63], v[116:119]
    v_mfma_f32_16x16x32_bf16 v[120:123], v[72:75], v[64:67], v[120:123]
    v_mfma_f32_16x16x32_bf16 v[124:127], v[76:79], v[52:55], v[124:127]
    v_mfma_f32_16x16x32_bf16 v[128:131], v[76:79], v[56:59], v[128:131]
    v_mfma_f32_16x16x32_bf16 v[132:135], v[76:79], v[60:63], v[132:135]
    v_mfma_f32_16x16x32_bf16 v[136:139], v[76:79], v[64:67], v[136:139]
    s_waitcnt lgkmcnt(0)
    s_barrier
    v_mfma_f32_16x16x32_bf16 v[92:95], v[36:39], v[20:23], v[92:95]
    ds_read_b64_tr_b16 v[68:69], v10 offset:13312
    ds_read_b64_tr_b16 v[70:71], v10 offset:13824
    v_mfma_f32_16x16x32_bf16 v[96:99], v[36:39], v[24:27], v[96:99]
    ds_read_b128 v[52:55], v9 offset:49152
    ds_read_b128 v[56:59], v9 offset:51200
    v_mfma_f32_16x16x32_bf16 v[100:103], v[36:39], v[28:31], v[100:103]
    ds_read_b128 v[60:63], v9 offset:53248
    ds_read_b128 v[64:67], v9 offset:55296
    v_mfma_f32_16x16x32_bf16 v[104:107], v[36:39], v[32:35], v[104:107]
    ds_read_b64_tr_b16 v[72:73], v11 offset:13312
    ds_read_b64_tr_b16 v[74:75], v11 offset:13472
    v_mfma_f32_16x16x32_bf16 v[108:111], v[40:43], v[20:23], v[108:111]
    ds_read_b128 v[76:79], v12 offset:448
    v_mfma_f32_16x16x32_bf16 v[112:115], v[40:43], v[24:27], v[112:115]
    v_mfma_f32_16x16x32_bf16 v[116:119], v[40:43], v[28:31], v[116:119]
    v_mfma_f32_16x16x32_bf16 v[120:123], v[40:43], v[32:35], v[120:123]
    v_mfma_f32_16x16x32_bf16 v[124:127], v[44:47], v[20:23], v[124:127]
    v_mfma_f32_16x16x32_bf16 v[128:131], v[44:47], v[24:27], v[128:131]
    v_mfma_f32_16x16x32_bf16 v[132:135], v[44:47], v[28:31], v[132:135]
    v_mfma_f32_16x16x32_bf16 v[136:139], v[44:47], v[32:35], v[136:139]
    s_waitcnt lgkmcnt(0)
    s_barrier
    v_mfma_f32_16x16x32_bf16 v[92:95], v[68:71], v[52:55], v[92:95]
    ds_read_b64_tr_b16 v[36:37], v10 offset:19968
    ds_read_b64_tr_b16 v[38:39], v10 offset:20480
    v_mfma_f32_16x16x32_bf16 v[96:99], v[68:71], v[56:59], v[96:99]
    ds_read_b128 v[20:23], v8 offset:0
    ds_read_b128 v[24:27], v8 offset:2048
    v_mfma_f32_16x16x32_bf16 v[100:103], v[68:71], v[60:63], v[100:103]
    ds_read_b128 v[28:31], v8 offset:4096
    ds_read_b128 v[32:35], v8 offset:6144
    v_mfma_f32_16x16x32_bf16 v[104:107], v[68:71], v[64:67], v[104:107]
    ds_read_b64_tr_b16 v[40:41], v11 offset:19968
    ds_read_b64_tr_b16 v[42:43], v11 offset:20128
    v_mfma_f32_16x16x32_bf16 v[108:111], v[72:75], v[52:55], v[108:111]
    ds_read_b128 v[44:47], v12 offset:512
    v_mfma_f32_16x16x32_bf16 v[112:115], v[72:75], v[56:59], v[112:115]
    v_mfma_f32_16x16x32_bf16 v[116:119], v[72:75], v[60:63], v[116:119]
    v_mfma_f32_16x16x32_bf16 v[120:123], v[72:75], v[64:67], v[120:123]
    v_mfma_f32_16x16x32_bf16 v[124:127], v[76:79], v[52:55], v[124:127]
    v_mfma_f32_16x16x32_bf16 v[128:131], v[76:79], v[56:59], v[128:131]
    v_mfma_f32_16x16x32_bf16 v[132:135], v[76:79], v[60:63], v[132:135]
    v_mfma_f32_16x16x32_bf16 v[136:139], v[76:79], v[64:67], v[136:139]
    s_waitcnt lgkmcnt(0)
    s_barrier
    v_mfma_f32_16x16x32_bf16 v[92:95], v[36:39], v[20:23], v[92:95]
    ds_read_b64_tr_b16 v[68:69], v10 offset:26624
    ds_read_b64_tr_b16 v[70:71], v10 offset:27136
    v_mfma_f32_16x16x32_bf16 v[96:99], v[36:39], v[24:27], v[96:99]
    ds_read_b128 v[52:55], v9 offset:0
    ds_read_b128 v[56:59], v9 offset:2048
    v_mfma_f32_16x16x32_bf16 v[100:103], v[36:39], v[28:31], v[100:103]
    ds_read_b128 v[60:63], v9 offset:4096
    ds_read_b128 v[64:67], v9 offset:6144
    v_mfma_f32_16x16x32_bf16 v[104:107], v[36:39], v[32:35], v[104:107]
    ds_read_b64_tr_b16 v[72:73], v11 offset:26624
    ds_read_b64_tr_b16 v[74:75], v11 offset:26784
    v_mfma_f32_16x16x32_bf16 v[108:111], v[40:43], v[20:23], v[108:111]
    ds_read_b128 v[76:79], v12 offset:576
    v_mfma_f32_16x16x32_bf16 v[112:115], v[40:43], v[24:27], v[112:115]
    v_mfma_f32_16x16x32_bf16 v[116:119], v[40:43], v[28:31], v[116:119]
    v_mfma_f32_16x16x32_bf16 v[120:123], v[40:43], v[32:35], v[120:123]
    v_mfma_f32_16x16x32_bf16 v[124:127], v[44:47], v[20:23], v[124:127]
    v_mfma_f32_16x16x32_bf16 v[128:131], v[44:47], v[24:27], v[128:131]
    v_mfma_f32_16x16x32_bf16 v[132:135], v[44:47], v[28:31], v[132:135]
    v_mfma_f32_16x16x32_bf16 v[136:139], v[44:47], v[32:35], v[136:139]
    s_waitcnt lgkmcnt(0)
    s_barrier
    v_mfma_f32_16x16x32_bf16 v[92:95], v[68:71], v[52:55], v[92:95]
    ds_read_b64_tr_b16 v[36:37], v10 offset:0
    ds_read_b64_tr_b16 v[38:39], v10 offset:512
    v_mfma_f32_16x16x32_bf16 v[96:99], v[68:71], v[56:59], v[96:99]
    ds_read_b128 v[20:23], v8 offset:16384
    ds_read_b128 v[24:27], v8 offset:18432
    v_mfma_f32_16x16x32_bf16 v[100:103], v[68:71], v[60:63], v[100:103]
    ds_read_b128 v[28:31], v8 offset:20480
    ds_read_b128 v[32:35], v8 offset:22528
    v_mfma_f32_16x16x32_bf16 v[104:107], v[68:71], v[64:67], v[104:107]
    ds_read_b64_tr_b16 v[40:41], v11 offset:0
    ds_read_b64_tr_b16 v[42:43], v11 offset:160
    v_mfma_f32_16x16x32_bf16 v[108:111], v[72:75], v[52:55], v[108:111]
    ds_read_b128 v[44:47], v12 offset:640
    v_mfma_f32_16x16x32_bf16 v[112:115], v[72:75], v[56:59], v[112:115]
    v_mfma_f32_16x16x32_bf16 v[116:119], v[72:75], v[60:63], v[116:119]
    v_mfma_f32_16x16x32_bf16 v[120:123], v[72:75], v[64:67], v[120:123]
    v_mfma_f32_16x16x32_bf16 v[124:127], v[76:79], v[52:55], v[124:127]
    v_mfma_f32_16x16x32_bf16 v[128:131], v[76:79], v[56:59], v[128:131]
    v_mfma_f32_16x16x32_bf16 v[132:135], v[76:79], v[60:63], v[132:135]
    v_mfma_f32_16x16x32_bf16 v[136:139], v[76:79], v[64:67], v[136:139]
    s_waitcnt lgkmcnt(0)
    s_barrier
    v_mfma_f32_16x16x32_bf16 v[92:95], v[36:39], v[20:23], v[92:95]
    ds_read_b64_tr_b16 v[68:69], v10 offset:6656
    ds_read_b64_tr_b16 v[70:71], v10 offset:7168
    v_mfma_f32_16x16x32_bf16 v[96:99], v[36:39], v[24:27], v[96:99]
    ds_read_b128 v[52:55], v9 offset:16384
    ds_read_b128 v[56:59], v9 offset:18432
    v_mfma_f32_16x16x32_bf16 v[100:103], v[36:39], v[28:31], v[100:103]
    ds_read_b128 v[60:63], v9 offset:20480
    ds_read_b128 v[64:67], v9 offset:22528
    v_mfma_f32_16x16x32_bf16 v[104:107], v[36:39], v[32:35], v[104:107]
    ds_read_b64_tr_b16 v[72:73], v11 offset:6656
    ds_read_b64_tr_b16 v[74:75], v11 offset:6816
    v_mfma_f32_16x16x32_bf16 v[108:111], v[40:43], v[20:23], v[108:111]
    ds_read_b128 v[76:79], v12 offset:704
    v_mfma_f32_16x16x32_bf16 v[112:115], v[40:43], v[24:27], v[112:115]
    v_mfma_f32_16x16x32_bf16 v[116:119], v[40:43], v[28:31], v[116:119]
    v_mfma_f32_16x16x32_bf16 v[120:123], v[40:43], v[32:35], v[120:123]
    v_mfma_f32_16x16x32_bf16 v[124:127], v[44:47], v[20:23], v[124:127]
    v_mfma_f32_16x16x32_bf16 v[128:131], v[44:47], v[24:27], v[128:131]
    v_mfma_f32_16x16x32_bf16 v[132:135], v[44:47], v[28:31], v[132:135]
    v_mfma_f32_16x16x32_bf16 v[136:139], v[44:47], v[32:35], v[136:139]
    s_waitcnt lgkmcnt(0)
    s_barrier
    v_mfma_f32_16x16x32_bf16 v[92:95], v[68:71], v[52:55], v[92:95]
    ds_read_b64_tr_b16 v[36:37], v10 offset:13312
    ds_read_b64_tr_b16 v[38:39], v10 offset:13824
    v_mfma_f32_16x16x32_bf16 v[96:99], v[68:71], v[56:59], v[96:99]
    ds_read_b128 v[20:23], v8 offset:32768
    ds_read_b128 v[24:27], v8 offset:34816
    v_mfma_f32_16x16x32_bf16 v[100:103], v[68:71], v[60:63], v[100:103]
    ds_read_b128 v[28:31], v8 offset:36864
    ds_read_b128 v[32:35], v8 offset:38912
    v_mfma_f32_16x16x32_bf16 v[104:107], v[68:71], v[64:67], v[104:107]
    ds_read_b64_tr_b16 v[40:41], v11 offset:13312
    ds_read_b64_tr_b16 v[42:43], v11 offset:13472
    v_mfma_f32_16x16x32_bf16 v[108:111], v[72:75], v[52:55], v[108:111]
    ds_read_b128 v[44:47], v12 offset:768
    v_mfma_f32_16x16x32_bf16 v[112:115], v[72:75], v[56:59], v[112:115]
    v_mfma_f32_16x16x32_bf16 v[116:119], v[72:75], v[60:63], v[116:119]
    v_mfma_f32_16x16x32_bf16 v[120:123], v[72:75], v[64:67], v[120:123]
    v_mfma_f32_16x16x32_bf16 v[124:127], v[76:79], v[52:55], v[124:127]
    v_mfma_f32_16x16x32_bf16 v[128:131], v[76:79], v[56:59], v[128:131]
    v_mfma_f32_16x16x32_bf16 v[132:135], v[76:79], v[60:63], v[132:135]
    v_mfma_f32_16x16x32_bf16 v[136:139], v[76:79], v[64:67], v[136:139]
    s_waitcnt lgkmcnt(0)
    s_barrier
    v_mfma_f32_16x16x32_bf16 v[92:95], v[36:39], v[20:23], v[92:95]
    ds_read_b64_tr_b16 v[68:69], v10 offset:19968
    ds_read_b64_tr_b16 v[70:71], v10 offset:20480
    v_mfma_f32_16x16x32_bf16 v[96:99], v[36:39], v[24:27], v[96:99]
    ds_read_b128 v[52:55], v9 offset:32768
    ds_read_b128 v[56:59], v9 offset:34816
    v_mfma_f32_16x16x32_bf16 v[100:103], v[36:39], v[28:31], v[100:103]
    ds_read_b128 v[60:63], v9 offset:36864
    ds_read_b128 v[64:67], v9 offset:38912
    v_mfma_f32_16x16x32_bf16 v[104:107], v[36:39], v[32:35], v[104:107]
    ds_read_b64_tr_b16 v[72:73], v11 offset:19968
    ds_read_b64_tr_b16 v[74:75], v11 offset:20128
    v_mfma_f32_16x16x32_bf16 v[108:111], v[40:43], v[20:23], v[108:111]
    ds_read_b128 v[76:79], v12 offset:832
    v_mfma_f32_16x16x32_bf16 v[112:115], v[40:43], v[24:27], v[112:115]
    v_mfma_f32_16x16x32_bf16 v[116:119], v[40:43], v[28:31], v[116:119]
    v_mfma_f32_16x16x32_bf16 v[120:123], v[40:43], v[32:35], v[120:123]
    v_mfma_f32_16x16x32_bf16 v[124:127], v[44:47], v[20:23], v[124:127]
    v_mfma_f32_16x16x32_bf16 v[128:131], v[44:47], v[24:27], v[128:131]
    v_mfma_f32_16x16x32_bf16 v[132:135], v[44:47], v[28:31], v[132:135]
    v_mfma_f32_16x16x32_bf16 v[136:139], v[44:47], v[32:35], v[136:139]
    s_waitcnt lgkmcnt(0)
    s_barrier
    v_mfma_f32_16x16x32_bf16 v[92:95], v[68:71], v[52:55], v[92:95]
    ds_read_b64_tr_b16 v[36:37], v10 offset:26624
    ds_read_b64_tr_b16 v[38:39], v10 offset:27136
    v_mfma_f32_16x16x32_bf16 v[96:99], v[68:71], v[56:59], v[96:99]
    ds_read_b128 v[20:23], v8 offset:49152
    ds_read_b128 v[24:27], v8 offset:51200
    v_mfma_f32_16x16x32_bf16 v[100:103], v[68:71], v[60:63], v[100:103]
    ds_read_b128 v[28:31], v8 offset:53248
    ds_read_b128 v[32:35], v8 offset:55296
    v_mfma_f32_16x16x32_bf16 v[104:107], v[68:71], v[64:67], v[104:107]
    ds_read_b64_tr_b16 v[40:41], v11 offset:26624
    ds_read_b64_tr_b16 v[42:43], v11 offset:26784
    v_mfma_f32_16x16x32_bf16 v[108:111], v[72:75], v[52:55], v[108:111]
    ds_read_b128 v[44:47], v12 offset:896
    v_mfma_f32_16x16x32_bf16 v[112:115], v[72:75], v[56:59], v[112:115]
    v_mfma_f32_16x16x32_bf16 v[116:119], v[72:75], v[60:63], v[116:119]
    v_mfma_f32_16x16x32_bf16 v[120:123], v[72:75], v[64:67], v[120:123]
    v_mfma_f32_16x16x32_bf16 v[124:127], v[76:79], v[52:55], v[124:127]
    v_mfma_f32_16x16x32_bf16 v[128:131], v[76:79], v[56:59], v[128:131]
    v_mfma_f32_16x16x32_bf16 v[132:135], v[76:79], v[60:63], v[132:135]
    v_mfma_f32_16x16x32_bf16 v[136:139], v[76:79], v[64:67], v[136:139]
    s_waitcnt lgkmcnt(0)
    s_barrier
    v_mfma_f32_16x16x32_bf16 v[92:95], v[36:39], v[20:23], v[92:95]
    ds_read_b64_tr_b16 v[68:69], v10 offset:0
    ds_read_b64_tr_b16 v[70:71], v10 offset:512
    v_mfma_f32_16x16x32_bf16 v[96:99], v[36:39], v[24:27], v[96:99]
    ds_read_b128 v[52:55], v9 offset:49152
    ds_read_b128 v[56:59], v9 offset:51200
    v_mfma_f32_16x16x32_bf16 v[100:103], v[36:39], v[28:31], v[100:103]
    ds_read_b128 v[60:63], v9 offset:53248
    ds_read_b128 v[64:67], v9 offset:55296
    v_mfma_f32_16x16x32_bf16 v[104:107], v[36:39], v[32:35], v[104:107]
    ds_read_b64_tr_b16 v[72:73], v11 offset:0
    ds_read_b64_tr_b16 v[74:75], v11 offset:160
    v_mfma_f32_16x16x32_bf16 v[108:111], v[40:43], v[20:23], v[108:111]
    ds_read_b128 v[76:79], v12 offset:960
    v_mfma_f32_16x16x32_bf16 v[112:115], v[40:43], v[24:27], v[112:115]
    v_mfma_f32_16x16x32_bf16 v[116:119], v[40:43], v[28:31], v[116:119]
    v_mfma_f32_16x16x32_bf16 v[120:123], v[40:43], v[32:35], v[120:123]
    v_mfma_f32_16x16x32_bf16 v[124:127], v[44:47], v[20:23], v[124:127]
    v_mfma_f32_16x16x32_bf16 v[128:131], v[44:47], v[24:27], v[128:131]
    v_mfma_f32_16x16x32_bf16 v[132:135], v[44:47], v[28:31], v[132:135]
    v_mfma_f32_16x16x32_bf16 v[136:139], v[44:47], v[32:35], v[136:139]
    s_waitcnt lgkmcnt(0)
    s_barrier
    v_mfma_f32_16x16x32_bf16 v[92:95], v[68:71], v[52:55], v[92:95]
    ds_read_b64_tr_b16 v[36:37], v10 offset:6656
    ds_read_b64_tr_b16 v[38:39], v10 offset:7168
    v_mfma_f32_16x16x32_bf16 v[96:99], v[68:71], v[56:59], v[96:99]
    ds_read_b128 v[20:23], v8 offset:0
    ds_read_b128 v[24:27], v8 offset:2048
    v_mfma_f32_16x16x32_bf16 v[100:103], v[68:71], v[60:63], v[100:103]
    ds_read_b128 v[28:31], v8 offset:4096
    ds_read_b128 v[32:35], v8 offset:6144
    v_mfma_f32_16x16x32_bf16 v[104:107], v[68:71], v[64:67], v[104:107]
    ds_read_b64_tr_b16 v[40:41], v11 offset:6656
    ds_read_b64_tr_b16 v[42:43], v11 offset:6816
    v_mfma_f32_16x16x32_bf16 v[108:111], v[72:75], v[52:55], v[108:111]
    ds_read_b128 v[44:47], v12 offset:1024
    v_mfma_f32_16x16x32_bf16 v[112:115], v[72:75], v[56:59], v[112:115]
    v_mfma_f32_16x16x32_bf16 v[116:119], v[72:75], v[60:63], v[116:119]
    v_mfma_f32_16x16x32_bf16 v[120:123], v[72:75], v[64:67], v[120:123]
    v_mfma_f32_16x16x32_bf16 v[124:127], v[76:79], v[52:55], v[124:127]
    v_mfma_f32_16x16x32_bf16 v[128:131], v[76:79], v[56:59], v[128:131]
    v_mfma_f32_16x16x32_bf16 v[132:135], v[76:79], v[60:63], v[132:135]
    v_mfma_f32_16x16x32_bf16 v[136:139], v[76:79], v[64:67], v[136:139]
    s_waitcnt lgkmcnt(0)
    s_barrier
    v_mfma_f32_16x16x32_bf16 v[92:95], v[36:39], v[20:23], v[92:95]
    ds_read_b64_tr_b16 v[68:69], v10 offset:13312
    ds_read_b64_tr_b16 v[70:71], v10 offset:13824
    v_mfma_f32_16x16x32_bf16 v[96:99], v[36:39], v[24:27], v[96:99]
    ds_read_b128 v[52:55], v9 offset:0
    ds_read_b128 v[56:59], v9 offset:2048
    v_mfma_f32_16x16x32_bf16 v[100:103], v[36:39], v[28:31], v[100:103]
    ds_read_b128 v[60:63], v9 offset:4096
    ds_read_b128 v[64:67], v9 offset:6144
    v_mfma_f32_16x16x32_bf16 v[104:107], v[36:39], v[32:35], v[104:107]
    ds_read_b64_tr_b16 v[72:73], v11 offset:13312
    ds_read_b64_tr_b16 v[74:75], v11 offset:13472
    v_mfma_f32_16x16x32_bf16 v[108:111], v[40:43], v[20:23], v[108:111]
    ds_read_b128 v[76:79], v12 offset:1088
    v_mfma_f32_16x16x32_bf16 v[112:115], v[40:43], v[24:27], v[112:115]
    v_mfma_f32_16x16x32_bf16 v[116:119], v[40:43], v[28:31], v[116:119]
    v_mfma_f32_16x16x32_bf16 v[120:123], v[40:43], v[32:35], v[120:123]
    v_mfma_f32_16x16x32_bf16 v[124:127], v[44:47], v[20:23], v[124:127]
    v_mfma_f32_16x16x32_bf16 v[128:131], v[44:47], v[24:27], v[128:131]
    v_mfma_f32_16x16x32_bf16 v[132:135], v[44:47], v[28:31], v[132:135]
    v_mfma_f32_16x16x32_bf16 v[136:139], v[44:47], v[32:35], v[136:139]
    s_waitcnt lgkmcnt(0)
    s_barrier
    v_mfma_f32_16x16x32_bf16 v[92:95], v[68:71], v[52:55], v[92:95]
    ds_read_b64_tr_b16 v[36:37], v10 offset:19968
    ds_read_b64_tr_b16 v[38:39], v10 offset:20480
    v_mfma_f32_16x16x32_bf16 v[96:99], v[68:71], v[56:59], v[96:99]
    ds_read_b128 v[20:23], v8 offset:16384
    ds_read_b128 v[24:27], v8 offset:18432
    v_mfma_f32_16x16x32_bf16 v[100:103], v[68:71], v[60:63], v[100:103]
    ds_read_b128 v[28:31], v8 offset:20480
    ds_read_b128 v[32:35], v8 offset:22528
    v_mfma_f32_16x16x32_bf16 v[104:107], v[68:71], v[64:67], v[104:107]
    ds_read_b64_tr_b16 v[40:41], v11 offset:19968
    ds_read_b64_tr_b16 v[42:43], v11 offset:20128
    v_mfma_f32_16x16x32_bf16 v[108:111], v[72:75], v[52:55], v[108:111]
    ds_read_b128 v[44:47], v12 offset:1152
    v_mfma_f32_16x16x32_bf16 v[112:115], v[72:75], v[56:59], v[112:115]
    v_mfma_f32_16x16x32_bf16 v[116:119], v[72:75], v[60:63], v[116:119]
    v_mfma_f32_16x16x32_bf16 v[120:123], v[72:75], v[64:67], v[120:123]
    v_mfma_f32_16x16x32_bf16 v[124:127], v[76:79], v[52:55], v[124:127]
    v_mfma_f32_16x16x32_bf16 v[128:131], v[76:79], v[56:59], v[128:131]
    v_mfma_f32_16x16x32_bf16 v[132:135], v[76:79], v[60:63], v[132:135]
    v_mfma_f32_16x16x32_bf16 v[136:139], v[76:79], v[64:67], v[136:139]
    s_waitcnt lgkmcnt(0)
    s_barrier
    v_mfma_f32_16x16x32_bf16 v[92:95], v[36:39], v[20:23], v[92:95]
    ds_read_b64_tr_b16 v[68:69], v10 offset:26624
    ds_read_b64_tr_b16 v[70:71], v10 offset:27136
    v_mfma_f32_16x16x32_bf16 v[96:99], v[36:39], v[24:27], v[96:99]
    ds_read_b128 v[52:55], v9 offset:16384
    ds_read_b128 v[56:59], v9 offset:18432
    v_mfma_f32_16x16x32_bf16 v[100:103], v[36:39], v[28:31], v[100:103]
    ds_read_b128 v[60:63], v9 offset:20480
    ds_read_b128 v[64:67], v9 offset:22528
    v_mfma_f32_16x16x32_bf16 v[104:107], v[36:39], v[32:35], v[104:107]
    ds_read_b64_tr_b16 v[72:73], v11 offset:26624
    ds_read_b64_tr_b16 v[74:75], v11 offset:26784
    v_mfma_f32_16x16x32_bf16 v[108:111], v[40:43], v[20:23], v[108:111]
    ds_read_b128 v[76:79], v12 offset:1216
    v_mfma_f32_16x16x32_bf16 v[112:115], v[40:43], v[24:27], v[112:115]
    v_mfma_f32_16x16x32_bf16 v[116:119], v[40:43], v[28:31], v[116:119]
    v_mfma_f32_16x16x32_bf16 v[120:123], v[40:43], v[32:35], v[120:123]
    v_mfma_f32_16x16x32_bf16 v[124:127], v[44:47], v[20:23], v[124:127]
    v_mfma_f32_16x16x32_bf16 v[128:131], v[44:47], v[24:27], v[128:131]
    v_mfma_f32_16x16x32_bf16 v[132:135], v[44:47], v[28:31], v[132:135]
    v_mfma_f32_16x16x32_bf16 v[136:139], v[44:47], v[32:35], v[136:139]
    s_waitcnt lgkmcnt(0)
    v_mfma_f32_16x16x32_bf16 v[108:111], v[72:75], v[52:55], v[108:111]
    v_mfma_f32_16x16x32_bf16 v[112:115], v[72:75], v[56:59], v[112:115]
    v_mfma_f32_16x16x32_bf16 v[116:119], v[72:75], v[60:63], v[116:119]
    v_mfma_f32_16x16x32_bf16 v[120:123], v[72:75], v[64:67], v[120:123]
    v_mfma_f32_16x16x32_bf16 v[124:127], v[76:79], v[52:55], v[124:127]
    v_mfma_f32_16x16x32_bf16 v[128:131], v[76:79], v[56:59], v[128:131]
    v_mfma_f32_16x16x32_bf16 v[132:135], v[76:79], v[60:63], v[132:135]
    v_mfma_f32_16x16x32_bf16 v[136:139], v[76:79], v[64:67], v[136:139]
    v_mfma_f32_16x16x32_bf16 v[92:95], v[68:71], v[52:55], v[92:95]
    v_mfma_f32_16x16x32_bf16 v[96:99], v[68:71], v[56:59], v[96:99]
    v_mfma_f32_16x16x32_bf16 v[100:103], v[68:71], v[60:63], v[100:103]
    v_mfma_f32_16x16x32_bf16 v[104:107], v[68:71], v[64:67], v[104:107]
    v_mul_f32 v108, s47, v108
    v_mul_f32 v109, s47, v109
    v_mul_f32 v110, s47, v110
    v_mul_f32 v111, s47, v111
    v_mul_f32 v112, s47, v112
    v_mul_f32 v113, s47, v113
    v_mul_f32 v114, s47, v114
    v_mul_f32 v115, s47, v115
    v_mul_f32 v116, s47, v116
    v_mul_f32 v117, s47, v117
    v_mul_f32 v118, s47, v118
    v_mul_f32 v119, s47, v119
    v_mul_f32 v120, s47, v120
    v_mul_f32 v121, s47, v121
    v_mul_f32 v122, s47, v122
    v_mul_f32 v123, s47, v123
    v_cvt_pk_bf16_f32 v36, v108, v109
    v_cvt_pk_bf16_f32 v37, v110, v111
    v_cvt_pk_bf16_f32 v38, v112, v113
    v_cvt_pk_bf16_f32 v39, v114, v115
    v_cvt_pk_bf16_f32 v40, v116, v117
    v_cvt_pk_bf16_f32 v41, v118, v119
    v_cvt_pk_bf16_f32 v42, v120, v121
    v_cvt_pk_bf16_f32 v43, v122, v123
    v_permlane16_swap_b32 v36, v38
    v_permlane16_swap_b32 v37, v39
    v_permlane16_swap_b32 v40, v42
    v_permlane16_swap_b32 v41, v43
    s_cmp_eq_u32 s62, 1
    s_cbranch_scc1 K_ck4
    buffer_store_dwordx4 v[36:39], v84, s[32:35], s44 offen offset:0 sc1
    buffer_store_dwordx4 v[40:43], v84, s[32:35], s44 offen offset:1024 sc1
K_ca_m:
    v_bfi_b32 v92, s28, v92, v88
    v_bfi_b32 v96, s29, v96, v88
    v_cvt_pk_bf16_f32 v21, v94, v95
    v_cvt_pk_bf16_f32 v23, v98, v99
    v_cvt_pk_bf16_f32 v20, v92, v93
    v_cvt_pk_bf16_f32 v22, v96, v97
    buffer_store_dwordx4 v[20:23], v1, s[32:35], s40 offen sc1
    v_bfi_b32 v100, s28, v100, v88
    v_bfi_b32 v104, s29, v104, v88
    v_cvt_pk_bf16_f32 v25, v102, v103
    v_cvt_pk_bf16_f32 v27, v106, v107
    v_cvt_pk_bf16_f32 v24, v100, v101
    v_cvt_pk_bf16_f32 v26, v104, v105
    buffer_store_dwordx4 v[24:27], v1, s[32:35], s41 offen sc1
    s_branch K_cq_e
K_ck4:
    v_permlane32_swap_b32 v36, v40
    v_permlane32_swap_b32 v37, v41
    v_permlane16_swap_b32 v124, v128
    v_permlane16_swap_b32 v132, v136
    buffer_store_dwordx2 v[36:37], v84, s[32:35], s43 offen sc1
    s_nop 0
    v_permlane32_swap_b32 v124, v132
    v_mul_f32 v124, 0xbfb8aa3b, v124
    v_exp_f32 v124, v124
    s_nop 0
    v_add_f32 v124, 1.0, v124
    v_rcp_f32 v124, v124
    s_nop 0
    buffer_store_dword v124, v85, s[32:35], s45 offen sc1
    s_branch K_ca_m
K_cv:
    v_lshrrev_b32 v17, 1, v6
    v_mul_u32_u24 v84, 768, v17
    s_sub_u32 s44, 10, s62
    v_lshlrev_b32 v19, s44, v19
    v_add_u32 v84, v84, v19
    v_lshl_add_u32 v84, v5, 4, v84
    s_mul_i32 s44, s46, 1536
    s_and_b32 s45, s62, 1
    s_lshl_b32 s45, s45, 9
    s_add_u32 s44, s44, s45
    s_add_u32 s44, s44, 3276800
    s_barrier
    ds_read_b64_tr_b16 v[36:37], v10 offset:0
    ds_read_b64_tr_b16 v[38:39], v10 offset:512
    ds_read_b128 v[20:23], v8 offset:0
    ds_read_b128 v[24:27], v8 offset:2048
    ds_read_b128 v[28:31], v8 offset:4096
    ds_read_b128 v[32:35], v8 offset:6144
    ds_read_b64_tr_b16 v[40:41], v11 offset:0
    ds_read_b64_tr_b16 v[42:43], v11 offset:160
    s_waitcnt lgkmcnt(0)
    s_barrier
    v_mfma_f32_16x16x32_bf16 v[92:95], v[36:39], v[20:23], 0
    ds_read_b64_tr_b16 v[68:69], v10 offset:6656
    ds_read_b64_tr_b16 v[70:71], v10 offset:7168
    v_mfma_f32_16x16x32_bf16 v[96:99], v[36:39], v[24:27], 0
    ds_read_b128 v[52:55], v9 offset:0
    ds_read_b128 v[56:59], v9 offset:2048
    v_mfma_f32_16x16x32_bf16 v[100:103], v[36:39], v[28:31], 0
    ds_read_b128 v[60:63], v9 offset:4096
    ds_read_b128 v[64:67], v9 offset:6144
    v_mfma_f32_16x16x32_bf16 v[104:107], v[36:39], v[32:35], 0
    ds_read_b64_tr_b16 v[72:73], v11 offset:6656
    ds_read_b64_tr_b16 v[74:75], v11 offset:6816
    v_mfma_f32_16x16x32_bf16 v[108:111], v[20:23], v[40:43], 0
    v_mfma_f32_16x16x32_bf16 v[112:115], v[24:27], v[40:43], 0
    v_mfma_f32_16x16x32_bf16 v[116:119], v[28:31], v[40:43], 0
    v_mfma_f32_16x16x32_bf16 v[120:123], v[32:35], v[40:43], 0
    s_waitcnt lgkmcnt(0)
    s_barrier
    v_mfma_f32_16x16x32_bf16 v[92:95], v[68:71], v[52:55], v[92:95]
    ds_read_b64_tr_b16 v[36:37], v10 offset:13312
    ds_read_b64_tr_b16 v[38:39], v10 offset:13824
    v_mfma_f32_16x16x32_bf16 v[96:99], v[68:71], v[56:59], v[96:99]
    ds_read_b128 v[20:23], v8 offset:16384
    ds_read_b128 v[24:27], v8 offset:18432
    v_mfma_f32_16x16x32_bf16 v[100:103], v[68:71], v[60:63], v[100:103]
    ds_read_b128 v[28:31], v8 offset:20480
    ds_read_b128 v[32:35], v8 offset:22528
    v_mfma_f32_16x16x32_bf16 v[104:107], v[68:71], v[64:67], v[104:107]
    ds_read_b64_tr_b16 v[40:41], v11 offset:13312
    ds_read_b64_tr_b16 v[42:43], v11 offset:13472
    v_mfma_f32_16x16x32_bf16 v[108:111], v[52:55], v[72:75], v[108:111]
    v_mfma_f32_16x16x32_bf16 v[112:115], v[56:59], v[72:75], v[112:115]
    v_mfma_f32_16x16x32_bf16 v[116:119], v[60:63], v[72:75], v[116:119]
    v_mfma_f32_16x16x32_bf16 v[120:123], v[64:67], v[72:75], v[120:123]
    s_waitcnt lgkmcnt(0)
    s_barrier
    v_mfma_f32_16x16x32_bf16 v[92:95], v[36:39], v[20:23], v[92:95]
    ds_read_b64_tr_b16 v[68:69], v10 offset:19968
    ds_read_b64_tr_b16 v[70:71], v10 offset:20480
    v_mfma_f32_16x16x32_bf16 v[96:99], v[36:39], v[24:27], v[96:99]
    ds_read_b128 v[52:55], v9 offset:16384
    ds_read_b128 v[56:59], v9 offset:18432
    v_mfma_f32_16x16x32_bf16 v[100:103], v[36:39], v[28:31], v[100:103]
    ds_read_b128 v[60:63], v9 offset:20480
    ds_read_b128 v[64:67], v9 offset:22528
    v_mfma_f32_16x16x32_bf16 v[104:107], v[36:39], v[32:35], v[104:107]
    ds_read_b64_tr_b16 v[72:73], v11 offset:19968
    ds_read_b64_tr_b16 v[74:75], v11 offset:20128
    v_mfma_f32_16x16x32_bf16 v[108:111], v[20:23], v[40:43], v[108:111]
    v_mfma_f32_16x16x32_bf16 v[112:115], v[24:27], v[40:43], v[112:115]
    v_mfma_f32_16x16x32_bf16 v[116:119], v[28:31], v[40:43], v[116:119]
    v_mfma_f32_16x16x32_bf16 v[120:123], v[32:35], v[40:43], v[120:123]
    s_waitcnt lgkmcnt(0)
    s_barrier
    v_mfma_f32_16x16x32_bf16 v[92:95], v[68:71], v[52:55], v[92:95]
    ds_read_b64_tr_b16 v[36:37], v10 offset:26624
    ds_read_b64_tr_b16 v[38:39], v10 offset:27136
    v_mfma_f32_16x16x32_bf16 v[96:99], v[68:71], v[56:59], v[96:99]
    ds_read_b128 v[20:23], v8 offset:32768
    ds_read_b128 v[24:27], v8 offset:34816
    v_mfma_f32_16x16x32_bf16 v[100:103], v[68:71], v[60:63], v[100:103]
    ds_read_b128 v[28:31], v8 offset:36864
    ds_read_b128 v[32:35], v8 offset:38912
    v_mfma_f32_16x16x32_bf16 v[104:107], v[68:71], v[64:67], v[104:107]
    ds_read_b64_tr_b16 v[40:41], v11 offset:26624
    ds_read_b64_tr_b16 v[42:43], v11 offset:26784
    v_mfma_f32_16x16x32_bf16 v[108:111], v[52:55], v[72:75], v[108:111]
    v_mfma_f32_16x16x32_bf16 v[112:115], v[56:59], v[72:75], v[112:115]
    v_mfma_f32_16x16x32_bf16 v[116:119], v[60:63], v[72:75], v[116:119]
    v_mfma_f32_16x16x32_bf16 v[120:123], v[64:67], v[72:75], v[120:123]
    s_waitcnt lgkmcnt(0)
    s_barrier
    v_mfma_f32_16x16x32_bf16 v[92:95], v[36:39], v[20:23], v[92:95]
    ds_read_b64_tr_b16 v[68:69], v10 offset:0
    ds_read_b64_tr_b16 v[70:71], v10 offset:512
    v_mfma_f32_16x16x32_bf16 v[96:99], v[36:39], v[24:27], v[96:99]
    ds_read_b128 v[52:55], v9 offset:32768
    ds_read_b128 v[56:59], v9 offset:34816
    v_mfma_f32_16x16x32_bf16 v[100:103], v[36:39], v[28:31], v[100:103]
    ds_read_b128 v[60:63], v9 offset:36864
    ds_read_b128 v[64:67], v9 offset:38912
    v_mfma_f32_16x16x32_bf16 v[104:107], v[36:39], v[32:35], v[104:107]
    ds_read_b64_tr_b16 v[72:73], v11 offset:0
    ds_read_b64_tr_b16 v[74:75], v11 offset:160
    v_mfma_f32_16x16x32_bf16 v[108:111], v[20:23], v[40:43], v[108:111]
    v_mfma_f32_16x16x32_bf16 v[112:115], v[24:27], v[40:43], v[112:115]
    v_mfma_f32_16x16x32_bf16 v[116:119], v[28:31], v[40:43], v[116:119]
    v_mfma_f32_16x16x32_bf16 v[120:123], v[32:35], v[40:43], v[120:123]
    s_waitcnt lgkmcnt(0)
    s_barrier
    v_mfma_f32_16x16x32_bf16 v[92:95], v[68:71], v[52:55], v[92:95]
    ds_read_b64_tr_b16 v[36:37], v10 offset:6656
    ds_read_b64_tr_b16 v[38:39], v10 offset:7168
    v_mfma_f32_16x16x32_bf16 v[96:99], v[68:71], v[56:59], v[96:99]
    ds_read_b128 v[20:23], v8 offset:49152
    ds_read_b128 v[24:27], v8 offset:51200
    v_mfma_f32_16x16x32_bf16 v[100:103], v[68:71], v[60:63], v[100:103]
    ds_read_b128 v[28:31], v8 offset:53248
    ds_read_b128 v[32:35], v8 offset:55296
    v_mfma_f32_16x16x32_bf16 v[104:107], v[68:71], v[64:67], v[104:107]
    ds_read_b64_tr_b16 v[40:41], v11 offset:6656
    ds_read_b64_tr_b16 v[42:43], v11 offset:6816
    v_mfma_f32_16x16x32_bf16 v[108:111], v[52:55], v[72:75], v[108:111]
    v_mfma_f32_16x16x32_bf16 v[112:115], v[56:59], v[72:75], v[112:115]
    v_mfma_f32_16x16x32_bf16 v[116:119], v[60:63], v[72:75], v[116:119]
    v_mfma_f32_16x16x32_bf16 v[120:123], v[64:67], v[72:75], v[120:123]
    s_waitcnt lgkmcnt(0)
    s_barrier
    v_mfma_f32_16x16x32_bf16 v[92:95], v[36:39], v[20:23], v[92:95]
    ds_read_b64_tr_b16 v[68:69], v10 offset:13312
    ds_read_b64_tr_b16 v[70:71], v10 offset:13824
    v_mfma_f32_16x16x32_bf16 v[96:99], v[36:39], v[24:27], v[96:99]
    ds_read_b128 v[52:55], v9 offset:49152
    ds_read_b128 v[56:59], v9 offset:51200
    v_mfma_f32_16x16x32_bf16 v[100:103], v[36:39], v[28:31], v[100:103]
    ds_read_b128 v[60:63], v9 offset:53248
    ds_read_b128 v[64:67], v9 offset:55296
    v_mfma_f32_16x16x32_bf16 v[104:107], v[36:39], v[32:35], v[104:107]
    ds_read_b64_tr_b16 v[72:73], v11 offset:13312
    ds_read_b64_tr_b16 v[74:75], v11 offset:13472
    v_mfma_f32_16x16x32_bf16 v[108:111], v[20:23], v[40:43], v[108:111]
    v_mfma_f32_16x16x32_bf16 v[112:115], v[24:27], v[40:43], v[112:115]
    v_mfma_f32_16x16x32_bf16 v[116:119], v[28:31], v[40:43], v[116:119]
    v_mfma_f32_16x16x32_bf16 v[120:123], v[32:35], v[40:43], v[120:123]
    s_waitcnt lgkmcnt(0)
    s_barrier
    v_mfma_f32_16x16x32_bf16 v[92:95], v[68:71], v[52:55], v[92:95]
    ds_read_b64_tr_b16 v[36:37], v10 offset:19968
    ds_read_b64_tr_b16 v[38:39], v10 offset:20480
    v_mfma_f32_16x16x32_bf16 v[96:99], v[68:71], v[56:59], v[96:99]
    ds_read_b128 v[20:23], v8 offset:0
    ds_read_b128 v[24:27], v8 offset:2048
    v_mfma_f32_16x16x32_bf16 v[100:103], v[68:71], v[60:63], v[100:103]
    ds_read_b128 v[28:31], v8 offset:4096
    ds_read_b128 v[32:35], v8 offset:6144
    v_mfma_f32_16x16x32_bf16 v[104:107], v[68:71], v[64:67], v[104:107]
    ds_read_b64_tr_b16 v[40:41], v11 offset:19968
    ds_read_b64_tr_b16 v[42:43], v11 offset:20128
    v_mfma_f32_16x16x32_bf16 v[108:111], v[52:55], v[72:75], v[108:111]
    v_mfma_f32_16x16x32_bf16 v[112:115], v[56:59], v[72:75], v[112:115]
    v_mfma_f32_16x16x32_bf16 v[116:119], v[60:63], v[72:75], v[116:119]
    v_mfma_f32_16x16x32_bf16 v[120:123], v[64:67], v[72:75], v[120:123]
    s_waitcnt lgkmcnt(0)
    s_barrier
    v_mfma_f32_16x16x32_bf16 v[92:95], v[36:39], v[20:23], v[92:95]
    ds_read_b64_tr_b16 v[68:69], v10 offset:26624
    ds_read_b64_tr_b16 v[70:71], v10 offset:27136
    v_mfma_f32_16x16x32_bf16 v[96:99], v[36:39], v[24:27], v[96:99]
    ds_read_b128 v[52:55], v9 offset:0
    ds_read_b128 v[56:59], v9 offset:2048
    v_mfma_f32_16x16x32_bf16 v[100:103], v[36:39], v[28:31], v[100:103]
    ds_read_b128 v[60:63], v9 offset:4096
    ds_read_b128 v[64:67], v9 offset:6144
    v_mfma_f32_16x16x32_bf16 v[104:107], v[36:39], v[32:35], v[104:107]
    ds_read_b64_tr_b16 v[72:73], v11 offset:26624
    ds_read_b64_tr_b16 v[74:75], v11 offset:26784
    v_mfma_f32_16x16x32_bf16 v[108:111], v[20:23], v[40:43], v[108:111]
    v_mfma_f32_16x16x32_bf16 v[112:115], v[24:27], v[40:43], v[112:115]
    v_mfma_f32_16x16x32_bf16 v[116:119], v[28:31], v[40:43], v[116:119]
    v_mfma_f32_16x16x32_bf16 v[120:123], v[32:35], v[40:43], v[120:123]
    s_waitcnt lgkmcnt(0)
    s_barrier
    v_mfma_f32_16x16x32_bf16 v[92:95], v[68:71], v[52:55], v[92:95]
    ds_read_b64_tr_b16 v[36:37], v10 offset:0
    ds_read_b64_tr_b16 v[38:39], v10 offset:512
    v_mfma_f32_16x16x32_bf16 v[96:99], v[68:71], v[56:59], v[96:99]
    ds_read_b128 v[20:23], v8 offset:16384
    ds_read_b128 v[24:27], v8 offset:18432
    v_mfma_f32_16x16x32_bf16 v[100:103], v[68:71], v[60:63], v[100:103]
    ds_read_b128 v[28:31], v8 offset:20480
    ds_read_b128 v[32:35], v8 offset:22528
    v_mfma_f32_16x16x32_bf16 v[104:107], v[68:71], v[64:67], v[104:107]
    ds_read_b64_tr_b16 v[40:41], v11 offset:0
    ds_read_b64_tr_b16 v[42:43], v11 offset:160
    v_mfma_f32_16x16x32_bf16 v[108:111], v[52:55], v[72:75], v[108:111]
    v_mfma_f32_16x16x32_bf16 v[112:115], v[56:59], v[72:75], v[112:115]
    v_mfma_f32_16x16x32_bf16 v[116:119], v[60:63], v[72:75], v[116:119]
    v_mfma_f32_16x16x32_bf16 v[120:123], v[64:67], v[72:75], v[120:123]
    s_waitcnt lgkmcnt(0)
    s_barrier
    v_mfma_f32_16x16x32_bf16 v[92:95], v[36:39], v[20:23], v[92:95]
    ds_read_b64_tr_b16 v[68:69], v10 offset:6656
    ds_read_b64_tr_b16 v[70:71], v10 offset:7168
    v_mfma_f32_16x16x32_bf16 v[96:99], v[36:39], v[24:27], v[96:99]
    ds_read_b128 v[52:55], v9 offset:16384
    ds_read_b128 v[56:59], v9 offset:18432
    v_mfma_f32_16x16x32_bf16 v[100:103], v[36:39], v[28:31], v[100:103]
    ds_read_b128 v[60:63], v9 offset:20480
    ds_read_b128 v[64:67], v9 offset:22528
    v_mfma_f32_16x16x32_bf16 v[104:107], v[36:39], v[32:35], v[104:107]
    ds_read_b64_tr_b16 v[72:73], v11 offset:6656
    ds_read_b64_tr_b16 v[74:75], v11 offset:6816
    v_mfma_f32_16x16x32_bf16 v[108:111], v[20:23], v[40:43], v[108:111]
    v_mfma_f32_16x16x32_bf16 v[112:115], v[24:27], v[40:43], v[112:115]
    v_mfma_f32_16x16x32_bf16 v[116:119], v[28:31], v[40:43], v[116:119]
    v_mfma_f32_16x16x32_bf16 v[120:123], v[32:35], v[40:43], v[120:123]
    s_waitcnt lgkmcnt(0)
    s_barrier
    v_mfma_f32_16x16x32_bf16 v[92:95], v[68:71], v[52:55], v[92:95]
    ds_read_b64_tr_b16 v[36:37], v10 offset:13312
    ds_read_b64_tr_b16 v[38:39], v10 offset:13824
    v_mfma_f32_16x16x32_bf16 v[96:99], v[68:71], v[56:59], v[96:99]
    ds_read_b128 v[20:23], v8 offset:32768
    ds_read_b128 v[24:27], v8 offset:34816
    v_mfma_f32_16x16x32_bf16 v[100:103], v[68:71], v[60:63], v[100:103]
    ds_read_b128 v[28:31], v8 offset:36864
    ds_read_b128 v[32:35], v8 offset:38912
    v_mfma_f32_16x16x32_bf16 v[104:107], v[68:71], v[64:67], v[104:107]
    ds_read_b64_tr_b16 v[40:41], v11 offset:13312
    ds_read_b64_tr_b16 v[42:43], v11 offset:13472
    v_mfma_f32_16x16x32_bf16 v[108:111], v[52:55], v[72:75], v[108:111]
    v_mfma_f32_16x16x32_bf16 v[112:115], v[56:59], v[72:75], v[112:115]
    v_mfma_f32_16x16x32_bf16 v[116:119], v[60:63], v[72:75], v[116:119]
    v_mfma_f32_16x16x32_bf16 v[120:123], v[64:67], v[72:75], v[120:123]
    s_waitcnt lgkmcnt(0)
    s_barrier
    v_mfma_f32_16x16x32_bf16 v[92:95], v[36:39], v[20:23], v[92:95]
    ds_read_b64_tr_b16 v[68:69], v10 offset:19968
    ds_read_b64_tr_b16 v[70:71], v10 offset:20480
    v_mfma_f32_16x16x32_bf16 v[96:99], v[36:39], v[24:27], v[96:99]
    ds_read_b128 v[52:55], v9 offset:32768
    ds_read_b128 v[56:59], v9 offset:34816
    v_mfma_f32_16x16x32_bf16 v[100:103], v[36:39], v[28:31], v[100:103]
    ds_read_b128 v[60:63], v9 offset:36864
    ds_read_b128 v[64:67], v9 offset:38912
    v_mfma_f32_16x16x32_bf16 v[104:107], v[36:39], v[32:35], v[104:107]
    ds_read_b64_tr_b16 v[72:73], v11 offset:19968
    ds_read_b64_tr_b16 v[74:75], v11 offset:20128
    v_mfma_f32_16x16x32_bf16 v[108:111], v[20:23], v[40:43], v[108:111]
    v_mfma_f32_16x16x32_bf16 v[112:115], v[24:27], v[40:43], v[112:115]
    v_mfma_f32_16x16x32_bf16 v[116:119], v[28:31], v[40:43], v[116:119]
    v_mfma_f32_16x16x32_bf16 v[120:123], v[32:35], v[40:43], v[120:123]
    s_waitcnt lgkmcnt(0)
    s_barrier
    v_mfma_f32_16x16x32_bf16 v[92:95], v[68:71], v[52:55], v[92:95]
    ds_read_b64_tr_b16 v[36:37], v10 offset:26624
    ds_read_b64_tr_b16 v[38:39], v10 offset:27136
    v_mfma_f32_16x16x32_bf16 v[96:99], v[68:71], v[56:59], v[96:99]
    ds_read_b128 v[20:23], v8 offset:49152
    ds_read_b128 v[24:27], v8 offset:51200
    v_mfma_f32_16x16x32_bf16 v[100:103], v[68:71], v[60:63], v[100:103]
    ds_read_b128 v[28:31], v8 offset:53248
    ds_read_b128 v[32:35], v8 offset:55296
    v_mfma_f32_16x16x32_bf16 v[104:107], v[68:71], v[64:67], v[104:107]
    ds_read_b64_tr_b16 v[40:41], v11 offset:26624
    ds_read_b64_tr_b16 v[42:43], v11 offset:26784
    v_mfma_f32_16x16x32_bf16 v[108:111], v[52:55], v[72:75], v[108:111]
    v_mfma_f32_16x16x32_bf16 v[112:115], v[56:59], v[72:75], v[112:115]
    v_mfma_f32_16x16x32_bf16 v[116:119], v[60:63], v[72:75], v[116:119]
    v_mfma_f32_16x16x32_bf16 v[120:123], v[64:67], v[72:75], v[120:123]
    s_waitcnt lgkmcnt(0)
    s_barrier
    v_mfma_f32_16x16x32_bf16 v[92:95], v[36:39], v[20:23], v[92:95]
    ds_read_b64_tr_b16 v[68:69], v10 offset:0
    ds_read_b64_tr_b16 v[70:71], v10 offset:512
    v_mfma_f32_16x16x32_bf16 v[96:99], v[36:39], v[24:27], v[96:99]
    ds_read_b128 v[52:55], v9 offset:49152
    ds_read_b128 v[56:59], v9 offset:51200
    v_mfma_f32_16x16x32_bf16 v[100:103], v[36:39], v[28:31], v[100:103]
    ds_read_b128 v[60:63], v9 offset:53248
    ds_read_b128 v[64:67], v9 offset:55296
    v_mfma_f32_16x16x32_bf16 v[104:107], v[36:39], v[32:35], v[104:107]
    ds_read_b64_tr_b16 v[72:73], v11 offset:0
    ds_read_b64_tr_b16 v[74:75], v11 offset:160
    v_mfma_f32_16x16x32_bf16 v[108:111], v[20:23], v[40:43], v[108:111]
    v_mfma_f32_16x16x32_bf16 v[112:115], v[24:27], v[40:43], v[112:115]
    v_mfma_f32_16x16x32_bf16 v[116:119], v[28:31], v[40:43], v[116:119]
    v_mfma_f32_16x16x32_bf16 v[120:123], v[32:35], v[40:43], v[120:123]
    s_waitcnt lgkmcnt(0)
    s_barrier
    v_mfma_f32_16x16x32_bf16 v[92:95], v[68:71], v[52:55], v[92:95]
    ds_read_b64_tr_b16 v[36:37], v10 offset:6656
    ds_read_b64_tr_b16 v[38:39], v10 offset:7168
    v_mfma_f32_16x16x32_bf16 v[96:99], v[68:71], v[56:59], v[96:99]
    ds_read_b128 v[20:23], v8 offset:0
    ds_read_b128 v[24:27], v8 offset:2048
    v_mfma_f32_16x16x32_bf16 v[100:103], v[68:71], v[60:63], v[100:103]
    ds_read_b128 v[28:31], v8 offset:4096
    ds_read_b128 v[32:35], v8 offset:6144
    v_mfma_f32_16x16x32_bf16 v[104:107], v[68:71], v[64:67], v[104:107]
    ds_read_b64_tr_b16 v[40:41], v11 offset:6656
    ds_read_b64_tr_b16 v[42:43], v11 offset:6816
    v_mfma_f32_16x16x32_bf16 v[108:111], v[52:55], v[72:75], v[108:111]
    v_mfma_f32_16x16x32_bf16 v[112:115], v[56:59], v[72:75], v[112:115]
    v_mfma_f32_16x16x32_bf16 v[116:119], v[60:63], v[72:75], v[116:119]
    v_mfma_f32_16x16x32_bf16 v[120:123], v[64:67], v[72:75], v[120:123]
    s_waitcnt lgkmcnt(0)
    s_barrier
    v_mfma_f32_16x16x32_bf16 v[92:95], v[36:39], v[20:23], v[92:95]
    ds_read_b64_tr_b16 v[68:69], v10 offset:13312
    ds_read_b64_tr_b16 v[70:71], v10 offset:13824
    v_mfma_f32_16x16x32_bf16 v[96:99], v[36:39], v[24:27], v[96:99]
    ds_read_b128 v[52:55], v9 offset:0
    ds_read_b128 v[56:59], v9 offset:2048
    v_mfma_f32_16x16x32_bf16 v[100:103], v[36:39], v[28:31], v[100:103]
    ds_read_b128 v[60:63], v9 offset:4096
    ds_read_b128 v[64:67], v9 offset:6144
    v_mfma_f32_16x16x32_bf16 v[104:107], v[36:39], v[32:35], v[104:107]
    ds_read_b64_tr_b16 v[72:73], v11 offset:13312
    ds_read_b64_tr_b16 v[74:75], v11 offset:13472
    v_mfma_f32_16x16x32_bf16 v[108:111], v[20:23], v[40:43], v[108:111]
    v_mfma_f32_16x16x32_bf16 v[112:115], v[24:27], v[40:43], v[112:115]
    v_mfma_f32_16x16x32_bf16 v[116:119], v[28:31], v[40:43], v[116:119]
    v_mfma_f32_16x16x32_bf16 v[120:123], v[32:35], v[40:43], v[120:123]
    s_waitcnt lgkmcnt(0)
    s_barrier
    v_mfma_f32_16x16x32_bf16 v[92:95], v[68:71], v[52:55], v[92:95]
    ds_read_b64_tr_b16 v[36:37], v10 offset:19968
    ds_read_b64_tr_b16 v[38:39], v10 offset:20480
    v_mfma_f32_16x16x32_bf16 v[96:99], v[68:71], v[56:59], v[96:99]
    ds_read_b128 v[20:23], v8 offset:16384
    ds_read_b128 v[24:27], v8 offset:18432
    v_mfma_f32_16x16x32_bf16 v[100:103], v[68:71], v[60:63], v[100:103]
    ds_read_b128 v[28:31], v8 offset:20480
    ds_read_b128 v[32:35], v8 offset:22528
    v_mfma_f32_16x16x32_bf16 v[104:107], v[68:71], v[64:67], v[104:107]
    ds_read_b64_tr_b16 v[40:41], v11 offset:19968
    ds_read_b64_tr_b16 v[42:43], v11 offset:20128
    v_mfma_f32_16x16x32_bf16 v[108:111], v[52:55], v[72:75], v[108:111]
    v_mfma_f32_16x16x32_bf16 v[112:115], v[56:59], v[72:75], v[112:115]
    v_mfma_f32_16x16x32_bf16 v[116:119], v[60:63], v[72:75], v[116:119]
    v_mfma_f32_16x16x32_bf16 v[120:123], v[64:67], v[72:75], v[120:123]
    s_waitcnt lgkmcnt(0)
    s_barrier
    v_mfma_f32_16x16x32_bf16 v[92:95], v[36:39], v[20:23], v[92:95]
    ds_read_b64_tr_b16 v[68:69], v10 offset:26624
    ds_read_b64_tr_b16 v[70:71], v10 offset:27136
    v_mfma_f32_16x16x32_bf16 v[96:99], v[36:39], v[24:27], v[96:99]
    ds_read_b128 v[52:55], v9 offset:16384
    ds_read_b128 v[56:59], v9 offset:18432
    v_mfma_f32_16x16x32_bf16 v[100:103], v[36:39], v[28:31], v[100:103]
    ds_read_b128 v[60:63], v9 offset:20480
    ds_read_b128 v[64:67], v9 offset:22528
    v_mfma_f32_16x16x32_bf16 v[104:107], v[36:39], v[32:35], v[104:107]
    ds_read_b64_tr_b16 v[72:73], v11 offset:26624
    ds_read_b64_tr_b16 v[74:75], v11 offset:26784
    v_mfma_f32_16x16x32_bf16 v[108:111], v[20:23], v[40:43], v[108:111]
    v_mfma_f32_16x16x32_bf16 v[112:115], v[24:27], v[40:43], v[112:115]
    v_mfma_f32_16x16x32_bf16 v[116:119], v[28:31], v[40:43], v[116:119]
    v_mfma_f32_16x16x32_bf16 v[120:123], v[32:35], v[40:43], v[120:123]
    s_waitcnt lgkmcnt(0)
    v_mfma_f32_16x16x32_bf16 v[108:111], v[52:55], v[72:75], v[108:111]
    v_mfma_f32_16x16x32_bf16 v[112:115], v[56:59], v[72:75], v[112:115]
    v_mfma_f32_16x16x32_bf16 v[116:119], v[60:63], v[72:75], v[116:119]
    v_mfma_f32_16x16x32_bf16 v[120:123], v[64:67], v[72:75], v[120:123]
    v_mfma_f32_16x16x32_bf16 v[92:95], v[68:71], v[52:55], v[92:95]
    v_mfma_f32_16x16x32_bf16 v[96:99], v[68:71], v[56:59], v[96:99]
    v_mfma_f32_16x16x32_bf16 v[100:103], v[68:71], v[60:63], v[100:103]
    v_mfma_f32_16x16x32_bf16 v[104:107], v[68:71], v[64:67], v[104:107]
    s_nop 0
    v_cvt_pk_bf16_f32 v36, v108, v109
    v_cvt_pk_bf16_f32 v37, v110, v111
    v_cvt_pk_bf16_f32 v38, v112, v113
    v_cvt_pk_bf16_f32 v39, v114, v115
    v_cvt_pk_bf16_f32 v40, v116, v117
    v_cvt_pk_bf16_f32 v41, v118, v119
    v_cvt_pk_bf16_f32 v42, v120, v121
    v_cvt_pk_bf16_f32 v43, v122, v123
    s_cmp_eq_u32 s62, 2
    s_cbranch_scc1 K_cv_st
    s_mov_b32 exec_lo, 0x00f000f0
    s_mov_b32 exec_hi, 0x00f000f0
    v_mov_b32 v36, 0x3f803f80
    v_mov_b32 v37, 0x3f803f80
    v_mov_b32 v38, 0x3f803f80
    v_mov_b32 v39, 0x3f803f80
    v_mov_b32 v40, 0x3f803f80
    v_mov_b32 v41, 0x3f803f80
    v_mov_b32 v42, 0x3f803f80
    v_mov_b32 v43, 0x3f803f80
    s_mov_b32 exec_lo, 0x00ff00ff
    s_mov_b32 exec_hi, 0x00ff00ff
K_cv_st:
    buffer_store_dwordx4 v[36:39], v84, s[32:35], s44 offen offset:0 sc1
    buffer_store_dwordx4 v[40:43], v84, s[32:35], s44 offen offset:1536 sc1
    s_mov_b64 exec, -1
    s_branch K_ca_m
K_done:
    s_endpgm
.section .rodata,"a"
.p2align 6
.amdhsa_kernel gated_mix__grouped_kv_mqa__glu_gated_geglu__prompt_kernel
  .amdhsa_next_free_vgpr 168
  .amdhsa_next_free_sgpr 96
  .amdhsa_accum_offset 168
  .amdhsa_group_segment_fixed_size 0
  .amdhsa_kernarg_size 104
  .amdhsa_float_denorm_mode_32 3
  .amdhsa_user_sgpr_count 2
  .amdhsa_user_sgpr_kernarg_segment_ptr 1
  .amdhsa_system_sgpr_workgroup_id_x 1
.end_amdhsa_kernel
```
